```python
import torch

def _softmax(x, axis=-1):
    return torch.softmax(x, dim=axis)
def _gelu(x):
    return torch.nn.functional.gelu(x, approximate="tanh")
def _silu(x):
    return torch.nn.functional.silu(x)
def _sigmoid(x):
    return torch.sigmoid(x)
def _layernorm(x, axis=-1, eps=1e-5):
    m = x.mean(dim=axis, keepdim=True)
    v = x.var(dim=axis, keepdim=True, unbiased=False)
    return (x - m) / torch.sqrt(v + eps)
def _scatter_add(tgt, idx, src, axis=0):
    return tgt.clone().index_add_(axis, idx, src)
def _segment_sum(src, seg, n):
    out = torch.zeros((n,) + src.shape[1:], dtype=src.dtype)
    return out.index_add_(0, seg, src)
def _pad(x, pw):
    flat = tuple(v for pair in reversed(pw) for v in pair)
    return torch.nn.functional.pad(x, flat)

kernel_name = 'sequential_preLN__mha_block__glu_gated_geglu__prompt'

def setup_inputs():

    _w = (lambda a: (lambda t: t.to(torch.bfloat16) if t.is_floating_point() else t)(torch.as_tensor(a)))
    def _A_setup():
        B, S, D, H = 1, 2048, 1024, 32
        return {
            "x": _w((lambda *s: torch.randn(*s, dtype=torch.bfloat16) * 0.05)(B, S, D)),
            "wqkv": _w((lambda *s: torch.randn(*s, dtype=torch.bfloat16) * 0.05)(D, 3 * D)),
            "wo": _w((lambda *s: torch.randn(*s, dtype=torch.bfloat16) * 0.05)(D, D)),
        }
    _A_in = _A_setup()

    def _B_setup():
        B, S, Dm, Df = 1, 2048, 1024, 3584
        return {
            "x": _w((lambda *s: torch.randn(*s, dtype=torch.bfloat16) * 0.05)(B, S, Dm)),
            "w_gate": _w((lambda *s: torch.randn(*s, dtype=torch.bfloat16) * 0.8)(Dm, Df) * (Dm ** -0.5)),
            "w_up": _w((lambda *s: torch.randn(*s, dtype=torch.bfloat16) * 0.8)(Dm, Df) * (Dm ** -0.5)),
            "w_down": _w((lambda *s: torch.randn(*s, dtype=torch.bfloat16) * 0.8)(Df, Dm) * (Df ** -0.5)),
        }
    _B_in = _B_setup()

    return {
        "A_x": _A_in["x"],
        "A_wqkv": _A_in["wqkv"],
        "A_wo": _A_in["wo"],
        "B_x": _B_in["x"],
        "B_w_gate": _B_in["w_gate"],
        "B_w_up": _B_in["w_up"],
        "B_w_down": _B_in["w_down"],
    }

def reference(A_x, A_wqkv, A_wo, B_x, B_w_gate, B_w_up, B_w_down):
    def _A_ref(x, wqkv, wo):
        B, S, D = x.shape
        H = 32
        Dh = D // H
        qkv = (lambda x, *d: x.permute(*d))((x @ wqkv).reshape(B, S, 3, H, Dh), 2, 0, 3, 1, 4)
        q, k, v = qkv[0], qkv[1], qkv[2]
        scores = torch.einsum("bhqd,bhkd->bhqk", q, k) * (Dh ** -0.5)
        p = _softmax(scores, axis=-1)
        o = torch.einsum("bhqk,bhkd->bhqd", p, v)
        return (lambda x, *d: x.permute(*d))(o, 0, 2, 1, 3).reshape(B, S, D) @ wo

    def _B_ref(x, w_gate, w_up, w_down):
        g = torch.einsum("bsd,df->bsf", x, w_gate)
        u = torch.einsum("bsd,df->bsf", x, w_up)
        h = _gelu(g) * u
        return torch.einsum("bsf,fd->bsd", h, w_down)

    x = A_x
    h = x + _A_ref(_layernorm(x, axis=-1), A_wqkv, A_wo)
    h2 = h + _B_ref(_layernorm(h, axis=-1), B_w_gate, B_w_up, B_w_down)
    return h2
```

```asm
; @launch grid=(256,1,1) block=(512,1,1) lds=163840
.amdgcn_target "amdgcn-amd-amdhsa--gfx950"
.text
.globl sequential_preLN__mha_block__glu_gated_geglu__prompt_kernel
.p2align 8
.type sequential_preLN__mha_block__glu_gated_geglu__prompt_kernel,@function
sequential_preLN__mha_block__glu_gated_geglu__prompt_kernel:
  s_cmp_ge_u32 s2, 256
  s_cbranch_scc1 L_end
  s_load_dwordx16 s[64:79], s[0:1], 0
  s_load_dwordx4 s[80:83], s[0:1], 64
  v_and_b32 v1, 63, v0
  v_lshrrev_b32 v2, 6, v0
  s_nop 0
  v_readfirstlane_b32 s20, v2
  s_getpc_b64 s[44:45]
L_cpf_pc:
  s_mov_b32 s46, L_end-L_cpf_pc
  s_mov_b32 s47, 0x20000
  s_lshr_b32 s3, s2, 3
  s_lshl_b32 s3, s3, 11
  s_cmp_lg_u32 s20, 0
  s_cbranch_scc1 L_nocpf_1
  v_lshlrev_b32 v210, 5, v1
  v_add_u32 v210, s3, v210
  buffer_load_dword v211, v210, s[44:47], 0 offen
L_nocpf_1:
  s_and_b32 s21, s2, 7
  s_lshr_b32 s22, s2, 3
  s_and_b32 s23, s21, 1
  s_lshl_b32 s23, s23, 3
  s_and_b32 s24, s22, 7
  s_add_u32 s23, s23, s24
  s_lshr_b32 s24, s21, 1
  s_lshl_b32 s24, s24, 2
  s_lshr_b32 s25, s22, 3
  s_add_u32 s24, s24, s25
  s_and_b32 s25, s20, 1
  s_lshr_b32 s26, s20, 1
  v_lshrrev_b32 v14, 3, v1
  v_and_b32 v15, 7, v1
  v_lshrrev_b32 v16, 2, v14
  v_and_b32 v17, 3, v14
  v_lshl_add_u32 v16, v16, 3, v17
  v_mul_u32_u24 v16, 6144, v16
  v_lshrrev_b32 v17, 1, v15
  v_lshrrev_b32 v14, 1, v14
  v_xor_b32 v17, v17, v14
  v_and_b32 v15, 1, v15
  v_lshl_add_u32 v17, v17, 1, v15
  v_lshl_add_u32 v10, v17, 4, v16
  v_add_u32 v11, 2048, v10
  v_add_u32 v12, 4096, v10
  v_lshrrev_b32 v14, 3, v1
  v_and_b32 v15, 7, v1
  v_lshrrev_b32 v17, 4, v1
  v_xor_b32 v17, v17, v15
  v_lshlrev_b32 v17, 4, v17
  v_lshl_add_u32 v13, v14, 11, v17
  v_xor_b32 v4, 64, v13
  v_add_u32 v4, 15360, v4
  v_lshlrev_b32 v5, 4, v1
  s_lshr_b32 s27, s20, 2
  s_lshl_b32 s27, s27, 5
  s_bfe_u32 s28, s20, 0x10001
  s_lshl_b32 s28, s28, 4
  s_add_u32 s27, s27, s28
  s_lshl_b32 s28, s25, 2
  s_add_u32 s27, s27, s28
  s_mul_i32 s48, s27, 6144
  s_lshl_b32 s28, s24, 7
  s_add_u32 s48, s48, s28
  s_add_u32 s46, s48, 6291456
  s_lshl_b32 s49, s23, 3
  s_add_u32 s49, s49, s20
  s_lshl_b32 s49, s49, 15
  s_add_u32 s27, s23, s24
  s_and_b32 s27, s27, 15
  s_mul_i32 s28, s27, 393216
  s_add_u32 s30, s48, s28
  s_lshl_b32 s28, s27, 7
  s_add_u32 s31, s49, s28
  s_lshl_b32 s32, s20, 10
  s_lshl_b32 s33, s20, 11
  s_add_u32 s33, s33, 24576
  s_waitcnt lgkmcnt(0)
  s_mov_b32 s8, s66
  s_mov_b32 s9, s67
  s_mov_b32 s10, 0x600000
  s_mov_b32 s11, 0x20000
  s_mov_b32 s12, s82
  s_mov_b32 s13, s83
  s_mov_b32 s14, 0x10000000
  s_mov_b32 s15, 0x20000
  s_mov_b32 s16, s64
  s_mov_b32 s17, s65
  s_mov_b32 s18, 0x400000
  s_mov_b32 s19, 0x20000
  s_add_u32 m0, s32, 0
  s_nop 0
  buffer_load_dwordx4 v10, s[8:11], s30 offen lds
  s_add_u32 m0, s32, 8192
  s_nop 0
  buffer_load_dwordx4 v11, s[8:11], s30 offen lds
  s_add_u32 m0, s32, 16384
  s_nop 0
  buffer_load_dwordx4 v12, s[8:11], s30 offen lds
  s_add_u32 m0, s33, 0
  s_nop 0
  buffer_load_dwordx4 v13, s[16:19], s31 offen lds
  buffer_load_dwordx4 v4, s[16:19], s31 offen offset:1024 lds
  s_add_u32 s30, s30, 393216
  s_add_u32 s31, s31, 128
  s_cmp_eq_u32 s30, s46
  s_cselect_b32 s30, s48, s30
  s_cselect_b32 s31, s49, s31
  s_mov_b32 s88, s68
  s_mov_b32 s89, s69
  s_mov_b32 s90, 0x200000
  s_mov_b32 s91, 0x20000
  v_lshlrev_b32 v197, 4, v0
  v_mov_b32 v14, v197
  s_cmp_lg_u32 s2, 0
  s_cbranch_scc1 L_noinit_2
  v_mov_b32 v168, 0
  v_mov_b32 v169, 0
  v_mov_b32 v170, 0
  v_mov_b32 v171, 0
  s_mov_b32 s27, 41680896
  buffer_store_dwordx4 v[168:171], v14, s[12:15], s27 offen sc1
L_noinit_2:
  s_mov_b32 s60, s80
  s_mov_b32 s61, s81
  s_mov_b32 s62, 0x100
  s_mov_b32 s63, 0x20000
  v_lshrrev_b32 v14, 4, v1
  v_bfe_u32 v15, v1, 2, 2
  v_lshrrev_b32 v16, 1, v14
  v_and_b32 v17, 1, v14
  v_lshlrev_b32 v16, 4, v16
  v_lshl_add_u32 v16, v17, 2, v16
  v_add_u32 v16, v16, v15
  v_lshlrev_b32 v16, 7, v16
  v_lshrrev_b32 v18, 1, v15
  v_lshl_add_u32 v18, v17, 1, v18
  v_xor_b32 v18, s26, v18
  v_lshl_add_u32 v16, v18, 5, v16
  v_and_b32 v18, 3, v1
  v_lshl_add_u32 v2, v18, 3, v16
  v_add_u32 v3, 81920, v2
  v_cmp_eq_u32 s[50:51], 1, v18
  v_cmp_eq_u32 s[52:53], 2, v18
  v_cmp_eq_u32 s[54:55], 3, v18
  s_barrier
  v_cmp_eq_u32 s[56:57], v14, v15
  v_and_b32 v15, 15, v1
  v_cmp_eq_u32 s[58:59], 0, v15
  v_lshrrev_b32 v16, 1, v15
  v_xor_b32 v16, v16, v14
  v_lshlrev_b32 v16, 4, v16
  v_lshl_add_u32 v16, v15, 7, v16
  s_cmp_eq_u32 s25, 0
  s_cselect_b32 s58, s58, 0
  s_cselect_b32 s59, s59, 0
  s_lshl_b32 s28, s25, 13
  s_add_u32 s28, s28, 24576
  s_xor_b32 s27, s26, 0
  s_lshl_b32 s27, s27, 11
  s_add_u32 s27, s27, s28
  v_add_u32 v128, s27, v16
  v_xor_b32 v132, 64, v128
  v_add_u32 v136, 81920, v128
  v_add_u32 v140, 81920, v132
  s_xor_b32 s27, s26, 1
  s_lshl_b32 s27, s27, 11
  s_add_u32 s27, s27, s28
  v_add_u32 v129, s27, v16
  v_xor_b32 v133, 64, v129
  v_add_u32 v137, 81920, v129
  v_add_u32 v141, 81920, v133
  s_xor_b32 s27, s26, 2
  s_lshl_b32 s27, s27, 11
  s_add_u32 s27, s27, s28
  v_add_u32 v130, s27, v16
  v_xor_b32 v134, 64, v130
  v_add_u32 v138, 81920, v130
  v_add_u32 v142, 81920, v134
  s_xor_b32 s27, s26, 3
  s_lshl_b32 s27, s27, 11
  s_add_u32 s27, s27, s28
  v_add_u32 v131, s27, v16
  v_xor_b32 v135, 64, v131
  v_add_u32 v139, 81920, v131
  v_add_u32 v143, 81920, v135
  v_mov_b32 v6, 0
  v_lshlrev_b32 v8, 3, v15
  s_lshl_b32 s42, s23, 3
  s_lshl_b32 s27, s25, 2
  s_add_u32 s42, s42, s27
  s_add_u32 s42, s42, s26
  s_lshl_b32 s42, s42, 7
  s_lshl_b32 s27, s24, 14
  s_add_u32 s42, s42, s27
  s_add_u32 s42, s42, 41156608
  v_lshlrev_b32 v9, 4, v14
  s_lshl_b32 s43, s24, 4
  s_add_u32 s43, s43, s23
  s_mul_i32 s43, s43, 768
  s_lshl_b32 s27, s26, 6
  s_add_u32 s43, s43, s27
  s_add_u32 s43, s43, 41418752
  v_and_b32 v196, 1, v1
  v_lshlrev_b32 v196, 7, v196
  v_mov_b32 v64, 0
  v_mov_b32 v65, 0
  v_mov_b32 v66, 0
  v_mov_b32 v67, 0
  v_mov_b32 v68, 0
  v_mov_b32 v69, 0
  v_mov_b32 v70, 0
  v_mov_b32 v71, 0
  v_mov_b32 v72, 0
  v_mov_b32 v73, 0
  v_mov_b32 v74, 0
  v_mov_b32 v75, 0
  v_mov_b32 v76, 0
  v_mov_b32 v77, 0
  v_mov_b32 v78, 0
  v_mov_b32 v79, 0
  v_mov_b32 v80, 0
  v_mov_b32 v81, 0
  v_mov_b32 v82, 0
  v_mov_b32 v83, 0
  v_mov_b32 v84, 0
  v_mov_b32 v85, 0
  v_mov_b32 v86, 0
  v_mov_b32 v87, 0
  v_mov_b32 v88, 0
  v_mov_b32 v89, 0
  v_mov_b32 v90, 0
  v_mov_b32 v91, 0
  v_mov_b32 v92, 0
  v_mov_b32 v93, 0
  v_mov_b32 v94, 0
  v_mov_b32 v95, 0
  v_mov_b32 v96, 0
  v_mov_b32 v97, 0
  v_mov_b32 v98, 0
  v_mov_b32 v99, 0
  v_mov_b32 v100, 0
  v_mov_b32 v101, 0
  v_mov_b32 v102, 0
  v_mov_b32 v103, 0
  v_mov_b32 v104, 0
  v_mov_b32 v105, 0
  v_mov_b32 v106, 0
  v_mov_b32 v107, 0
  v_mov_b32 v108, 0
  v_mov_b32 v109, 0
  v_mov_b32 v110, 0
  v_mov_b32 v111, 0
  v_mov_b32 v144, 0
  v_mov_b32 v145, 0
  v_mov_b32 v146, 0
  v_mov_b32 v147, 0
  v_mov_b32 v148, 0
  v_mov_b32 v149, 0
  v_mov_b32 v150, 0
  v_mov_b32 v151, 0
  v_mov_b32 v152, 0
  v_mov_b32 v153, 0
  v_mov_b32 v154, 0
  v_mov_b32 v155, 0
  v_mov_b32 v156, 0
  v_mov_b32 v157, 0
  v_mov_b32 v158, 0
  v_mov_b32 v159, 0
  v_mov_b32 v160, 0
  v_mov_b32 v161, 0
  v_mov_b32 v162, 0
  v_mov_b32 v163, 0
  v_mov_b32 v164, 0x3f803f80
  v_mov_b32 v165, 0x3f803f80
  v_mov_b32 v166, 0x3f803f80
  v_mov_b32 v167, 0x3f803f80
  s_waitcnt vmcnt(3)
  s_add_u32 m0, s32, 40960
  s_nop 0
  buffer_load_dwordx4 v10, s[8:11], s30 offen lds
  s_add_u32 m0, s32, 49152
  s_nop 0
  buffer_load_dwordx4 v11, s[8:11], s30 offen lds
  s_add_u32 m0, s32, 57344
  s_nop 0
  buffer_load_dwordx4 v12, s[8:11], s30 offen lds
  s_add_u32 m0, s33, 40960
  s_nop 0
  buffer_load_dwordx4 v13, s[16:19], s31 offen lds
  buffer_load_dwordx4 v4, s[16:19], s31 offen offset:1024 lds
  s_add_u32 s30, s30, 393216
  s_add_u32 s31, s31, 128
  s_cmp_eq_u32 s30, s46
  s_cselect_b32 s30, s48, s30
  s_cselect_b32 s31, s49, s31
  s_waitcnt vmcnt(5)
  s_barrier
  ds_read_b64_tr_b16 v[16:17], v2 offset:0
  ds_read_b64_tr_b16 v[18:19], v2 offset:1024
  ds_read_b128 v[40:43], v128 offset:0
  ds_read_b128 v[44:47], v129 offset:0
  ds_read_b128 v[48:51], v130 offset:0
  ds_read_b128 v[52:55], v131 offset:0
  ds_read_b64_tr_b16 v[20:21], v2 offset:8192
  ds_read_b64_tr_b16 v[22:23], v2 offset:9216
  ds_read_b64_tr_b16 v[24:25], v2 offset:16384
  ds_read_b64_tr_b16 v[26:27], v2 offset:17408
  s_waitcnt lgkmcnt(0)
  v_mfma_f32_16x16x32_bf16 v[64:67], v[16:19], v[40:43], v[64:67]
  ds_read_b64_tr_b16 v[28:29], v2 offset:4096
  s_add_u32 m0, s32, 81920
  v_mfma_f32_16x16x32_bf16 v[68:71], v[16:19], v[44:47], v[68:71]
  ds_read_b64_tr_b16 v[30:31], v2 offset:5120
  buffer_load_dwordx4 v10, s[8:11], s30 offen lds
  v_mfma_f32_16x16x32_bf16 v[72:75], v[16:19], v[48:51], v[72:75]
  ds_read_b128 v[112:115], v132 offset:0
  s_add_u32 m0, s32, 90112
  v_mfma_f32_16x16x32_bf16 v[76:79], v[16:19], v[52:55], v[76:79]
  ds_read_b128 v[116:119], v133 offset:0
  buffer_load_dwordx4 v11, s[8:11], s30 offen lds
  v_mfma_f32_16x16x32_bf16 v[80:83], v[20:23], v[40:43], v[80:83]
  ds_read_b128 v[120:123], v134 offset:0
  s_add_u32 m0, s32, 98304
  v_mfma_f32_16x16x32_bf16 v[84:87], v[20:23], v[44:47], v[84:87]
  ds_read_b128 v[124:127], v135 offset:0
  buffer_load_dwordx4 v12, s[8:11], s30 offen lds
  v_mfma_f32_16x16x32_bf16 v[88:91], v[20:23], v[48:51], v[88:91]
  ds_read_b64_tr_b16 v[32:33], v2 offset:12288
  s_add_u32 m0, s33, 81920
  v_mfma_f32_16x16x32_bf16 v[92:95], v[20:23], v[52:55], v[92:95]
  ds_read_b64_tr_b16 v[34:35], v2 offset:13312
  buffer_load_dwordx4 v13, s[16:19], s31 offen lds
  v_mfma_f32_16x16x32_bf16 v[96:99], v[40:43], v[24:27], v[96:99]
  ds_read_b64_tr_b16 v[36:37], v2 offset:20480
  v_mfma_f32_16x16x32_bf16 v[100:103], v[44:47], v[24:27], v[100:103]
  ds_read_b64_tr_b16 v[38:39], v2 offset:21504
  buffer_load_dwordx4 v4, s[16:19], s31 offen offset:1024 lds
  v_mfma_f32_16x16x32_bf16 v[104:107], v[48:51], v[24:27], v[104:107]
  s_add_u32 s30, s30, 393216
  s_add_u32 s31, s31, 128
  s_cmp_eq_u32 s30, s46
  s_cselect_b32 s30, s48, s30
  s_cselect_b32 s31, s49, s31
  v_mfma_f32_16x16x32_bf16 v[108:111], v[52:55], v[24:27], v[108:111]
  v_mfma_f32_16x16x32_bf16 v[144:147], v[16:19], v[164:167], v[144:147]
  v_mfma_f32_16x16x32_bf16 v[148:151], v[20:23], v[164:167], v[148:151]
  v_mfma_f32_16x16x32_bf16 v[152:155], v[24:27], v[164:167], v[152:155]
  v_mfma_f32_16x16x32_bf16 v[156:159], v[164:167], v[40:43], v[156:159]
  v_mfma_f32_16x16x32_bf16 v[160:163], v[40:43], v[40:43], v[160:163]
  s_waitcnt vmcnt(5) lgkmcnt(0)
  s_barrier
  v_mfma_f32_16x16x32_bf16 v[64:67], v[28:31], v[112:115], v[64:67]
  ds_read_b64_tr_b16 v[16:17], v2 offset:40960
  s_add_u32 m0, s32, 122880
  v_mfma_f32_16x16x32_bf16 v[68:71], v[28:31], v[116:119], v[68:71]
  ds_read_b64_tr_b16 v[18:19], v2 offset:41984
  buffer_load_dwordx4 v10, s[8:11], s30 offen lds
  v_mfma_f32_16x16x32_bf16 v[72:75], v[28:31], v[120:123], v[72:75]
  ds_read_b128 v[40:43], v128 offset:40960
  s_add_u32 m0, s32, 131072
  v_mfma_f32_16x16x32_bf16 v[76:79], v[28:31], v[124:127], v[76:79]
  ds_read_b128 v[44:47], v129 offset:40960
  buffer_load_dwordx4 v11, s[8:11], s30 offen lds
  v_mfma_f32_16x16x32_bf16 v[80:83], v[32:35], v[112:115], v[80:83]
  ds_read_b128 v[48:51], v130 offset:40960
  s_add_u32 m0, s32, 139264
  v_mfma_f32_16x16x32_bf16 v[84:87], v[32:35], v[116:119], v[84:87]
  ds_read_b128 v[52:55], v131 offset:40960
  buffer_load_dwordx4 v12, s[8:11], s30 offen lds
  v_mfma_f32_16x16x32_bf16 v[88:91], v[32:35], v[120:123], v[88:91]
  ds_read_b64_tr_b16 v[20:21], v2 offset:49152
  s_add_u32 m0, s33, 122880
  v_mfma_f32_16x16x32_bf16 v[92:95], v[32:35], v[124:127], v[92:95]
  ds_read_b64_tr_b16 v[22:23], v2 offset:50176
  buffer_load_dwordx4 v13, s[16:19], s31 offen lds
  v_mfma_f32_16x16x32_bf16 v[96:99], v[112:115], v[36:39], v[96:99]
  ds_read_b64_tr_b16 v[24:25], v2 offset:57344
  v_mfma_f32_16x16x32_bf16 v[100:103], v[116:119], v[36:39], v[100:103]
  ds_read_b64_tr_b16 v[26:27], v2 offset:58368
  buffer_load_dwordx4 v4, s[16:19], s31 offen offset:1024 lds
  v_mfma_f32_16x16x32_bf16 v[104:107], v[120:123], v[36:39], v[104:107]
  s_add_u32 s30, s30, 393216
  s_add_u32 s31, s31, 128
  s_cmp_eq_u32 s30, s46
  s_cselect_b32 s30, s48, s30
  s_cselect_b32 s31, s49, s31
  v_mfma_f32_16x16x32_bf16 v[108:111], v[124:127], v[36:39], v[108:111]
  v_mfma_f32_16x16x32_bf16 v[144:147], v[28:31], v[164:167], v[144:147]
  v_mfma_f32_16x16x32_bf16 v[148:151], v[32:35], v[164:167], v[148:151]
  v_mfma_f32_16x16x32_bf16 v[152:155], v[36:39], v[164:167], v[152:155]
  v_mfma_f32_16x16x32_bf16 v[156:159], v[164:167], v[112:115], v[156:159]
  v_mfma_f32_16x16x32_bf16 v[160:163], v[112:115], v[112:115], v[160:163]
  s_waitcnt lgkmcnt(0)
  v_mfma_f32_16x16x32_bf16 v[64:67], v[16:19], v[40:43], v[64:67]
  ds_read_b64_tr_b16 v[28:29], v2 offset:45056
  s_add_u32 m0, s32, 0
  v_mfma_f32_16x16x32_bf16 v[68:71], v[16:19], v[44:47], v[68:71]
  ds_read_b64_tr_b16 v[30:31], v2 offset:46080
  buffer_load_dwordx4 v10, s[8:11], s30 offen lds
  v_mfma_f32_16x16x32_bf16 v[72:75], v[16:19], v[48:51], v[72:75]
  ds_read_b128 v[112:115], v132 offset:40960
  s_add_u32 m0, s32, 8192
  v_mfma_f32_16x16x32_bf16 v[76:79], v[16:19], v[52:55], v[76:79]
  ds_read_b128 v[116:119], v133 offset:40960
  buffer_load_dwordx4 v11, s[8:11], s30 offen lds
  v_mfma_f32_16x16x32_bf16 v[80:83], v[20:23], v[40:43], v[80:83]
  ds_read_b128 v[120:123], v134 offset:40960
  s_add_u32 m0, s32, 16384
  v_mfma_f32_16x16x32_bf16 v[84:87], v[20:23], v[44:47], v[84:87]
  ds_read_b128 v[124:127], v135 offset:40960
  buffer_load_dwordx4 v12, s[8:11], s30 offen lds
  v_mfma_f32_16x16x32_bf16 v[88:91], v[20:23], v[48:51], v[88:91]
  ds_read_b64_tr_b16 v[32:33], v2 offset:53248
  s_add_u32 m0, s33, 0
  v_mfma_f32_16x16x32_bf16 v[92:95], v[20:23], v[52:55], v[92:95]
  ds_read_b64_tr_b16 v[34:35], v2 offset:54272
  buffer_load_dwordx4 v13, s[16:19], s31 offen lds
  v_mfma_f32_16x16x32_bf16 v[96:99], v[40:43], v[24:27], v[96:99]
  ds_read_b64_tr_b16 v[36:37], v2 offset:61440
  v_mfma_f32_16x16x32_bf16 v[100:103], v[44:47], v[24:27], v[100:103]
  ds_read_b64_tr_b16 v[38:39], v2 offset:62464
  buffer_load_dwordx4 v4, s[16:19], s31 offen offset:1024 lds
  v_mfma_f32_16x16x32_bf16 v[104:107], v[48:51], v[24:27], v[104:107]
  s_add_u32 s30, s30, 393216
  s_add_u32 s31, s31, 128
  s_cmp_eq_u32 s30, s46
  s_cselect_b32 s30, s48, s30
  s_cselect_b32 s31, s49, s31
  v_mfma_f32_16x16x32_bf16 v[108:111], v[52:55], v[24:27], v[108:111]
  v_cndmask_b32 v160, v160, v161, s[50:51]
  v_cndmask_b32 v160, v160, v162, s[52:53]
  v_cndmask_b32 v160, v160, v163, s[54:55]
  v_mov_b32 v157, v160
  s_mov_b64 exec, s[56:57]
  buffer_store_dwordx2 v[156:157], v8, s[12:15], s42 offen sc1
  s_mov_b64 exec, s[58:59]
  buffer_store_dwordx4 v[144:147], v9, s[12:15], s43 offen offset:0 sc1
  buffer_store_dwordx4 v[148:151], v9, s[12:15], s43 offen offset:256 sc1
  buffer_store_dwordx4 v[152:155], v9, s[12:15], s43 offen offset:512 sc1
  s_mov_b64 exec, -1
  s_waitcnt vmcnt(10) lgkmcnt(0)
  s_barrier
  v_mfma_f32_16x16x32_bf16 v[64:67], v[28:31], v[112:115], v[64:67]
  ds_read_b64_tr_b16 v[16:17], v3 offset:0
  s_add_u32 m0, s32, 40960
  v_mfma_f32_16x16x32_bf16 v[68:71], v[28:31], v[116:119], v[68:71]
  ds_read_b64_tr_b16 v[18:19], v3 offset:1024
  buffer_load_dwordx4 v10, s[8:11], s30 offen lds
  v_mfma_f32_16x16x32_bf16 v[72:75], v[28:31], v[120:123], v[72:75]
  ds_read_b128 v[40:43], v136 offset:0
  s_add_u32 m0, s32, 49152
  v_mfma_f32_16x16x32_bf16 v[76:79], v[28:31], v[124:127], v[76:79]
  ds_read_b128 v[44:47], v137 offset:0
  buffer_load_dwordx4 v11, s[8:11], s30 offen lds
  v_mfma_f32_16x16x32_bf16 v[80:83], v[32:35], v[112:115], v[80:83]
  ds_read_b128 v[48:51], v138 offset:0
  s_add_u32 m0, s32, 57344
  v_mfma_f32_16x16x32_bf16 v[84:87], v[32:35], v[116:119], v[84:87]
  ds_read_b128 v[52:55], v139 offset:0
  buffer_load_dwordx4 v12, s[8:11], s30 offen lds
  v_mfma_f32_16x16x32_bf16 v[88:91], v[32:35], v[120:123], v[88:91]
  ds_read_b64_tr_b16 v[20:21], v3 offset:8192
  s_add_u32 m0, s33, 40960
  v_mfma_f32_16x16x32_bf16 v[92:95], v[32:35], v[124:127], v[92:95]
  ds_read_b64_tr_b16 v[22:23], v3 offset:9216
  buffer_load_dwordx4 v13, s[16:19], s31 offen lds
  v_mfma_f32_16x16x32_bf16 v[96:99], v[112:115], v[36:39], v[96:99]
  ds_read_b64_tr_b16 v[24:25], v3 offset:16384
  v_mfma_f32_16x16x32_bf16 v[100:103], v[116:119], v[36:39], v[100:103]
  ds_read_b64_tr_b16 v[26:27], v3 offset:17408
  buffer_load_dwordx4 v4, s[16:19], s31 offen offset:1024 lds
  v_mfma_f32_16x16x32_bf16 v[104:107], v[120:123], v[36:39], v[104:107]
  s_add_u32 s30, s30, 393216
  s_add_u32 s31, s31, 128
  s_cmp_eq_u32 s30, s46
  s_cselect_b32 s30, s48, s30
  s_cselect_b32 s31, s49, s31
  v_mfma_f32_16x16x32_bf16 v[108:111], v[124:127], v[36:39], v[108:111]
  s_waitcnt lgkmcnt(0)
  v_mfma_f32_16x16x32_bf16 v[64:67], v[16:19], v[40:43], v[64:67]
  ds_read_b64_tr_b16 v[28:29], v3 offset:4096
  v_mfma_f32_16x16x32_bf16 v[68:71], v[16:19], v[44:47], v[68:71]
  ds_read_b64_tr_b16 v[30:31], v3 offset:5120
  v_mfma_f32_16x16x32_bf16 v[72:75], v[16:19], v[48:51], v[72:75]
  ds_read_b128 v[112:115], v140 offset:0
  v_mfma_f32_16x16x32_bf16 v[76:79], v[16:19], v[52:55], v[76:79]
  ds_read_b128 v[116:119], v141 offset:0
  v_mfma_f32_16x16x32_bf16 v[80:83], v[20:23], v[40:43], v[80:83]
  ds_read_b128 v[120:123], v142 offset:0
  v_mfma_f32_16x16x32_bf16 v[84:87], v[20:23], v[44:47], v[84:87]
  ds_read_b128 v[124:127], v143 offset:0
  v_mfma_f32_16x16x32_bf16 v[88:91], v[20:23], v[48:51], v[88:91]
  ds_read_b64_tr_b16 v[32:33], v3 offset:12288
  v_mfma_f32_16x16x32_bf16 v[92:95], v[20:23], v[52:55], v[92:95]
  ds_read_b64_tr_b16 v[34:35], v3 offset:13312
  v_mfma_f32_16x16x32_bf16 v[96:99], v[40:43], v[24:27], v[96:99]
  ds_read_b64_tr_b16 v[36:37], v3 offset:20480
  v_mfma_f32_16x16x32_bf16 v[100:103], v[44:47], v[24:27], v[100:103]
  ds_read_b64_tr_b16 v[38:39], v3 offset:21504
  v_mfma_f32_16x16x32_bf16 v[104:107], v[48:51], v[24:27], v[104:107]
  v_mfma_f32_16x16x32_bf16 v[108:111], v[52:55], v[24:27], v[108:111]
  s_waitcnt vmcnt(10) lgkmcnt(0)
  s_barrier
  v_mfma_f32_16x16x32_bf16 v[64:67], v[28:31], v[112:115], v[64:67]
  ds_read_b64_tr_b16 v[16:17], v3 offset:40960
  s_add_u32 m0, s32, 81920
  v_mfma_f32_16x16x32_bf16 v[68:71], v[28:31], v[116:119], v[68:71]
  ds_read_b64_tr_b16 v[18:19], v3 offset:41984
  buffer_load_dwordx4 v10, s[8:11], s30 offen lds
  v_mfma_f32_16x16x32_bf16 v[72:75], v[28:31], v[120:123], v[72:75]
  ds_read_b128 v[40:43], v136 offset:40960
  s_add_u32 m0, s32, 90112
  v_mfma_f32_16x16x32_bf16 v[76:79], v[28:31], v[124:127], v[76:79]
  ds_read_b128 v[44:47], v137 offset:40960
  buffer_load_dwordx4 v11, s[8:11], s30 offen lds
  v_mfma_f32_16x16x32_bf16 v[80:83], v[32:35], v[112:115], v[80:83]
  ds_read_b128 v[48:51], v138 offset:40960
  s_add_u32 m0, s32, 98304
  v_mfma_f32_16x16x32_bf16 v[84:87], v[32:35], v[116:119], v[84:87]
  ds_read_b128 v[52:55], v139 offset:40960
  buffer_load_dwordx4 v12, s[8:11], s30 offen lds
  v_mfma_f32_16x16x32_bf16 v[88:91], v[32:35], v[120:123], v[88:91]
  ds_read_b64_tr_b16 v[20:21], v3 offset:49152
  s_add_u32 m0, s33, 81920
  v_mfma_f32_16x16x32_bf16 v[92:95], v[32:35], v[124:127], v[92:95]
  ds_read_b64_tr_b16 v[22:23], v3 offset:50176
  buffer_load_dwordx4 v13, s[16:19], s31 offen lds
  v_mfma_f32_16x16x32_bf16 v[96:99], v[112:115], v[36:39], v[96:99]
  ds_read_b64_tr_b16 v[24:25], v3 offset:57344
  v_mfma_f32_16x16x32_bf16 v[100:103], v[116:119], v[36:39], v[100:103]
  ds_read_b64_tr_b16 v[26:27], v3 offset:58368
  buffer_load_dwordx4 v4, s[16:19], s31 offen offset:1024 lds
  v_mfma_f32_16x16x32_bf16 v[104:107], v[120:123], v[36:39], v[104:107]
  s_add_u32 s30, s30, 393216
  s_add_u32 s31, s31, 128
  s_cmp_eq_u32 s30, s46
  s_cselect_b32 s30, s48, s30
  s_cselect_b32 s31, s49, s31
  v_mfma_f32_16x16x32_bf16 v[108:111], v[124:127], v[36:39], v[108:111]
  s_waitcnt lgkmcnt(0)
  v_mfma_f32_16x16x32_bf16 v[64:67], v[16:19], v[40:43], v[64:67]
  ds_read_b64_tr_b16 v[28:29], v3 offset:45056
  v_mfma_f32_16x16x32_bf16 v[68:71], v[16:19], v[44:47], v[68:71]
  ds_read_b64_tr_b16 v[30:31], v3 offset:46080
  v_mfma_f32_16x16x32_bf16 v[72:75], v[16:19], v[48:51], v[72:75]
  ds_read_b128 v[112:115], v140 offset:40960
  v_mfma_f32_16x16x32_bf16 v[76:79], v[16:19], v[52:55], v[76:79]
  ds_read_b128 v[116:119], v141 offset:40960
  v_mfma_f32_16x16x32_bf16 v[80:83], v[20:23], v[40:43], v[80:83]
  ds_read_b128 v[120:123], v142 offset:40960
  v_mfma_f32_16x16x32_bf16 v[84:87], v[20:23], v[44:47], v[84:87]
  ds_read_b128 v[124:127], v143 offset:40960
  v_mfma_f32_16x16x32_bf16 v[88:91], v[20:23], v[48:51], v[88:91]
  ds_read_b64_tr_b16 v[32:33], v3 offset:53248
  v_mfma_f32_16x16x32_bf16 v[92:95], v[20:23], v[52:55], v[92:95]
  ds_read_b64_tr_b16 v[34:35], v3 offset:54272
  v_mfma_f32_16x16x32_bf16 v[96:99], v[40:43], v[24:27], v[96:99]
  ds_read_b64_tr_b16 v[36:37], v3 offset:61440
  v_mfma_f32_16x16x32_bf16 v[100:103], v[44:47], v[24:27], v[100:103]
  ds_read_b64_tr_b16 v[38:39], v3 offset:62464
  v_mfma_f32_16x16x32_bf16 v[104:107], v[48:51], v[24:27], v[104:107]
  v_mfma_f32_16x16x32_bf16 v[108:111], v[52:55], v[24:27], v[108:111]
  s_waitcnt vmcnt(10) lgkmcnt(0)
  s_barrier
  v_mfma_f32_16x16x32_bf16 v[64:67], v[28:31], v[112:115], v[64:67]
  ds_read_b64_tr_b16 v[16:17], v2 offset:0
  s_add_u32 m0, s32, 122880
  v_mfma_f32_16x16x32_bf16 v[68:71], v[28:31], v[116:119], v[68:71]
  ds_read_b64_tr_b16 v[18:19], v2 offset:1024
  buffer_load_dwordx4 v10, s[8:11], s30 offen lds
  v_mfma_f32_16x16x32_bf16 v[72:75], v[28:31], v[120:123], v[72:75]
  ds_read_b128 v[40:43], v128 offset:0
  s_add_u32 m0, s32, 131072
  v_mfma_f32_16x16x32_bf16 v[76:79], v[28:31], v[124:127], v[76:79]
  ds_read_b128 v[44:47], v129 offset:0
  buffer_load_dwordx4 v11, s[8:11], s30 offen lds
  v_mfma_f32_16x16x32_bf16 v[80:83], v[32:35], v[112:115], v[80:83]
  ds_read_b128 v[48:51], v130 offset:0
  s_add_u32 m0, s32, 139264
  v_mfma_f32_16x16x32_bf16 v[84:87], v[32:35], v[116:119], v[84:87]
  ds_read_b128 v[52:55], v131 offset:0
  buffer_load_dwordx4 v12, s[8:11], s30 offen lds
  v_mfma_f32_16x16x32_bf16 v[88:91], v[32:35], v[120:123], v[88:91]
  ds_read_b64_tr_b16 v[20:21], v2 offset:8192
  s_add_u32 m0, s33, 122880
  v_mfma_f32_16x16x32_bf16 v[92:95], v[32:35], v[124:127], v[92:95]
  ds_read_b64_tr_b16 v[22:23], v2 offset:9216
  buffer_load_dwordx4 v13, s[16:19], s31 offen lds
  v_mfma_f32_16x16x32_bf16 v[96:99], v[112:115], v[36:39], v[96:99]
  ds_read_b64_tr_b16 v[24:25], v2 offset:16384
  v_mfma_f32_16x16x32_bf16 v[100:103], v[116:119], v[36:39], v[100:103]
  ds_read_b64_tr_b16 v[26:27], v2 offset:17408
  buffer_load_dwordx4 v4, s[16:19], s31 offen offset:1024 lds
  v_mfma_f32_16x16x32_bf16 v[104:107], v[120:123], v[36:39], v[104:107]
  s_add_u32 s30, s30, 393216
  s_add_u32 s31, s31, 128
  s_cmp_eq_u32 s30, s46
  s_cselect_b32 s30, s48, s30
  s_cselect_b32 s31, s49, s31
  v_mfma_f32_16x16x32_bf16 v[108:111], v[124:127], v[36:39], v[108:111]
  s_cmp_lg_u32 s20, 0
  s_cbranch_scc1 L_nosig1_3
  s_mov_b64 exec, 1
  v_mov_b32 v14, 1
  s_and_b32 s27, s2, 1
  s_lshl_b32 s27, s27, 7
  buffer_atomic_add v14, v6, s[60:63], s27 offen sc1
  s_mov_b64 exec, -1
L_nosig1_3:
  s_mov_b32 s34, 0
L_p1loop_4:
  s_waitcnt lgkmcnt(0)
  v_mfma_f32_16x16x32_bf16 v[64:67], v[16:19], v[40:43], v[64:67]
  ds_read_b64_tr_b16 v[28:29], v2 offset:4096
  v_mfma_f32_16x16x32_bf16 v[68:71], v[16:19], v[44:47], v[68:71]
  ds_read_b64_tr_b16 v[30:31], v2 offset:5120
  v_mfma_f32_16x16x32_bf16 v[72:75], v[16:19], v[48:51], v[72:75]
  ds_read_b128 v[112:115], v132 offset:0
  v_mfma_f32_16x16x32_bf16 v[76:79], v[16:19], v[52:55], v[76:79]
  ds_read_b128 v[116:119], v133 offset:0
  v_mfma_f32_16x16x32_bf16 v[80:83], v[20:23], v[40:43], v[80:83]
  ds_read_b128 v[120:123], v134 offset:0
  v_mfma_f32_16x16x32_bf16 v[84:87], v[20:23], v[44:47], v[84:87]
  ds_read_b128 v[124:127], v135 offset:0
  v_mfma_f32_16x16x32_bf16 v[88:91], v[20:23], v[48:51], v[88:91]
  ds_read_b64_tr_b16 v[32:33], v2 offset:12288
  v_mfma_f32_16x16x32_bf16 v[92:95], v[20:23], v[52:55], v[92:95]
  ds_read_b64_tr_b16 v[34:35], v2 offset:13312
  v_mfma_f32_16x16x32_bf16 v[96:99], v[40:43], v[24:27], v[96:99]
  ds_read_b64_tr_b16 v[36:37], v2 offset:20480
  v_mfma_f32_16x16x32_bf16 v[100:103], v[44:47], v[24:27], v[100:103]
  ds_read_b64_tr_b16 v[38:39], v2 offset:21504
  v_mfma_f32_16x16x32_bf16 v[104:107], v[48:51], v[24:27], v[104:107]
  v_mfma_f32_16x16x32_bf16 v[108:111], v[52:55], v[24:27], v[108:111]
  s_waitcnt vmcnt(10) lgkmcnt(0)
  s_barrier
  v_mfma_f32_16x16x32_bf16 v[64:67], v[28:31], v[112:115], v[64:67]
  ds_read_b64_tr_b16 v[16:17], v2 offset:40960
  s_add_u32 m0, s32, 0
  v_mfma_f32_16x16x32_bf16 v[68:71], v[28:31], v[116:119], v[68:71]
  ds_read_b64_tr_b16 v[18:19], v2 offset:41984
  buffer_load_dwordx4 v10, s[8:11], s30 offen lds
  v_mfma_f32_16x16x32_bf16 v[72:75], v[28:31], v[120:123], v[72:75]
  ds_read_b128 v[40:43], v128 offset:40960
  s_add_u32 m0, s32, 8192
  v_mfma_f32_16x16x32_bf16 v[76:79], v[28:31], v[124:127], v[76:79]
  ds_read_b128 v[44:47], v129 offset:40960
  buffer_load_dwordx4 v11, s[8:11], s30 offen lds
  v_mfma_f32_16x16x32_bf16 v[80:83], v[32:35], v[112:115], v[80:83]
  ds_read_b128 v[48:51], v130 offset:40960
  s_add_u32 m0, s32, 16384
  v_mfma_f32_16x16x32_bf16 v[84:87], v[32:35], v[116:119], v[84:87]
  ds_read_b128 v[52:55], v131 offset:40960
  buffer_load_dwordx4 v12, s[8:11], s30 offen lds
  v_mfma_f32_16x16x32_bf16 v[88:91], v[32:35], v[120:123], v[88:91]
  ds_read_b64_tr_b16 v[20:21], v2 offset:49152
  s_add_u32 m0, s33, 0
  v_mfma_f32_16x16x32_bf16 v[92:95], v[32:35], v[124:127], v[92:95]
  ds_read_b64_tr_b16 v[22:23], v2 offset:50176
  buffer_load_dwordx4 v13, s[16:19], s31 offen lds
  v_mfma_f32_16x16x32_bf16 v[96:99], v[112:115], v[36:39], v[96:99]
  ds_read_b64_tr_b16 v[24:25], v2 offset:57344
  v_mfma_f32_16x16x32_bf16 v[100:103], v[116:119], v[36:39], v[100:103]
  ds_read_b64_tr_b16 v[26:27], v2 offset:58368
  buffer_load_dwordx4 v4, s[16:19], s31 offen offset:1024 lds
  v_mfma_f32_16x16x32_bf16 v[104:107], v[120:123], v[36:39], v[104:107]
  s_add_u32 s30, s30, 393216
  s_add_u32 s31, s31, 128
  s_cmp_eq_u32 s30, s46
  s_cselect_b32 s30, s48, s30
  s_cselect_b32 s31, s49, s31
  v_mfma_f32_16x16x32_bf16 v[108:111], v[124:127], v[36:39], v[108:111]
  s_waitcnt lgkmcnt(0)
  v_mfma_f32_16x16x32_bf16 v[64:67], v[16:19], v[40:43], v[64:67]
  ds_read_b64_tr_b16 v[28:29], v2 offset:45056
  v_mfma_f32_16x16x32_bf16 v[68:71], v[16:19], v[44:47], v[68:71]
  ds_read_b64_tr_b16 v[30:31], v2 offset:46080
  v_mfma_f32_16x16x32_bf16 v[72:75], v[16:19], v[48:51], v[72:75]
  ds_read_b128 v[112:115], v132 offset:40960
  v_mfma_f32_16x16x32_bf16 v[76:79], v[16:19], v[52:55], v[76:79]
  ds_read_b128 v[116:119], v133 offset:40960
  v_mfma_f32_16x16x32_bf16 v[80:83], v[20:23], v[40:43], v[80:83]
  ds_read_b128 v[120:123], v134 offset:40960
  v_mfma_f32_16x16x32_bf16 v[84:87], v[20:23], v[44:47], v[84:87]
  ds_read_b128 v[124:127], v135 offset:40960
  v_mfma_f32_16x16x32_bf16 v[88:91], v[20:23], v[48:51], v[88:91]
  ds_read_b64_tr_b16 v[32:33], v2 offset:53248
  v_mfma_f32_16x16x32_bf16 v[92:95], v[20:23], v[52:55], v[92:95]
  ds_read_b64_tr_b16 v[34:35], v2 offset:54272
  v_mfma_f32_16x16x32_bf16 v[96:99], v[40:43], v[24:27], v[96:99]
  ds_read_b64_tr_b16 v[36:37], v2 offset:61440
  v_mfma_f32_16x16x32_bf16 v[100:103], v[44:47], v[24:27], v[100:103]
  ds_read_b64_tr_b16 v[38:39], v2 offset:62464
  v_mfma_f32_16x16x32_bf16 v[104:107], v[48:51], v[24:27], v[104:107]
  v_mfma_f32_16x16x32_bf16 v[108:111], v[52:55], v[24:27], v[108:111]
  s_waitcnt vmcnt(10) lgkmcnt(0)
  s_barrier
  v_mfma_f32_16x16x32_bf16 v[64:67], v[28:31], v[112:115], v[64:67]
  ds_read_b64_tr_b16 v[16:17], v3 offset:0
  s_add_u32 m0, s32, 40960
  v_mfma_f32_16x16x32_bf16 v[68:71], v[28:31], v[116:119], v[68:71]
  ds_read_b64_tr_b16 v[18:19], v3 offset:1024
  buffer_load_dwordx4 v10, s[8:11], s30 offen lds
  v_mfma_f32_16x16x32_bf16 v[72:75], v[28:31], v[120:123], v[72:75]
  ds_read_b128 v[40:43], v136 offset:0
  s_add_u32 m0, s32, 49152
  v_mfma_f32_16x16x32_bf16 v[76:79], v[28:31], v[124:127], v[76:79]
  ds_read_b128 v[44:47], v137 offset:0
  buffer_load_dwordx4 v11, s[8:11], s30 offen lds
  v_mfma_f32_16x16x32_bf16 v[80:83], v[32:35], v[112:115], v[80:83]
  ds_read_b128 v[48:51], v138 offset:0
  s_add_u32 m0, s32, 57344
  v_mfma_f32_16x16x32_bf16 v[84:87], v[32:35], v[116:119], v[84:87]
  ds_read_b128 v[52:55], v139 offset:0
  buffer_load_dwordx4 v12, s[8:11], s30 offen lds
  v_mfma_f32_16x16x32_bf16 v[88:91], v[32:35], v[120:123], v[88:91]
  ds_read_b64_tr_b16 v[20:21], v3 offset:8192
  s_add_u32 m0, s33, 40960
  v_mfma_f32_16x16x32_bf16 v[92:95], v[32:35], v[124:127], v[92:95]
  ds_read_b64_tr_b16 v[22:23], v3 offset:9216
  buffer_load_dwordx4 v13, s[16:19], s31 offen lds
  v_mfma_f32_16x16x32_bf16 v[96:99], v[112:115], v[36:39], v[96:99]
  ds_read_b64_tr_b16 v[24:25], v3 offset:16384
  v_mfma_f32_16x16x32_bf16 v[100:103], v[116:119], v[36:39], v[100:103]
  ds_read_b64_tr_b16 v[26:27], v3 offset:17408
  buffer_load_dwordx4 v4, s[16:19], s31 offen offset:1024 lds
  v_mfma_f32_16x16x32_bf16 v[104:107], v[120:123], v[36:39], v[104:107]
  s_add_u32 s30, s30, 393216
  s_add_u32 s31, s31, 128
  s_cmp_eq_u32 s30, s46
  s_cselect_b32 s30, s48, s30
  s_cselect_b32 s31, s49, s31
  v_mfma_f32_16x16x32_bf16 v[108:111], v[124:127], v[36:39], v[108:111]
  s_waitcnt lgkmcnt(0)
  v_mfma_f32_16x16x32_bf16 v[64:67], v[16:19], v[40:43], v[64:67]
  ds_read_b64_tr_b16 v[28:29], v3 offset:4096
  v_mfma_f32_16x16x32_bf16 v[68:71], v[16:19], v[44:47], v[68:71]
  ds_read_b64_tr_b16 v[30:31], v3 offset:5120
  v_mfma_f32_16x16x32_bf16 v[72:75], v[16:19], v[48:51], v[72:75]
  ds_read_b128 v[112:115], v140 offset:0
  v_mfma_f32_16x16x32_bf16 v[76:79], v[16:19], v[52:55], v[76:79]
  ds_read_b128 v[116:119], v141 offset:0
  v_mfma_f32_16x16x32_bf16 v[80:83], v[20:23], v[40:43], v[80:83]
  ds_read_b128 v[120:123], v142 offset:0
  v_mfma_f32_16x16x32_bf16 v[84:87], v[20:23], v[44:47], v[84:87]
  ds_read_b128 v[124:127], v143 offset:0
  v_mfma_f32_16x16x32_bf16 v[88:91], v[20:23], v[48:51], v[88:91]
  ds_read_b64_tr_b16 v[32:33], v3 offset:12288
  v_mfma_f32_16x16x32_bf16 v[92:95], v[20:23], v[52:55], v[92:95]
  ds_read_b64_tr_b16 v[34:35], v3 offset:13312
  v_mfma_f32_16x16x32_bf16 v[96:99], v[40:43], v[24:27], v[96:99]
  ds_read_b64_tr_b16 v[36:37], v3 offset:20480
  v_mfma_f32_16x16x32_bf16 v[100:103], v[44:47], v[24:27], v[100:103]
  ds_read_b64_tr_b16 v[38:39], v3 offset:21504
  v_mfma_f32_16x16x32_bf16 v[104:107], v[48:51], v[24:27], v[104:107]
  v_mfma_f32_16x16x32_bf16 v[108:111], v[52:55], v[24:27], v[108:111]
  s_waitcnt vmcnt(10) lgkmcnt(0)
  s_barrier
  v_mfma_f32_16x16x32_bf16 v[64:67], v[28:31], v[112:115], v[64:67]
  ds_read_b64_tr_b16 v[16:17], v3 offset:40960
  s_add_u32 m0, s32, 81920
  v_mfma_f32_16x16x32_bf16 v[68:71], v[28:31], v[116:119], v[68:71]
  ds_read_b64_tr_b16 v[18:19], v3 offset:41984
  buffer_load_dwordx4 v10, s[8:11], s30 offen lds
  v_mfma_f32_16x16x32_bf16 v[72:75], v[28:31], v[120:123], v[72:75]
  ds_read_b128 v[40:43], v136 offset:40960
  s_add_u32 m0, s32, 90112
  v_mfma_f32_16x16x32_bf16 v[76:79], v[28:31], v[124:127], v[76:79]
  ds_read_b128 v[44:47], v137 offset:40960
  buffer_load_dwordx4 v11, s[8:11], s30 offen lds
  v_mfma_f32_16x16x32_bf16 v[80:83], v[32:35], v[112:115], v[80:83]
  ds_read_b128 v[48:51], v138 offset:40960
  s_add_u32 m0, s32, 98304
  v_mfma_f32_16x16x32_bf16 v[84:87], v[32:35], v[116:119], v[84:87]
  ds_read_b128 v[52:55], v139 offset:40960
  buffer_load_dwordx4 v12, s[8:11], s30 offen lds
  v_mfma_f32_16x16x32_bf16 v[88:91], v[32:35], v[120:123], v[88:91]
  ds_read_b64_tr_b16 v[20:21], v3 offset:49152
  s_add_u32 m0, s33, 81920
  v_mfma_f32_16x16x32_bf16 v[92:95], v[32:35], v[124:127], v[92:95]
  ds_read_b64_tr_b16 v[22:23], v3 offset:50176
  buffer_load_dwordx4 v13, s[16:19], s31 offen lds
  v_mfma_f32_16x16x32_bf16 v[96:99], v[112:115], v[36:39], v[96:99]
  ds_read_b64_tr_b16 v[24:25], v3 offset:57344
  v_mfma_f32_16x16x32_bf16 v[100:103], v[116:119], v[36:39], v[100:103]
  ds_read_b64_tr_b16 v[26:27], v3 offset:58368
  buffer_load_dwordx4 v4, s[16:19], s31 offen offset:1024 lds
  v_mfma_f32_16x16x32_bf16 v[104:107], v[120:123], v[36:39], v[104:107]
  s_add_u32 s30, s30, 393216
  s_add_u32 s31, s31, 128
  s_cmp_eq_u32 s30, s46
  s_cselect_b32 s30, s48, s30
  s_cselect_b32 s31, s49, s31
  v_mfma_f32_16x16x32_bf16 v[108:111], v[124:127], v[36:39], v[108:111]
  s_waitcnt lgkmcnt(0)
  v_mfma_f32_16x16x32_bf16 v[64:67], v[16:19], v[40:43], v[64:67]
  ds_read_b64_tr_b16 v[28:29], v3 offset:45056
  v_mfma_f32_16x16x32_bf16 v[68:71], v[16:19], v[44:47], v[68:71]
  ds_read_b64_tr_b16 v[30:31], v3 offset:46080
  v_mfma_f32_16x16x32_bf16 v[72:75], v[16:19], v[48:51], v[72:75]
  ds_read_b128 v[112:115], v140 offset:40960
  v_mfma_f32_16x16x32_bf16 v[76:79], v[16:19], v[52:55], v[76:79]
  ds_read_b128 v[116:119], v141 offset:40960
  v_mfma_f32_16x16x32_bf16 v[80:83], v[20:23], v[40:43], v[80:83]
  ds_read_b128 v[120:123], v142 offset:40960
  v_mfma_f32_16x16x32_bf16 v[84:87], v[20:23], v[44:47], v[84:87]
  ds_read_b128 v[124:127], v143 offset:40960
  v_mfma_f32_16x16x32_bf16 v[88:91], v[20:23], v[48:51], v[88:91]
  ds_read_b64_tr_b16 v[32:33], v3 offset:53248
  v_mfma_f32_16x16x32_bf16 v[92:95], v[20:23], v[52:55], v[92:95]
  ds_read_b64_tr_b16 v[34:35], v3 offset:54272
  v_mfma_f32_16x16x32_bf16 v[96:99], v[40:43], v[24:27], v[96:99]
  ds_read_b64_tr_b16 v[36:37], v3 offset:61440
  v_mfma_f32_16x16x32_bf16 v[100:103], v[44:47], v[24:27], v[100:103]
  ds_read_b64_tr_b16 v[38:39], v3 offset:62464
  v_mfma_f32_16x16x32_bf16 v[104:107], v[48:51], v[24:27], v[104:107]
  v_mfma_f32_16x16x32_bf16 v[108:111], v[52:55], v[24:27], v[108:111]
  s_waitcnt vmcnt(10) lgkmcnt(0)
  s_barrier
  v_mfma_f32_16x16x32_bf16 v[64:67], v[28:31], v[112:115], v[64:67]
  ds_read_b64_tr_b16 v[16:17], v2 offset:0
  s_add_u32 m0, s32, 122880
  v_mfma_f32_16x16x32_bf16 v[68:71], v[28:31], v[116:119], v[68:71]
  ds_read_b64_tr_b16 v[18:19], v2 offset:1024
  buffer_load_dwordx4 v10, s[8:11], s30 offen lds
  v_mfma_f32_16x16x32_bf16 v[72:75], v[28:31], v[120:123], v[72:75]
  ds_read_b128 v[40:43], v128 offset:0
  s_add_u32 m0, s32, 131072
  v_mfma_f32_16x16x32_bf16 v[76:79], v[28:31], v[124:127], v[76:79]
  ds_read_b128 v[44:47], v129 offset:0
  buffer_load_dwordx4 v11, s[8:11], s30 offen lds
  v_mfma_f32_16x16x32_bf16 v[80:83], v[32:35], v[112:115], v[80:83]
  ds_read_b128 v[48:51], v130 offset:0
  s_add_u32 m0, s32, 139264
  v_mfma_f32_16x16x32_bf16 v[84:87], v[32:35], v[116:119], v[84:87]
  ds_read_b128 v[52:55], v131 offset:0
  buffer_load_dwordx4 v12, s[8:11], s30 offen lds
  v_mfma_f32_16x16x32_bf16 v[88:91], v[32:35], v[120:123], v[88:91]
  ds_read_b64_tr_b16 v[20:21], v2 offset:8192
  s_add_u32 m0, s33, 122880
  v_mfma_f32_16x16x32_bf16 v[92:95], v[32:35], v[124:127], v[92:95]
  ds_read_b64_tr_b16 v[22:23], v2 offset:9216
  buffer_load_dwordx4 v13, s[16:19], s31 offen lds
  v_mfma_f32_16x16x32_bf16 v[96:99], v[112:115], v[36:39], v[96:99]
  ds_read_b64_tr_b16 v[24:25], v2 offset:16384
  v_mfma_f32_16x16x32_bf16 v[100:103], v[116:119], v[36:39], v[100:103]
  ds_read_b64_tr_b16 v[26:27], v2 offset:17408
  buffer_load_dwordx4 v4, s[16:19], s31 offen offset:1024 lds
  v_mfma_f32_16x16x32_bf16 v[104:107], v[120:123], v[36:39], v[104:107]
  s_add_u32 s30, s30, 393216
  s_add_u32 s31, s31, 128
  s_cmp_eq_u32 s30, s46
  s_cselect_b32 s30, s48, s30
  s_cselect_b32 s31, s49, s31
  v_mfma_f32_16x16x32_bf16 v[108:111], v[124:127], v[36:39], v[108:111]
  s_add_u32 s34, s34, 1
  s_cmp_lt_u32 s34, 2
  s_cbranch_scc1 L_p1loop_4
  s_waitcnt lgkmcnt(0)
  v_mfma_f32_16x16x32_bf16 v[64:67], v[16:19], v[40:43], v[64:67]
  ds_read_b64_tr_b16 v[28:29], v2 offset:4096
  v_mfma_f32_16x16x32_bf16 v[68:71], v[16:19], v[44:47], v[68:71]
  ds_read_b64_tr_b16 v[30:31], v2 offset:5120
  v_mfma_f32_16x16x32_bf16 v[72:75], v[16:19], v[48:51], v[72:75]
  ds_read_b128 v[112:115], v132 offset:0
  v_mfma_f32_16x16x32_bf16 v[76:79], v[16:19], v[52:55], v[76:79]
  ds_read_b128 v[116:119], v133 offset:0
  v_mfma_f32_16x16x32_bf16 v[80:83], v[20:23], v[40:43], v[80:83]
  ds_read_b128 v[120:123], v134 offset:0
  v_mfma_f32_16x16x32_bf16 v[84:87], v[20:23], v[44:47], v[84:87]
  ds_read_b128 v[124:127], v135 offset:0
  v_mfma_f32_16x16x32_bf16 v[88:91], v[20:23], v[48:51], v[88:91]
  ds_read_b64_tr_b16 v[32:33], v2 offset:12288
  v_mfma_f32_16x16x32_bf16 v[92:95], v[20:23], v[52:55], v[92:95]
  ds_read_b64_tr_b16 v[34:35], v2 offset:13312
  v_mfma_f32_16x16x32_bf16 v[96:99], v[40:43], v[24:27], v[96:99]
  ds_read_b64_tr_b16 v[36:37], v2 offset:20480
  v_mfma_f32_16x16x32_bf16 v[100:103], v[44:47], v[24:27], v[100:103]
  ds_read_b64_tr_b16 v[38:39], v2 offset:21504
  v_mfma_f32_16x16x32_bf16 v[104:107], v[48:51], v[24:27], v[104:107]
  v_mfma_f32_16x16x32_bf16 v[108:111], v[52:55], v[24:27], v[108:111]
  buffer_load_dword v7, v196, s[60:63], 0 offen sc1
  s_lshl_b32 s27, s2, 13
  buffer_load_dwordx4 v[192:195], v197, s[88:91], s27 offen
  s_waitcnt vmcnt(12) lgkmcnt(0)
  s_barrier
  v_mfma_f32_16x16x32_bf16 v[64:67], v[28:31], v[112:115], v[64:67]
  ds_read_b64_tr_b16 v[16:17], v2 offset:40960
  v_mfma_f32_16x16x32_bf16 v[68:71], v[28:31], v[116:119], v[68:71]
  ds_read_b64_tr_b16 v[18:19], v2 offset:41984
  v_mfma_f32_16x16x32_bf16 v[72:75], v[28:31], v[120:123], v[72:75]
  ds_read_b128 v[40:43], v128 offset:40960
  v_mfma_f32_16x16x32_bf16 v[76:79], v[28:31], v[124:127], v[76:79]
  ds_read_b128 v[44:47], v129 offset:40960
  v_mfma_f32_16x16x32_bf16 v[80:83], v[32:35], v[112:115], v[80:83]
  ds_read_b128 v[48:51], v130 offset:40960
  v_mfma_f32_16x16x32_bf16 v[84:87], v[32:35], v[116:119], v[84:87]
  ds_read_b128 v[52:55], v131 offset:40960
  v_mfma_f32_16x16x32_bf16 v[88:91], v[32:35], v[120:123], v[88:91]
  ds_read_b64_tr_b16 v[20:21], v2 offset:49152
  v_mfma_f32_16x16x32_bf16 v[92:95], v[32:35], v[124:127], v[92:95]
  ds_read_b64_tr_b16 v[22:23], v2 offset:50176
  v_mfma_f32_16x16x32_bf16 v[96:99], v[112:115], v[36:39], v[96:99]
  ds_read_b64_tr_b16 v[24:25], v2 offset:57344
  v_mfma_f32_16x16x32_bf16 v[100:103], v[116:119], v[36:39], v[100:103]
  ds_read_b64_tr_b16 v[26:27], v2 offset:58368
  v_mfma_f32_16x16x32_bf16 v[104:107], v[120:123], v[36:39], v[104:107]
  v_mfma_f32_16x16x32_bf16 v[108:111], v[124:127], v[36:39], v[108:111]
  s_waitcnt lgkmcnt(0)
  v_mfma_f32_16x16x32_bf16 v[64:67], v[16:19], v[40:43], v[64:67]
  ds_read_b64_tr_b16 v[28:29], v2 offset:45056
  v_mfma_f32_16x16x32_bf16 v[68:71], v[16:19], v[44:47], v[68:71]
  ds_read_b64_tr_b16 v[30:31], v2 offset:46080
  v_mfma_f32_16x16x32_bf16 v[72:75], v[16:19], v[48:51], v[72:75]
  ds_read_b128 v[112:115], v132 offset:40960
  v_mfma_f32_16x16x32_bf16 v[76:79], v[16:19], v[52:55], v[76:79]
  ds_read_b128 v[116:119], v133 offset:40960
  v_mfma_f32_16x16x32_bf16 v[80:83], v[20:23], v[40:43], v[80:83]
  ds_read_b128 v[120:123], v134 offset:40960
  v_mfma_f32_16x16x32_bf16 v[84:87], v[20:23], v[44:47], v[84:87]
  ds_read_b128 v[124:127], v135 offset:40960
  v_mfma_f32_16x16x32_bf16 v[88:91], v[20:23], v[48:51], v[88:91]
  ds_read_b64_tr_b16 v[32:33], v2 offset:53248
  v_mfma_f32_16x16x32_bf16 v[92:95], v[20:23], v[52:55], v[92:95]
  ds_read_b64_tr_b16 v[34:35], v2 offset:54272
  v_mfma_f32_16x16x32_bf16 v[96:99], v[40:43], v[24:27], v[96:99]
  ds_read_b64_tr_b16 v[36:37], v2 offset:61440
  v_mfma_f32_16x16x32_bf16 v[100:103], v[44:47], v[24:27], v[100:103]
  ds_read_b64_tr_b16 v[38:39], v2 offset:62464
  v_mfma_f32_16x16x32_bf16 v[104:107], v[48:51], v[24:27], v[104:107]
  v_mfma_f32_16x16x32_bf16 v[108:111], v[52:55], v[24:27], v[108:111]
  s_waitcnt vmcnt(7) lgkmcnt(0)
  s_barrier
  v_mfma_f32_16x16x32_bf16 v[64:67], v[28:31], v[112:115], v[64:67]
  ds_read_b64_tr_b16 v[16:17], v3 offset:0
  v_mfma_f32_16x16x32_bf16 v[68:71], v[28:31], v[116:119], v[68:71]
  ds_read_b64_tr_b16 v[18:19], v3 offset:1024
  v_mfma_f32_16x16x32_bf16 v[72:75], v[28:31], v[120:123], v[72:75]
  ds_read_b128 v[40:43], v136 offset:0
  v_mfma_f32_16x16x32_bf16 v[76:79], v[28:31], v[124:127], v[76:79]
  ds_read_b128 v[44:47], v137 offset:0
  v_mfma_f32_16x16x32_bf16 v[80:83], v[32:35], v[112:115], v[80:83]
  ds_read_b128 v[48:51], v138 offset:0
  v_mfma_f32_16x16x32_bf16 v[84:87], v[32:35], v[116:119], v[84:87]
  ds_read_b128 v[52:55], v139 offset:0
  v_mfma_f32_16x16x32_bf16 v[88:91], v[32:35], v[120:123], v[88:91]
  ds_read_b64_tr_b16 v[20:21], v3 offset:8192
  v_mfma_f32_16x16x32_bf16 v[92:95], v[32:35], v[124:127], v[92:95]
  ds_read_b64_tr_b16 v[22:23], v3 offset:9216
  v_mfma_f32_16x16x32_bf16 v[96:99], v[112:115], v[36:39], v[96:99]
  ds_read_b64_tr_b16 v[24:25], v3 offset:16384
  v_mfma_f32_16x16x32_bf16 v[100:103], v[116:119], v[36:39], v[100:103]
  ds_read_b64_tr_b16 v[26:27], v3 offset:17408
  v_mfma_f32_16x16x32_bf16 v[104:107], v[120:123], v[36:39], v[104:107]
  v_mfma_f32_16x16x32_bf16 v[108:111], v[124:127], v[36:39], v[108:111]
  s_waitcnt lgkmcnt(0)
  v_mfma_f32_16x16x32_bf16 v[64:67], v[16:19], v[40:43], v[64:67]
  ds_read_b64_tr_b16 v[28:29], v3 offset:4096
  v_mfma_f32_16x16x32_bf16 v[68:71], v[16:19], v[44:47], v[68:71]
  ds_read_b64_tr_b16 v[30:31], v3 offset:5120
  v_mfma_f32_16x16x32_bf16 v[72:75], v[16:19], v[48:51], v[72:75]
  ds_read_b128 v[112:115], v140 offset:0
  v_mfma_f32_16x16x32_bf16 v[76:79], v[16:19], v[52:55], v[76:79]
  ds_read_b128 v[116:119], v141 offset:0
  v_mfma_f32_16x16x32_bf16 v[80:83], v[20:23], v[40:43], v[80:83]
  ds_read_b128 v[120:123], v142 offset:0
  v_mfma_f32_16x16x32_bf16 v[84:87], v[20:23], v[44:47], v[84:87]
  ds_read_b128 v[124:127], v143 offset:0
  v_mfma_f32_16x16x32_bf16 v[88:91], v[20:23], v[48:51], v[88:91]
  ds_read_b64_tr_b16 v[32:33], v3 offset:12288
  v_mfma_f32_16x16x32_bf16 v[92:95], v[20:23], v[52:55], v[92:95]
  ds_read_b64_tr_b16 v[34:35], v3 offset:13312
  v_mfma_f32_16x16x32_bf16 v[96:99], v[40:43], v[24:27], v[96:99]
  ds_read_b64_tr_b16 v[36:37], v3 offset:20480
  v_mfma_f32_16x16x32_bf16 v[100:103], v[44:47], v[24:27], v[100:103]
  ds_read_b64_tr_b16 v[38:39], v3 offset:21504
  v_mfma_f32_16x16x32_bf16 v[104:107], v[48:51], v[24:27], v[104:107]
  v_mfma_f32_16x16x32_bf16 v[108:111], v[52:55], v[24:27], v[108:111]
  s_waitcnt vmcnt(0) lgkmcnt(0)
  s_barrier
  v_cmp_eq_u32 vcc, 128, v7
  s_cmp_eq_u64 vcc, -1
  s_cbranch_scc1 L_p1rdy_5
  s_mov_b32 s28, 0
L_p1spin_6:
  s_add_u32 s28, s28, 1
  s_cmp_gt_u32 s28, 262144
  s_cbranch_scc1 L_p1rdy_5
  s_sleep 2
  buffer_load_dword v7, v196, s[60:63], 0 offen sc1
  s_waitcnt vmcnt(0)
  v_cmp_eq_u32 vcc, 128, v7
  s_cmp_eq_u64 vcc, -1
  s_cbranch_scc0 L_p1spin_6
L_p1rdy_5:
  v_lshrrev_b32 v14, 4, v1
  v_lshlrev_b32 v14, 16, v14
  v_and_b32 v15, 15, v1
  s_lshl_b32 s27, s20, 4
  v_add_u32 v15, s27, v15
  v_lshl_add_u32 v14, v15, 3, v14
  s_lshl_b32 s27, s23, 10
  s_add_u32 s27, s27, 41156608
  buffer_load_dwordx2 v[168:169], v14, s[12:15], s27 offen sc1
  s_add_u32 s27, s27, 16384
  buffer_load_dwordx2 v[170:171], v14, s[12:15], s27 offen sc1
  s_add_u32 s27, s27, 16384
  buffer_load_dwordx2 v[172:173], v14, s[12:15], s27 offen sc1
  s_add_u32 s27, s27, 16384
  buffer_load_dwordx2 v[174:175], v14, s[12:15], s27 offen sc1
  s_cmp_ge_u32 s20, 3
  s_cbranch_scc1 L_p1nocs_7
  v_lshlrev_b32 v14, 2, v0
  s_mul_i32 s27, s24, 12288
  s_add_u32 s27, s27, 41418752
  buffer_load_dword v176, v14, s[12:15], s27 offen offset:0 sc1
  buffer_load_dword v177, v14, s[12:15], s27 offen offset:768 sc1
  buffer_load_dword v178, v14, s[12:15], s27 offen offset:1536 sc1
  buffer_load_dword v179, v14, s[12:15], s27 offen offset:2304 sc1
  s_add_u32 s27, s27, 3072
  buffer_load_dword v180, v14, s[12:15], s27 offen offset:0 sc1
  buffer_load_dword v181, v14, s[12:15], s27 offen offset:768 sc1
  buffer_load_dword v182, v14, s[12:15], s27 offen offset:1536 sc1
  buffer_load_dword v183, v14, s[12:15], s27 offen offset:2304 sc1
  s_add_u32 s27, s27, 3072
  buffer_load_dword v184, v14, s[12:15], s27 offen offset:0 sc1
  buffer_load_dword v185, v14, s[12:15], s27 offen offset:768 sc1
  buffer_load_dword v186, v14, s[12:15], s27 offen offset:1536 sc1
  buffer_load_dword v187, v14, s[12:15], s27 offen offset:2304 sc1
  s_add_u32 s27, s27, 3072
  buffer_load_dword v188, v14, s[12:15], s27 offen offset:0 sc1
  buffer_load_dword v189, v14, s[12:15], s27 offen offset:768 sc1
  buffer_load_dword v190, v14, s[12:15], s27 offen offset:1536 sc1
  buffer_load_dword v191, v14, s[12:15], s27 offen offset:2304 sc1
L_p1nocs_7:
  v_mfma_f32_16x16x32_bf16 v[64:67], v[28:31], v[112:115], v[64:67]
  ds_read_b64_tr_b16 v[16:17], v3 offset:40960
  v_mfma_f32_16x16x32_bf16 v[68:71], v[28:31], v[116:119], v[68:71]
  ds_read_b64_tr_b16 v[18:19], v3 offset:41984
  v_mfma_f32_16x16x32_bf16 v[72:75], v[28:31], v[120:123], v[72:75]
  ds_read_b128 v[40:43], v136 offset:40960
  v_mfma_f32_16x16x32_bf16 v[76:79], v[28:31], v[124:127], v[76:79]
  ds_read_b128 v[44:47], v137 offset:40960
  v_mfma_f32_16x16x32_bf16 v[80:83], v[32:35], v[112:115], v[80:83]
  ds_read_b128 v[48:51], v138 offset:40960
  v_mfma_f32_16x16x32_bf16 v[84:87], v[32:35], v[116:119], v[84:87]
  ds_read_b128 v[52:55], v139 offset:40960
  v_mfma_f32_16x16x32_bf16 v[88:91], v[32:35], v[120:123], v[88:91]
  ds_read_b64_tr_b16 v[20:21], v3 offset:49152
  v_mfma_f32_16x16x32_bf16 v[92:95], v[32:35], v[124:127], v[92:95]
  ds_read_b64_tr_b16 v[22:23], v3 offset:50176
  v_mfma_f32_16x16x32_bf16 v[96:99], v[112:115], v[36:39], v[96:99]
  ds_read_b64_tr_b16 v[24:25], v3 offset:57344
  v_mfma_f32_16x16x32_bf16 v[100:103], v[116:119], v[36:39], v[100:103]
  ds_read_b64_tr_b16 v[26:27], v3 offset:58368
  v_mfma_f32_16x16x32_bf16 v[104:107], v[120:123], v[36:39], v[104:107]
  v_mfma_f32_16x16x32_bf16 v[108:111], v[124:127], v[36:39], v[108:111]
  s_waitcnt lgkmcnt(0)
  v_mfma_f32_16x16x32_bf16 v[64:67], v[16:19], v[40:43], v[64:67]
  ds_read_b64_tr_b16 v[28:29], v3 offset:45056
  v_mfma_f32_16x16x32_bf16 v[68:71], v[16:19], v[44:47], v[68:71]
  ds_read_b64_tr_b16 v[30:31], v3 offset:46080
  v_mfma_f32_16x16x32_bf16 v[72:75], v[16:19], v[48:51], v[72:75]
  ds_read_b128 v[112:115], v140 offset:40960
  v_mfma_f32_16x16x32_bf16 v[76:79], v[16:19], v[52:55], v[76:79]
  ds_read_b128 v[116:119], v141 offset:40960
  v_mfma_f32_16x16x32_bf16 v[80:83], v[20:23], v[40:43], v[80:83]
  ds_read_b128 v[120:123], v142 offset:40960
  v_mfma_f32_16x16x32_bf16 v[84:87], v[20:23], v[44:47], v[84:87]
  ds_read_b128 v[124:127], v143 offset:40960
  v_mfma_f32_16x16x32_bf16 v[88:91], v[20:23], v[48:51], v[88:91]
  ds_read_b64_tr_b16 v[32:33], v3 offset:53248
  v_mfma_f32_16x16x32_bf16 v[92:95], v[20:23], v[52:55], v[92:95]
  ds_read_b64_tr_b16 v[34:35], v3 offset:54272
  v_mfma_f32_16x16x32_bf16 v[96:99], v[40:43], v[24:27], v[96:99]
  ds_read_b64_tr_b16 v[36:37], v3 offset:61440
  v_mfma_f32_16x16x32_bf16 v[100:103], v[44:47], v[24:27], v[100:103]
  ds_read_b64_tr_b16 v[38:39], v3 offset:62464
  v_mfma_f32_16x16x32_bf16 v[104:107], v[48:51], v[24:27], v[104:107]
  v_mfma_f32_16x16x32_bf16 v[108:111], v[52:55], v[24:27], v[108:111]
  s_waitcnt lgkmcnt(0)
  v_mfma_f32_16x16x32_bf16 v[64:67], v[28:31], v[112:115], v[64:67]
  v_mfma_f32_16x16x32_bf16 v[68:71], v[28:31], v[116:119], v[68:71]
  v_mfma_f32_16x16x32_bf16 v[72:75], v[28:31], v[120:123], v[72:75]
  v_mfma_f32_16x16x32_bf16 v[76:79], v[28:31], v[124:127], v[76:79]
  v_mfma_f32_16x16x32_bf16 v[80:83], v[32:35], v[112:115], v[80:83]
  v_mfma_f32_16x16x32_bf16 v[84:87], v[32:35], v[116:119], v[84:87]
  v_mfma_f32_16x16x32_bf16 v[88:91], v[32:35], v[120:123], v[88:91]
  v_mfma_f32_16x16x32_bf16 v[92:95], v[32:35], v[124:127], v[92:95]
  v_mfma_f32_16x16x32_bf16 v[96:99], v[112:115], v[36:39], v[96:99]
  v_mfma_f32_16x16x32_bf16 v[100:103], v[116:119], v[36:39], v[100:103]
  v_mfma_f32_16x16x32_bf16 v[104:107], v[120:123], v[36:39], v[104:107]
  v_mfma_f32_16x16x32_bf16 v[108:111], v[124:127], v[36:39], v[108:111]
  v_mov_b32 v14, 0
  v_dot2c_f32_bf16 v14, v192, v164
  v_dot2c_f32_bf16 v14, v193, v164
  v_dot2c_f32_bf16 v14, v194, v164
  v_dot2c_f32_bf16 v14, v195, v164
  s_nop 2
  v_add_f32_dpp v14, v14, v14 row_ror:8 row_mask:0xf bank_mask:0xf
  s_nop 1
  v_add_f32_dpp v14, v14, v14 row_ror:4 row_mask:0xf bank_mask:0xf
  s_nop 1
  v_add_f32_dpp v14, v14, v14 row_ror:2 row_mask:0xf bank_mask:0xf
  s_nop 1
  v_add_f32_dpp v14, v14, v14 row_ror:1 row_mask:0xf bank_mask:0xf
  v_mov_b32 v15, v14
  s_nop 1
  v_permlane16_swap_b32 v14, v15
  v_add_f32 v14, v14, v15
  v_mov_b32 v15, v14
  s_nop 1
  v_permlane32_swap_b32 v14, v15
  v_add_f32 v14, v14, v15
  s_lshl_b32 s27, s20, 2
  s_add_u32 s27, s27, 2048
  v_mov_b32 v15, s27
  ds_write_b32 v15, v14
  s_waitcnt vmcnt(0)
  v_add_f32 v168, v168, v170
  v_add_f32 v169, v169, v171
  v_add_f32 v172, v172, v174
  v_add_f32 v173, v173, v175
  v_add_f32 v168, v168, v172
  v_add_f32 v169, v169, v173
  v_and_b32 v16, 15, v1
  s_lshl_b32 s27, s20, 4
  v_add_u32 v16, s27, v16
  v_lshlrev_b32 v16, 2, v16
  v_permlane16_swap_b32 v168, v169
  v_add_f32 v168, v168, v169
  v_mov_b32 v169, v168
  s_nop 1
  v_permlane32_swap_b32 v168, v169
  v_add_f32 v168, v168, v169
  v_mov_b32 v169, v168
  s_nop 1
  v_permlane16_swap_b32 v168, v169
  v_mul_f32 v168, 0x3a800000, v168
  v_mul_f32 v169, 0x3a800000, v169
  s_cmp_lg_u32 s24, 0
  s_cbranch_scc1 L_nomx_8
  s_lshl_b32 s27, s23, 9
  s_add_u32 s27, s27, 41811968
  buffer_store_dword v168, v16, s[12:15], s27 offen sc1
L_nomx_8:
  v_fma_f32 v169, -v168, v168, v169
  v_max_f32 v169, 0, v169
  v_add_f32 v169, 0x3727c5ac, v169
  v_rsq_f32 v169, v169
  s_nop 0
  v_mul_f32 v170, v168, v169
  v_sub_f32 v170, 0, v170
  ds_write_b32 v16, v169
  ds_write_b32 v16, v170 offset:512
  s_cmp_ge_u32 s20, 3
  s_cbranch_scc1 L_nocs2_9
  v_add_f32 v176, v176, v184
  v_add_f32 v177, v177, v185
  v_add_f32 v178, v178, v186
  v_add_f32 v179, v179, v187
  v_add_f32 v180, v180, v188
  v_add_f32 v181, v181, v189
  v_add_f32 v182, v182, v190
  v_add_f32 v183, v183, v191
  v_add_f32 v176, v176, v180
  v_add_f32 v177, v177, v181
  v_add_f32 v178, v178, v182
  v_add_f32 v179, v179, v183
  v_add_f32 v176, v176, v178
  v_add_f32 v177, v177, v179
  v_add_f32 v176, v176, v177
  v_lshlrev_b32 v16, 2, v0
  ds_write_b32 v16, v176 offset:1024
L_nocs2_9:
  v_and_b32 v15, 15, v1
  s_lshl_b32 s27, s25, 8
  s_lshl_b32 s28, s26, 6
  s_add_u32 s28, s28, s27
  v_lshlrev_b32 v16, 2, v15
  v_add_u32 v17, s28, v16
  v_lshrrev_b32 v14, 4, v1
  v_lshlrev_b32 v19, 4, v14
  v_add_u32 v20, s28, v19
  s_lshl_b32 s29, s26, 6
  s_add_u32 s29, s29, 1024
  v_add_u32 v19, s29, v19
  v_add_u32 v18, s29, v16
  v_xor_b32 v21, 64, v20
  v_xor_b32 v24, 64, v17
  v_xor_b32 v22, 128, v20
  v_xor_b32 v25, 128, v17
  v_xor_b32 v23, 192, v20
  v_xor_b32 v26, 192, v17
  s_lshl_b32 s27, s23, 2
  s_lshl_b32 s28, s25, 1
  s_add_u32 s27, s27, s28
  s_lshl_b32 s27, s27, 16
  s_lshl_b32 s28, s24, 12
  s_add_u32 s27, s27, s28
  s_lshl_b32 s28, s26, 10
  s_add_u32 s27, s27, s28
  s_lshr_b32 s42, s26, 1
  s_lshl_b32 s28, s42, 16
  s_add_u32 s35, s27, s28
  s_xor_b32 s28, s28, 0x10000
  s_add_u32 s37, s27, s28
  s_add_u32 s36, s35, 8388608
  s_add_u32 s38, s37, 8388608
  s_add_u32 s35, s35, 4194304
  s_add_u32 s37, s37, 4194304
  s_lshl_b32 s27, s24, 1
  s_add_u32 s27, s27, s42
  s_lshl_b32 s27, s27, 7
  s_lshl_b32 s28, s23, 3
  s_add_u32 s27, s27, s28
  s_lshl_b32 s28, s25, 2
  s_add_u32 s27, s27, s28
  s_lshl_b32 s27, s27, 10
  s_and_b32 s43, s26, 1
  s_lshl_b32 s28, s43, 8
  s_add_u32 s27, s27, s28
  s_add_u32 s27, s27, 12582912
  s_lshl_b32 s28, s42, 11
  s_add_u32 s39, s27, s28
  s_xor_b32 s28, s28, 2048
  s_add_u32 s40, s27, s28
  v_lshrrev_b32 v27, 5, v1
  v_xor_b32 v27, s43, v27
  v_lshlrev_b32 v27, 10, v27
  v_bfe_u32 v28, v1, 4, 1
  v_lshl_add_u32 v27, v28, 9, v27
  v_lshl_add_u32 v14, v15, 4, v27
  s_lshl_b32 s28, s43, 8
  v_xor_b32 v5, s28, v5
  s_waitcnt lgkmcnt(0)
  s_barrier
  ds_read2_b32 v[28:29], v17 offset0:0 offset1:128
  ds_read2_b32 v[30:31], v24 offset0:0 offset1:128
  ds_read2_b32 v[32:33], v25 offset0:0 offset1:128
  ds_read2_b32 v[34:35], v26 offset0:0 offset1:128
  ds_read_b128 v[36:39], v19
  ds_read_b128 v[40:43], v19 offset:256
  ds_read_b32 v152, v18 offset:512
  ds_read_b128 v[112:115], v20
  ds_read_b128 v[116:119], v20 offset:512
  ds_read_b128 v[120:123], v21
  ds_read_b128 v[124:127], v21 offset:512
  ds_read_b128 v[128:131], v22
  ds_read_b128 v[132:135], v22 offset:512
  ds_read_b128 v[136:139], v23
  ds_read_b128 v[140:143], v23 offset:512
  s_cmp_lg_u32 s20, 7
  s_cbranch_scc1 L_norm_10
  ds_read_b128 v[168:171], v6 offset:2048
  ds_read_b128 v[172:175], v6 offset:2064
  s_waitcnt lgkmcnt(0)
  v_add_f32 v168, v168, v169
  v_mul_f32 v168, 0x3a800000, v168
  v_add_f32 v170, v170, v171
  v_mul_f32 v170, 0x3a800000, v170
  v_add_f32 v172, v172, v173
  v_mul_f32 v172, 0x3a800000, v172
  v_add_f32 v174, v174, v175
  v_mul_f32 v174, 0x3a800000, v174
  v_cvt_pk_bf16_f32 v176, v168, v170
  v_cvt_pk_bf16_f32 v177, v172, v174
  s_lshl_b32 s27, s2, 3
  s_add_u32 s27, s27, 41746432
  s_mov_b64 exec, 1
  buffer_store_dwordx2 v[176:177], v6, s[12:15], s27 offen sc1
  s_mov_b64 exec, -1
L_norm_10:
  s_mov_b32 s44, 0x3e8293ee
  s_waitcnt lgkmcnt(9)
  v_mul_f32 v52, s44, v28
  v_mul_f32 v53, s44, v29
  v_mul_f32 v54, s44, v30
  v_mul_f32 v55, s44, v31
  v_mul_f32 v56, s44, v32
  v_mul_f32 v57, s44, v33
  v_mul_f32 v58, s44, v34
  v_mul_f32 v59, s44, v35
  v_pk_mul_f32 v[144:145], v[36:37], v[52:53] op_sel:[0,1] op_sel_hi:[1,1]
  v_pk_fma_f32 v[64:65], v[64:65], v[52:53], v[144:145] op_sel:[0,0,0] op_sel_hi:[1,0,1]
  v_pk_mul_f32 v[146:147], v[38:39], v[52:53] op_sel:[0,1] op_sel_hi:[1,1]
  v_pk_fma_f32 v[66:67], v[66:67], v[52:53], v[146:147] op_sel:[0,0,0] op_sel_hi:[1,0,1]
  v_cvt_pk_bf16_f32 v16, v64, v65
  v_cvt_pk_bf16_f32 v17, v66, v67
  v_pk_mul_f32 v[148:149], v[36:37], v[54:55] op_sel:[0,1] op_sel_hi:[1,1]
  v_pk_fma_f32 v[68:69], v[68:69], v[54:55], v[148:149] op_sel:[0,0,0] op_sel_hi:[1,0,1]
  v_pk_mul_f32 v[150:151], v[38:39], v[54:55] op_sel:[0,1] op_sel_hi:[1,1]
  v_pk_fma_f32 v[70:71], v[70:71], v[54:55], v[150:151] op_sel:[0,0,0] op_sel_hi:[1,0,1]
  v_cvt_pk_bf16_f32 v18, v68, v69
  v_cvt_pk_bf16_f32 v19, v70, v71
  s_nop 0
  v_permlane16_swap_b32 v16, v18
  v_permlane16_swap_b32 v17, v19
  buffer_store_dwordx4 v[16:19], v5, s[12:15], s35 offen sc1
  v_pk_mul_f32 v[144:145], v[36:37], v[56:57] op_sel:[0,1] op_sel_hi:[1,1]
  v_pk_fma_f32 v[72:73], v[72:73], v[56:57], v[144:145] op_sel:[0,0,0] op_sel_hi:[1,0,1]
  v_pk_mul_f32 v[146:147], v[38:39], v[56:57] op_sel:[0,1] op_sel_hi:[1,1]
  v_pk_fma_f32 v[74:75], v[74:75], v[56:57], v[146:147] op_sel:[0,0,0] op_sel_hi:[1,0,1]
  v_cvt_pk_bf16_f32 v20, v72, v73
  v_cvt_pk_bf16_f32 v21, v74, v75
  v_pk_mul_f32 v[148:149], v[36:37], v[58:59] op_sel:[0,1] op_sel_hi:[1,1]
  v_pk_fma_f32 v[76:77], v[76:77], v[58:59], v[148:149] op_sel:[0,0,0] op_sel_hi:[1,0,1]
  v_pk_mul_f32 v[150:151], v[38:39], v[58:59] op_sel:[0,1] op_sel_hi:[1,1]
  v_pk_fma_f32 v[78:79], v[78:79], v[58:59], v[150:151] op_sel:[0,0,0] op_sel_hi:[1,0,1]
  v_cvt_pk_bf16_f32 v22, v76, v77
  v_cvt_pk_bf16_f32 v23, v78, v79
  s_nop 0
  v_permlane16_swap_b32 v20, v22
  v_permlane16_swap_b32 v21, v23
  buffer_store_dwordx4 v[20:23], v5, s[12:15], s37 offen sc1
  v_pk_mul_f32 v[144:145], v[40:41], v[28:29] op_sel:[0,1] op_sel_hi:[1,1]
  v_pk_fma_f32 v[80:81], v[80:81], v[28:29], v[144:145] op_sel:[0,0,0] op_sel_hi:[1,0,1]
  v_pk_mul_f32 v[146:147], v[42:43], v[28:29] op_sel:[0,1] op_sel_hi:[1,1]
  v_pk_fma_f32 v[82:83], v[82:83], v[28:29], v[146:147] op_sel:[0,0,0] op_sel_hi:[1,0,1]
  v_cvt_pk_bf16_f32 v24, v80, v81
  v_cvt_pk_bf16_f32 v25, v82, v83
  v_pk_mul_f32 v[148:149], v[40:41], v[30:31] op_sel:[0,1] op_sel_hi:[1,1]
  v_pk_fma_f32 v[84:85], v[84:85], v[30:31], v[148:149] op_sel:[0,0,0] op_sel_hi:[1,0,1]
  v_pk_mul_f32 v[150:151], v[42:43], v[30:31] op_sel:[0,1] op_sel_hi:[1,1]
  v_pk_fma_f32 v[86:87], v[86:87], v[30:31], v[150:151] op_sel:[0,0,0] op_sel_hi:[1,0,1]
  v_cvt_pk_bf16_f32 v26, v84, v85
  v_cvt_pk_bf16_f32 v27, v86, v87
  s_nop 0
  v_permlane16_swap_b32 v24, v26
  v_permlane16_swap_b32 v25, v27
  buffer_store_dwordx4 v[24:27], v5, s[12:15], s36 offen sc1
  v_pk_mul_f32 v[144:145], v[40:41], v[32:33] op_sel:[0,1] op_sel_hi:[1,1]
  v_pk_fma_f32 v[88:89], v[88:89], v[32:33], v[144:145] op_sel:[0,0,0] op_sel_hi:[1,0,1]
  v_pk_mul_f32 v[146:147], v[42:43], v[32:33] op_sel:[0,1] op_sel_hi:[1,1]
  v_pk_fma_f32 v[90:91], v[90:91], v[32:33], v[146:147] op_sel:[0,0,0] op_sel_hi:[1,0,1]
  v_cvt_pk_bf16_f32 v44, v88, v89
  v_cvt_pk_bf16_f32 v45, v90, v91
  v_pk_mul_f32 v[148:149], v[40:41], v[34:35] op_sel:[0,1] op_sel_hi:[1,1]
  v_pk_fma_f32 v[92:93], v[92:93], v[34:35], v[148:149] op_sel:[0,0,0] op_sel_hi:[1,0,1]
  v_pk_mul_f32 v[150:151], v[42:43], v[34:35] op_sel:[0,1] op_sel_hi:[1,1]
  v_pk_fma_f32 v[94:95], v[94:95], v[34:35], v[150:151] op_sel:[0,0,0] op_sel_hi:[1,0,1]
  v_cvt_pk_bf16_f32 v46, v92, v93
  v_cvt_pk_bf16_f32 v47, v94, v95
  s_nop 0
  v_permlane16_swap_b32 v44, v46
  v_permlane16_swap_b32 v45, v47
  buffer_store_dwordx4 v[44:47], v5, s[12:15], s38 offen sc1
  s_waitcnt lgkmcnt(0)
  v_pk_mul_f32 v[144:145], v[116:117], v[152:153] op_sel:[0,0] op_sel_hi:[1,0]
  v_pk_fma_f32 v[96:97], v[96:97], v[112:113], v[144:145]
  v_pk_mul_f32 v[146:147], v[118:119], v[152:153] op_sel:[0,0] op_sel_hi:[1,0]
  v_pk_fma_f32 v[98:99], v[98:99], v[114:115], v[146:147]
  v_cvt_pk_bf16_f32 v48, v96, v97
  v_cvt_pk_bf16_f32 v49, v98, v99
  v_pk_mul_f32 v[148:149], v[124:125], v[152:153] op_sel:[0,0] op_sel_hi:[1,0]
  v_pk_fma_f32 v[100:101], v[100:101], v[120:121], v[148:149]
  v_pk_mul_f32 v[150:151], v[126:127], v[152:153] op_sel:[0,0] op_sel_hi:[1,0]
  v_pk_fma_f32 v[102:103], v[102:103], v[122:123], v[150:151]
  v_cvt_pk_bf16_f32 v50, v100, v101
  v_cvt_pk_bf16_f32 v51, v102, v103
  s_nop 0
  v_permlane32_swap_b32 v48, v50
  v_permlane32_swap_b32 v49, v51
  buffer_store_dwordx4 v[48:51], v14, s[12:15], s39 offen sc1
  v_pk_mul_f32 v[144:145], v[132:133], v[152:153] op_sel:[0,0] op_sel_hi:[1,0]
  v_pk_fma_f32 v[104:105], v[104:105], v[128:129], v[144:145]
  v_pk_mul_f32 v[146:147], v[134:135], v[152:153] op_sel:[0,0] op_sel_hi:[1,0]
  v_pk_fma_f32 v[106:107], v[106:107], v[130:131], v[146:147]
  v_cvt_pk_bf16_f32 v60, v104, v105
  v_cvt_pk_bf16_f32 v61, v106, v107
  v_pk_mul_f32 v[148:149], v[140:141], v[152:153] op_sel:[0,0] op_sel_hi:[1,0]
  v_pk_fma_f32 v[108:109], v[108:109], v[136:137], v[148:149]
  v_pk_mul_f32 v[150:151], v[142:143], v[152:153] op_sel:[0,0] op_sel_hi:[1,0]
  v_pk_fma_f32 v[110:111], v[110:111], v[138:139], v[150:151]
  v_cvt_pk_bf16_f32 v62, v108, v109
  v_cvt_pk_bf16_f32 v63, v110, v111
  s_nop 0
  v_permlane32_swap_b32 v60, v62
  v_permlane32_swap_b32 v61, v63
  buffer_store_dwordx4 v[60:63], v14, s[12:15], s40 offen sc1
  s_lshl_b32 s27, s24, 7
  s_add_u32 s27, s27, 41680896
  s_waitcnt vmcnt(0)
  s_barrier
  s_cmp_lg_u32 s20, 0
  s_cbranch_scc1 L_nosig_11
  s_mov_b64 exec, 1
  v_mov_b32 v30, 1
  v_mov_b32 v31, 0
  buffer_atomic_add v30, v31, s[12:15], s27 offen sc1
  s_mov_b64 exec, -1
L_nosig_11:
  s_and_b32 s21, s2, 7
  s_lshr_b32 s22, s2, 3
  s_and_b32 s27, s21, 3
  s_lshl_b32 s27, s27, 2
  s_and_b32 s28, s22, 3
  s_add_u32 s27, s27, s28
  s_lshr_b32 s29, s21, 2
  s_lshl_b32 s29, s29, 3
  s_lshr_b32 s28, s22, 2
  s_add_u32 s29, s29, s28
  v_lshrrev_b32 v180, 3, v1
  v_and_b32 v181, 7, v1
  v_lshrrev_b32 v182, 2, v180
  v_and_b32 v183, 3, v180
  v_lshl_add_u32 v182, v182, 3, v183
  v_mul_u32_u24 v182, 2048, v182
  v_lshrrev_b32 v183, 1, v181
  v_lshrrev_b32 v180, 1, v180
  v_xor_b32 v183, v183, v180
  v_and_b32 v181, 1, v181
  v_lshl_add_u32 v183, v183, 1, v181
  v_lshl_add_u32 v200, v183, 4, v182
  v_add_u32 v201, 8192, v200
  s_lshr_b32 s27, s20, 1
  s_lshl_b32 s27, s27, 5
  s_and_b32 s28, s20, 1
  s_lshl_b32 s28, s28, 4
  s_add_u32 s27, s27, s28
  s_lshl_b32 s50, s27, 11
  s_lshl_b32 s28, s29, 7
  s_add_u32 s50, s50, s28
  s_lshl_b32 s51, s20, 11
  s_add_u32 s51, s51, 98304
  s_mov_b32 s8, s68
  s_mov_b32 s9, s69
  s_mov_b32 s10, 0x200000
  s_mov_b32 s11, 0x20000
  s_and_b32 s21, s2, 7
  s_lshl_b32 s21, s21, 2
  s_lshr_b32 s22, s2, 6
  s_add_u32 s21, s21, s22
  s_bfe_u32 s22, s2, 0x30003
  s_and_b32 s23, s20, 3
  s_lshr_b32 s24, s20, 2
  v_lshlrev_b32 v2, 4, v1
  s_lshl_b32 s30, s24, 5
  s_add_u32 s30, s30, s23
  s_lshl_b32 s30, s30, 16
  s_lshl_b32 s25, s21, 11
  s_add_u32 s30, s30, s25
  s_add_u32 s30, s30, 8388608
  s_lshl_b32 s31, s21, 7
  s_lshl_b32 s25, s24, 6
  s_add_u32 s31, s31, s25
  s_lshl_b32 s25, s23, 1
  s_add_u32 s31, s31, s25
  s_lshl_b32 s31, s31, 10
  s_add_u32 s31, s31, 12582912
  s_lshl_b32 s32, s24, 14
  s_lshl_b32 s25, s23, 11
  s_add_u32 s32, s32, s25
  s_lshl_b32 s33, s22, 3
  s_lshl_b32 s25, s23, 1
  s_add_u32 s33, s33, s25
  s_lshl_b32 s33, s33, 16
  s_lshl_b32 s25, s21, 11
  s_add_u32 s33, s33, s25
  s_add_u32 s45, s33, 16777216
  s_add_u32 s33, s33, 4194304
  s_add_u32 s34, s33, 65536
  v_lshrrev_b32 v5, 2, v1
  v_lshrrev_b32 v180, 4, v1
  v_xor_b32 v5, v5, v180
  v_and_b32 v5, 1, v5
  v_cmp_eq_u32 vcc, 0, v5
  v_mov_b32 v180, 0x3f803f80
  s_nop 0
  v_cndmask_b32 v176, 0, v180, vcc
  v_mov_b32 v177, v176
  v_mov_b32 v178, v176
  v_mov_b32 v179, v176
  v_mov_b32 v144, 0
  v_mov_b32 v145, 0
  v_mov_b32 v146, 0
  v_mov_b32 v147, 0
  v_mov_b32 v148, 0
  v_mov_b32 v149, 0
  v_mov_b32 v150, 0
  v_mov_b32 v151, 0
  v_mov_b32 v152, 0
  v_mov_b32 v153, 0
  v_mov_b32 v154, 0
  v_mov_b32 v155, 0
  v_mov_b32 v156, 0
  v_mov_b32 v157, 0
  v_mov_b32 v158, 0
  v_mov_b32 v159, 0
  v_mov_b32 v160, 0
  v_mov_b32 v161, 0
  v_mov_b32 v162, 0
  v_mov_b32 v163, 0
  v_mov_b32 v164, 0
  v_mov_b32 v165, 0
  v_mov_b32 v166, 0
  v_mov_b32 v167, 0
  v_mov_b32 v168, 0
  v_mov_b32 v169, 0
  v_mov_b32 v170, 0
  v_mov_b32 v171, 0
  v_mov_b32 v172, 0
  v_mov_b32 v173, 0
  v_mov_b32 v174, 0
  v_mov_b32 v175, 0
  s_mov_b32 s46, 0
  s_lshl_b32 s25, s24, 14
  v_add_u32 v5, s25, v2
  s_lshl_b32 s25, s2, 3
  s_add_u32 s25, s25, s20
  s_mul_i32 s26, s25, 3584
  v_lshlrev_b32 v198, 6, v1
  v_add_u32 v198, s26, v198
  s_mov_b32 s88, s68
  s_mov_b32 s89, s69
  s_mov_b32 s90, 0x200000
  s_mov_b32 s91, 0x20000
  s_mov_b64 s[92:93], s[72:73]
  s_mov_b64 s[94:95], s[74:75]
  s_mov_b64 s[96:97], s[76:77]
  s_mov_b32 s60, s76
  s_mov_b32 s61, s77
  s_mov_b32 s62, 0x700000
  s_mov_b32 s63, 0x20000
  v_lshrrev_b32 v224, 3, v1
  s_mov_b32 s26, 458752
  v_mul_lo_u32 v224, v224, s26
  v_and_b32 v225, 7, v1
  v_lshl_add_u32 v224, v225, 4, v224
  s_mul_i32 s98, s2, 14
  s_lshl_b32 s26, s20, 1
  s_add_u32 s98, s98, s26
  s_lshl_b32 s98, s98, 7
  s_add_u32 s98, s98, 50331392
  s_add_u32 s99, s98, 3670016
  s_mul_i32 s100, s2, 28672
  s_lshl_b32 s26, s20, 12
  s_add_u32 s100, s100, s26
  s_sub_u32 s100, s100, 4096
  s_cmp_eq_u32 s20, 0
  s_cselect_b32 s101, 99, 3
  s_cselect_b32 s101, 99, 0xfffffffc
  s_sub_u32 s98, s98, 256
  s_mov_b32 s99, 3670016
  s_sub_u32 s100, s100, 3072
  s_cmp_lt_u32 s20, 4
  s_cbranch_scc1 L_nofill_12
  s_and_b32 s25, s2, 7
  s_lshr_b32 s26, s2, 3
  s_and_b32 s27, s25, 3
  s_lshl_b32 s27, s27, 2
  s_and_b32 s28, s26, 3
  s_add_u32 s27, s27, s28
  s_lshr_b32 s29, s25, 2
  s_lshl_b32 s29, s29, 3
  s_lshr_b32 s28, s26, 2
  s_add_u32 s29, s29, s28
  s_lshl_b32 s27, s27, 4
  s_add_u32 s29, s27, s29
  s_lshl_b32 s27, s29, 14
  s_and_b32 s28, s20, 3
  s_lshl_b32 s28, s28, 12
  s_add_u32 s27, s27, s28
  s_add_u32 s27, s27, 58720256
  v_mov_b32 v32, -1
  v_mov_b32 v33, -1
  v_mov_b32 v34, -1
  v_mov_b32 v35, -1
  buffer_store_dwordx4 v[32:35], v2, s[12:15], s27 offen offset:0 sc1
  buffer_store_dwordx4 v[32:35], v2, s[12:15], s27 offen offset:1024 sc1
  buffer_store_dwordx4 v[32:35], v2, s[12:15], s27 offen offset:2048 sc1
  buffer_store_dwordx4 v[32:35], v2, s[12:15], s27 offen offset:3072 sc1
  s_getreg_b32 s26, hwreg(HW_REG_XCC_ID, 0, 4)
  s_lshl_b32 s27, s29, 10
  s_lshr_b32 s28, s28, 4
  s_add_u32 s27, s27, s28
  s_add_u32 s27, s27, 62914560
  v_mov_b32 v36, s26
  v_lshlrev_b32 v37, 2, v1
  buffer_store_dword v36, v37, s[12:15], s27 offen sc1
L_nofill_12:
  s_lshr_b32 s27, s21, 1
  s_lshl_b32 s27, s27, 7
  s_add_u32 s27, s27, 41680896
  s_cmp_lg_u32 s20, 0
  s_cbranch_scc1 L_wdone_13
  v_mov_b32 v181, 0
  s_mov_b32 s28, 0
L_wspin_14:
  buffer_load_dword v180, v181, s[12:15], s27 offen sc1
  s_add_u32 s28, s28, 1
  s_waitcnt vmcnt(0)
  v_readfirstlane_b32 s29, v180
  s_cmp_eq_u32 s29, 16
  s_cbranch_scc1 L_wdone_13
  s_cmp_gt_u32 s28, 262144
  s_cbranch_scc1 L_wdone_13
  s_sleep 1
  s_branch L_wspin_14
L_wdone_13:
  s_barrier
  buffer_load_dwordx4 v[8:11], v2, s[12:15], s33 offen offset:0 sc1
  buffer_load_dwordx4 v[16:19], v2, s[12:15], s34 offen offset:0 sc1
  buffer_load_dwordx4 v[12:15], v2, s[12:15], s33 offen offset:1024 sc1
  buffer_load_dwordx4 v[20:23], v2, s[12:15], s34 offen offset:1024 sc1
L_p2main_15:
  s_mov_b32 s40, s30
  s_mov_b32 s41, s31
  s_mov_b32 s42, 0
  s_add_u32 m0, s42, s32
  s_nop 0
  buffer_load_dwordx4 v2, s[12:15], s40 offen sc1 lds
  buffer_load_dwordx4 v2, s[12:15], s40 offen offset:1024 sc1 lds
  s_add_u32 m0, m0, 8192
  s_nop 0
  buffer_load_dwordx4 v2, s[12:15], s41 offen sc1 lds
  buffer_load_dwordx4 v2, s[12:15], s41 offen offset:1024 sc1 lds
  s_add_u32 s40, s40, 262144
  s_add_u32 s41, s41, 8192
  s_mov_b32 s42, 32768
  s_add_u32 m0, s42, s32
  s_nop 0
  buffer_load_dwordx4 v2, s[12:15], s40 offen sc1 lds
  buffer_load_dwordx4 v2, s[12:15], s40 offen offset:1024 sc1 lds
  s_add_u32 m0, m0, 8192
  s_nop 0
  buffer_load_dwordx4 v2, s[12:15], s41 offen sc1 lds
  buffer_load_dwordx4 v2, s[12:15], s41 offen offset:1024 sc1 lds
  s_add_u32 s40, s40, 262144
  s_add_u32 s41, s41, 8192
  s_mov_b32 s42, 65536
  v_mov_b32 v3, v5
  v_add_u32 v4, 32768, v5
  s_mov_b32 s43, 32768
  v_mov_b32 v104, 0
  v_mov_b32 v120, 0
  v_mov_b32 v105, 0
  v_mov_b32 v121, 0
  v_mov_b32 v106, 0
  v_mov_b32 v122, 0
  v_mov_b32 v107, 0
  v_mov_b32 v123, 0
  v_mov_b32 v108, 0
  v_mov_b32 v124, 0
  v_mov_b32 v109, 0
  v_mov_b32 v125, 0
  v_mov_b32 v110, 0
  v_mov_b32 v126, 0
  v_mov_b32 v111, 0
  v_mov_b32 v127, 0
  v_mov_b32 v112, 0
  v_mov_b32 v128, 0
  v_mov_b32 v113, 0
  v_mov_b32 v129, 0
  v_mov_b32 v114, 0
  v_mov_b32 v130, 0
  v_mov_b32 v115, 0
  v_mov_b32 v131, 0
  v_mov_b32 v116, 0
  v_mov_b32 v132, 0
  v_mov_b32 v117, 0
  v_mov_b32 v133, 0
  v_mov_b32 v118, 0
  v_mov_b32 v134, 0
  v_mov_b32 v119, 0
  v_mov_b32 v135, 0
  v_mov_b32 v136, 0
  v_mov_b32 v140, 0
  v_mov_b32 v137, 0
  v_mov_b32 v141, 0
  v_mov_b32 v138, 0
  v_mov_b32 v142, 0
  v_mov_b32 v139, 0
  v_mov_b32 v143, 0
  v_mov_b32 v96, 0
  v_mov_b32 v48, 0
  v_mov_b32 v97, 0
  v_mov_b32 v49, 0
  v_mov_b32 v98, 0
  v_mov_b32 v50, 0
  v_mov_b32 v99, 0
  v_mov_b32 v51, 0
  v_mov_b32 v100, 0
  v_mov_b32 v52, 0
  v_mov_b32 v101, 0
  v_mov_b32 v53, 0
  v_mov_b32 v102, 0
  v_mov_b32 v54, 0
  v_mov_b32 v103, 0
  v_mov_b32 v55, 0
  s_waitcnt vmcnt(4)
  s_barrier
  s_cmp_lg_u32 s46, 0
  s_cbranch_scc1 L_p2nopf_20
  s_add_u32 m0, s51, 0
  s_nop 0
  buffer_load_dwordx4 v200, s[8:11], s50 offen lds
  s_add_u32 m0, s51, 1024
  s_nop 0
  buffer_load_dwordx4 v201, s[8:11], s50 offen lds
  s_add_u32 s50, s50, 262144
  s_add_u32 m0, s51, 16384
  s_nop 0
  buffer_load_dwordx4 v200, s[8:11], s50 offen lds
  s_add_u32 m0, s51, 17408
  s_nop 0
  buffer_load_dwordx4 v201, s[8:11], s50 offen lds
  s_add_u32 s50, s50, 262144
  s_add_u32 m0, s51, 32768
  s_nop 0
  buffer_load_dwordx4 v200, s[8:11], s50 offen lds
  s_add_u32 m0, s51, 33792
  s_nop 0
  buffer_load_dwordx4 v201, s[8:11], s50 offen lds
  s_add_u32 s50, s50, 262144
  s_add_u32 m0, s51, 49152
  s_nop 0
  buffer_load_dwordx4 v200, s[8:11], s50 offen lds
  s_add_u32 m0, s51, 50176
  s_nop 0
  buffer_load_dwordx4 v201, s[8:11], s50 offen lds
  s_add_u32 s50, s50, 262144
L_p2nopf_20:
  ds_read_b128 v[24:27], v3 offset:0
  ds_read_b128 v[28:31], v3 offset:1024
  s_waitcnt lgkmcnt(0)
  v_mfma_f32_32x32x16_bf16 v[56:71], v[24:27], v[8:11], v[144:159]
  v_mfma_f32_32x32x16_bf16 v[56:71], v[28:31], v[12:15], v[56:71]
  s_mov_b32 s44, 0
L_p2loop_16:
  v_mfma_f32_32x32x16_bf16 v[72:87], v[24:27], v[16:19], v[160:175]
  ds_read_b128 v[32:35], v3 offset:2048
  s_nop 8
  v_exp_f32 v56, v56
  v_exp_f32 v57, v57
  v_exp_f32 v58, v58
  v_exp_f32 v59, v59
  v_mfma_f32_32x32x16_bf16 v[72:87], v[28:31], v[20:23], v[72:87]
  ds_read_b128 v[36:39], v3 offset:3072
  v_cvt_pk_bf16_f32 v88, v56, v57
  v_cvt_pk_bf16_f32 v89, v58, v59
  v_exp_f32 v60, v60
  v_exp_f32 v61, v61
  v_mfma_f32_32x32x16_bf16 v[120:135], v[48:51], v[96:99], v[120:135]
  ds_read_b128 v[40:43], v3 offset:8192
  v_exp_f32 v62, v62
  v_exp_f32 v63, v63
  v_cvt_pk_bf16_f32 v90, v60, v61
  v_cvt_pk_bf16_f32 v91, v62, v63
  v_mfma_f32_32x32x16_bf16 v[120:135], v[52:55], v[100:103], v[120:135]
  ds_read_b128 v[44:47], v3 offset:9216
  v_exp_f32 v64, v64
  v_exp_f32 v65, v65
  v_exp_f32 v66, v66
  v_exp_f32 v67, v67
  v_mfma_f32_16x16x32_bf16 v[140:143], v[176:179], v[96:99], v[140:143]
  buffer_load_dword v199, v198, s[88:91], 0 offen
  v_cvt_pk_bf16_f32 v92, v64, v65
  v_cvt_pk_bf16_f32 v93, v66, v67
  v_exp_f32 v68, v68
  v_exp_f32 v69, v69
  v_mfma_f32_16x16x32_bf16 v[140:143], v[176:179], v[100:103], v[140:143]
  s_mov_b64 s[88:89], s[92:93]
  s_mov_b64 s[92:93], s[94:95]
  s_mov_b64 s[94:95], s[96:97]
  s_cmp_lt_u32 s44, 2
  s_cselect_b32 s90, 0x700000, 0
  v_exp_f32 v70, v70
  v_exp_f32 v71, v71
  v_cvt_pk_bf16_f32 v94, v68, v69
  v_cvt_pk_bf16_f32 v95, v70, v71
  s_waitcnt lgkmcnt(0)
  v_mfma_f32_32x32x16_bf16 v[56:71], v[32:35], v[8:11], v[144:159]
  v_exp_f32 v72, v72
  v_exp_f32 v73, v73
  v_exp_f32 v74, v74
  v_exp_f32 v75, v75
  v_mfma_f32_32x32x16_bf16 v[56:71], v[36:39], v[12:15], v[56:71]
  v_cvt_pk_bf16_f32 v96, v72, v73
  v_cvt_pk_bf16_f32 v97, v74, v75
  v_exp_f32 v76, v76
  v_exp_f32 v77, v77
  v_mfma_f32_32x32x16_bf16 v[104:119], v[40:43], v[88:91], v[104:119]
  v_exp_f32 v78, v78
  v_exp_f32 v79, v79
  v_cvt_pk_bf16_f32 v98, v76, v77
  v_cvt_pk_bf16_f32 v99, v78, v79
  v_mfma_f32_32x32x16_bf16 v[104:119], v[44:47], v[92:95], v[104:119]
  v_exp_f32 v80, v80
  v_exp_f32 v81, v81
  v_exp_f32 v82, v82
  v_exp_f32 v83, v83
  v_mfma_f32_16x16x32_bf16 v[136:139], v[176:179], v[88:91], v[136:139]
  v_cvt_pk_bf16_f32 v100, v80, v81
  v_cvt_pk_bf16_f32 v101, v82, v83
  v_exp_f32 v84, v84
  v_exp_f32 v85, v85
  v_mfma_f32_16x16x32_bf16 v[136:139], v[176:179], v[92:95], v[136:139]
  v_exp_f32 v86, v86
  v_exp_f32 v87, v87
  v_cvt_pk_bf16_f32 v102, v84, v85
  v_cvt_pk_bf16_f32 v103, v86, v87
  v_mfma_f32_32x32x16_bf16 v[72:87], v[32:35], v[16:19], v[160:175]
  ds_read_b128 v[24:27], v3 offset:4096
  v_exp_f32 v56, v56
  v_exp_f32 v57, v57
  v_exp_f32 v58, v58
  v_exp_f32 v59, v59
  v_mfma_f32_32x32x16_bf16 v[72:87], v[36:39], v[20:23], v[72:87]
  ds_read_b128 v[28:31], v3 offset:5120
  v_cvt_pk_bf16_f32 v88, v56, v57
  v_cvt_pk_bf16_f32 v89, v58, v59
  v_exp_f32 v60, v60
  v_exp_f32 v61, v61
  v_mfma_f32_32x32x16_bf16 v[120:135], v[40:43], v[96:99], v[120:135]
  ds_read_b128 v[48:51], v3 offset:10240
  v_exp_f32 v62, v62
  v_exp_f32 v63, v63
  v_cvt_pk_bf16_f32 v90, v60, v61
  v_cvt_pk_bf16_f32 v91, v62, v63
  v_mfma_f32_32x32x16_bf16 v[120:135], v[44:47], v[100:103], v[120:135]
  ds_read_b128 v[52:55], v3 offset:11264
  v_exp_f32 v64, v64
  v_exp_f32 v65, v65
  v_exp_f32 v66, v66
  v_exp_f32 v67, v67
  v_mfma_f32_16x16x32_bf16 v[140:143], v[176:179], v[96:99], v[140:143]
  v_cvt_pk_bf16_f32 v92, v64, v65
  v_cvt_pk_bf16_f32 v93, v66, v67
  v_exp_f32 v68, v68
  v_exp_f32 v69, v69
  v_mfma_f32_16x16x32_bf16 v[140:143], v[176:179], v[100:103], v[140:143]
  v_exp_f32 v70, v70
  v_exp_f32 v71, v71
  v_cvt_pk_bf16_f32 v94, v68, v69
  v_cvt_pk_bf16_f32 v95, v70, v71
  s_waitcnt lgkmcnt(0)
  v_mfma_f32_32x32x16_bf16 v[56:71], v[24:27], v[8:11], v[144:159]
  v_exp_f32 v72, v72
  v_exp_f32 v73, v73
  v_exp_f32 v74, v74
  v_exp_f32 v75, v75
  v_mfma_f32_32x32x16_bf16 v[56:71], v[28:31], v[12:15], v[56:71]
  v_cvt_pk_bf16_f32 v96, v72, v73
  v_cvt_pk_bf16_f32 v97, v74, v75
  v_exp_f32 v76, v76
  v_exp_f32 v77, v77
  v_mfma_f32_32x32x16_bf16 v[104:119], v[48:51], v[88:91], v[104:119]
  v_exp_f32 v78, v78
  v_exp_f32 v79, v79
  v_cvt_pk_bf16_f32 v98, v76, v77
  v_cvt_pk_bf16_f32 v99, v78, v79
  v_mfma_f32_32x32x16_bf16 v[104:119], v[52:55], v[92:95], v[104:119]
  v_exp_f32 v80, v80
  v_exp_f32 v81, v81
  v_exp_f32 v82, v82
  v_exp_f32 v83, v83
  v_mfma_f32_16x16x32_bf16 v[136:139], v[176:179], v[88:91], v[136:139]
  v_cvt_pk_bf16_f32 v100, v80, v81
  v_cvt_pk_bf16_f32 v101, v82, v83
  v_exp_f32 v84, v84
  v_exp_f32 v85, v85
  v_mfma_f32_16x16x32_bf16 v[136:139], v[176:179], v[92:95], v[136:139]
  v_exp_f32 v86, v86
  v_exp_f32 v87, v87
  v_cvt_pk_bf16_f32 v102, v84, v85
  v_cvt_pk_bf16_f32 v103, v86, v87
  v_mfma_f32_32x32x16_bf16 v[72:87], v[24:27], v[16:19], v[160:175]
  ds_read_b128 v[32:35], v3 offset:6144
  v_exp_f32 v56, v56
  v_exp_f32 v57, v57
  v_exp_f32 v58, v58
  v_exp_f32 v59, v59
  v_mfma_f32_32x32x16_bf16 v[72:87], v[28:31], v[20:23], v[72:87]
  ds_read_b128 v[36:39], v3 offset:7168
  v_cvt_pk_bf16_f32 v88, v56, v57
  v_cvt_pk_bf16_f32 v89, v58, v59
  v_exp_f32 v60, v60
  v_exp_f32 v61, v61
  v_mfma_f32_32x32x16_bf16 v[120:135], v[48:51], v[96:99], v[120:135]
  ds_read_b128 v[40:43], v3 offset:12288
  v_exp_f32 v62, v62
  v_exp_f32 v63, v63
  v_cvt_pk_bf16_f32 v90, v60, v61
  v_cvt_pk_bf16_f32 v91, v62, v63
  v_mfma_f32_32x32x16_bf16 v[120:135], v[52:55], v[100:103], v[120:135]
  ds_read_b128 v[44:47], v3 offset:13312
  v_exp_f32 v64, v64
  v_exp_f32 v65, v65
  v_exp_f32 v66, v66
  v_exp_f32 v67, v67
  v_mfma_f32_16x16x32_bf16 v[140:143], v[176:179], v[96:99], v[140:143]
  v_cvt_pk_bf16_f32 v92, v64, v65
  v_cvt_pk_bf16_f32 v93, v66, v67
  v_exp_f32 v68, v68
  v_exp_f32 v69, v69
  v_mfma_f32_16x16x32_bf16 v[140:143], v[176:179], v[100:103], v[140:143]
  v_exp_f32 v70, v70
  v_exp_f32 v71, v71
  v_cvt_pk_bf16_f32 v94, v68, v69
  v_cvt_pk_bf16_f32 v95, v70, v71
  s_waitcnt lgkmcnt(0)
  v_mfma_f32_32x32x16_bf16 v[56:71], v[32:35], v[8:11], v[144:159]
  v_exp_f32 v72, v72
  v_exp_f32 v73, v73
  v_exp_f32 v74, v74
  v_exp_f32 v75, v75
  v_mfma_f32_32x32x16_bf16 v[56:71], v[36:39], v[12:15], v[56:71]
  v_cvt_pk_bf16_f32 v96, v72, v73
  v_cvt_pk_bf16_f32 v97, v74, v75
  v_exp_f32 v76, v76
  v_exp_f32 v77, v77
  v_mfma_f32_32x32x16_bf16 v[104:119], v[40:43], v[88:91], v[104:119]
  v_exp_f32 v78, v78
  v_exp_f32 v79, v79
  v_cvt_pk_bf16_f32 v98, v76, v77
  v_cvt_pk_bf16_f32 v99, v78, v79
  v_mfma_f32_32x32x16_bf16 v[104:119], v[44:47], v[92:95], v[104:119]
  v_exp_f32 v80, v80
  v_exp_f32 v81, v81
  v_exp_f32 v82, v82
  v_exp_f32 v83, v83
  v_mfma_f32_16x16x32_bf16 v[136:139], v[176:179], v[88:91], v[136:139]
  v_cvt_pk_bf16_f32 v100, v80, v81
  v_cvt_pk_bf16_f32 v101, v82, v83
  v_exp_f32 v84, v84
  v_exp_f32 v85, v85
  v_mfma_f32_16x16x32_bf16 v[136:139], v[176:179], v[92:95], v[136:139]
  v_exp_f32 v86, v86
  v_exp_f32 v87, v87
  v_cvt_pk_bf16_f32 v102, v84, v85
  v_cvt_pk_bf16_f32 v103, v86, v87
  s_waitcnt vmcnt(1)
  s_barrier
  s_cmp_ge_u32 s44, 6
  s_cbranch_scc1 L_nodma_21
  s_add_u32 m0, s42, s32
  s_nop 0
  buffer_load_dwordx4 v2, s[12:15], s40 offen sc1 lds
  buffer_load_dwordx4 v2, s[12:15], s40 offen offset:1024 sc1 lds
  s_add_u32 m0, m0, 8192
  s_nop 0
  buffer_load_dwordx4 v2, s[12:15], s41 offen sc1 lds
  buffer_load_dwordx4 v2, s[12:15], s41 offen offset:1024 sc1 lds
  s_add_u32 s40, s40, 262144
  s_add_u32 s41, s41, 8192
  s_add_u32 s42, s42, 32768
  s_cmp_eq_u32 s42, 98304
  s_cselect_b32 s42, 0, s42
L_nodma_21:
  v_mfma_f32_32x32x16_bf16 v[72:87], v[32:35], v[16:19], v[160:175]
  ds_read_b128 v[24:27], v4 offset:0
  v_exp_f32 v56, v56
  v_exp_f32 v57, v57
  v_exp_f32 v58, v58
  v_exp_f32 v59, v59
  v_mfma_f32_32x32x16_bf16 v[72:87], v[36:39], v[20:23], v[72:87]
  ds_read_b128 v[28:31], v4 offset:1024
  v_cvt_pk_bf16_f32 v88, v56, v57
  v_cvt_pk_bf16_f32 v89, v58, v59
  v_exp_f32 v60, v60
  v_exp_f32 v61, v61
  v_mfma_f32_32x32x16_bf16 v[120:135], v[40:43], v[96:99], v[120:135]
  ds_read_b128 v[48:51], v3 offset:14336
  v_exp_f32 v62, v62
  v_exp_f32 v63, v63
  v_cvt_pk_bf16_f32 v90, v60, v61
  v_cvt_pk_bf16_f32 v91, v62, v63
  v_mfma_f32_32x32x16_bf16 v[120:135], v[44:47], v[100:103], v[120:135]
  ds_read_b128 v[52:55], v3 offset:15360
  v_exp_f32 v64, v64
  v_exp_f32 v65, v65
  v_exp_f32 v66, v66
  v_exp_f32 v67, v67
  v_mfma_f32_16x16x32_bf16 v[140:143], v[176:179], v[96:99], v[140:143]
  v_cvt_pk_bf16_f32 v92, v64, v65
  v_cvt_pk_bf16_f32 v93, v66, v67
  v_exp_f32 v68, v68
  v_exp_f32 v69, v69
  v_mfma_f32_16x16x32_bf16 v[140:143], v[176:179], v[100:103], v[140:143]
  v_exp_f32 v70, v70
  v_exp_f32 v71, v71
  v_cvt_pk_bf16_f32 v94, v68, v69
  v_cvt_pk_bf16_f32 v95, v70, v71
  s_waitcnt lgkmcnt(0)
  v_mfma_f32_32x32x16_bf16 v[56:71], v[24:27], v[8:11], v[144:159]
  v_mov_b32 v3, v4
  v_exp_f32 v72, v72
  v_exp_f32 v73, v73
  v_exp_f32 v74, v74
  v_exp_f32 v75, v75
  v_mfma_f32_32x32x16_bf16 v[56:71], v[28:31], v[12:15], v[56:71]
  s_add_u32 s43, s43, 32768
  s_cmp_eq_u32 s43, 98304
  v_cvt_pk_bf16_f32 v96, v72, v73
  v_cvt_pk_bf16_f32 v97, v74, v75
  v_exp_f32 v76, v76
  v_exp_f32 v77, v77
  v_mfma_f32_32x32x16_bf16 v[104:119], v[48:51], v[88:91], v[104:119]
  s_cselect_b32 s43, 0, s43
  v_exp_f32 v78, v78
  v_exp_f32 v79, v79
  v_cvt_pk_bf16_f32 v98, v76, v77
  v_cvt_pk_bf16_f32 v99, v78, v79
  v_mfma_f32_32x32x16_bf16 v[104:119], v[52:55], v[92:95], v[104:119]
  v_add_u32 v4, s43, v5
  v_exp_f32 v80, v80
  v_exp_f32 v81, v81
  v_exp_f32 v82, v82
  v_exp_f32 v83, v83
  v_mfma_f32_16x16x32_bf16 v[136:139], v[176:179], v[88:91], v[136:139]
  s_cmp_lt_u32 s101, 4
  s_cselect_b64 exec, -1, 0
  buffer_store_dwordx4 v[208:211], v224, s[12:15], s98 offen sc1
  s_add_u32 s101, s101, 1
  s_cmp_lt_u32 s101, 4
  s_cselect_b64 exec, -1, 0
  buffer_load_dwordx4 v[208:211], v2, s[60:63], s100 offen
  s_mov_b64 exec, -1
  v_cvt_pk_bf16_f32 v100, v80, v81
  v_cvt_pk_bf16_f32 v101, v82, v83
  v_exp_f32 v84, v84
  v_exp_f32 v85, v85
  v_mfma_f32_16x16x32_bf16 v[136:139], v[176:179], v[92:95], v[136:139]
  s_add_u32 s98, s98, s99
  s_sub_u32 s99, 128, s99
  s_add_u32 s100, s100, 1024
  v_exp_f32 v86, v86
  v_exp_f32 v87, v87
  v_cvt_pk_bf16_f32 v102, v84, v85
  v_cvt_pk_bf16_f32 v103, v86, v87
  s_add_u32 s44, s44, 1
  s_cmp_lt_u32 s44, 8
  s_cbranch_scc1 L_p2loop_16
  v_mfma_f32_32x32x16_bf16 v[120:135], v[48:51], v[96:99], v[120:135]
  v_mfma_f32_32x32x16_bf16 v[120:135], v[52:55], v[100:103], v[120:135]
  v_mfma_f32_16x16x32_bf16 v[140:143], v[176:179], v[96:99], v[140:143]
  v_mfma_f32_16x16x32_bf16 v[140:143], v[176:179], v[100:103], v[140:143]
  s_nop 7
  s_nop 3
  s_cmp_eq_u32 s24, 0
  s_cbranch_scc1 L_nosw_22
  v_swap_b32 v104, v120
  v_swap_b32 v105, v121
  v_swap_b32 v106, v122
  v_swap_b32 v107, v123
  v_swap_b32 v108, v124
  v_swap_b32 v109, v125
  v_swap_b32 v110, v126
  v_swap_b32 v111, v127
  v_swap_b32 v112, v128
  v_swap_b32 v113, v129
  v_swap_b32 v114, v130
  v_swap_b32 v115, v131
  v_swap_b32 v116, v132
  v_swap_b32 v117, v133
  v_swap_b32 v118, v134
  v_swap_b32 v119, v135
  v_swap_b32 v136, v140
L_nosw_22:
  s_barrier
  s_mul_i32 s25, s20, 5120
  v_add_u32 v180, s25, v2
  v_lshlrev_b32 v181, 2, v1
  v_add_u32 v181, s25, v181
  ds_write_b128 v180, v[120:123] offset:0
  ds_write_b128 v180, v[124:127] offset:1024
  ds_write_b128 v180, v[128:131] offset:2048
  ds_write_b128 v180, v[132:135] offset:3072
  ds_write_b32 v181, v140 offset:4096
  s_xor_b32 s26, s20, 4
  s_mul_i32 s25, s26, 5120
  v_add_u32 v180, s25, v2
  v_lshlrev_b32 v181, 2, v1
  v_add_u32 v181, s25, v181
  s_waitcnt lgkmcnt(0)
  s_barrier
  ds_read_b128 v[120:123], v180 offset:0
  ds_read_b128 v[124:127], v180 offset:1024
  ds_read_b128 v[128:131], v180 offset:2048
  ds_read_b128 v[132:135], v180 offset:3072
  ds_read_b32 v140, v181 offset:4096
  s_waitcnt lgkmcnt(0)
  v_add_f32 v136, v136, v140
  v_add_f32 v104, v104, v120
  v_add_f32 v105, v105, v121
  v_add_f32 v106, v106, v122
  v_add_f32 v107, v107, v123
  v_add_f32 v108, v108, v124
  v_add_f32 v109, v109, v125
  v_add_f32 v110, v110, v126
  v_add_f32 v111, v111, v127
  v_add_f32 v112, v112, v128
  v_add_f32 v113, v113, v129
  v_add_f32 v114, v114, v130
  v_add_f32 v115, v115, v131
  v_add_f32 v116, v116, v132
  v_add_f32 v117, v117, v133
  v_add_f32 v118, v118, v134
  v_add_f32 v119, v119, v135
  s_cmp_lg_u32 s46, 0
  s_cbranch_scc1 L_p2fin_17
  v_mov_b32 v182, v136
  v_fma_f32 v182, v104, 0, v182
  v_fma_f32 v182, v105, 0, v182
  v_fma_f32 v182, v106, 0, v182
  v_fma_f32 v182, v107, 0, v182
  v_fma_f32 v182, v108, 0, v182
  v_fma_f32 v182, v109, 0, v182
  v_fma_f32 v182, v110, 0, v182
  v_fma_f32 v182, v111, 0, v182
  v_fma_f32 v182, v112, 0, v182
  v_fma_f32 v182, v113, 0, v182
  v_fma_f32 v182, v114, 0, v182
  v_fma_f32 v182, v115, 0, v182
  v_fma_f32 v182, v116, 0, v182
  v_fma_f32 v182, v117, 0, v182
  v_fma_f32 v182, v118, 0, v182
  v_fma_f32 v182, v119, 0, v182
  v_mov_b32 v183, 0x71800000
  v_cmp_le_f32 vcc, 1.0, v182
  v_cmp_le_f32 s[48:49], v182, v183
  s_and_b64 vcc, vcc, s[48:49]
  s_cmp_eq_u64 vcc, -1
  s_cselect_b32 s47, 0, 1
  v_mov_b32 v182, s47
  s_lshl_b32 s25, s20, 2
  v_mov_b32 v183, s25
  ds_write_b32 v183, v182 offset:45056
  s_waitcnt lgkmcnt(0)
  s_barrier
  v_mov_b32 v183, 0
  ds_read_b128 v[184:187], v183 offset:45056
  ds_read_b128 v[188:191], v183 offset:45072
  s_waitcnt lgkmcnt(0)
  v_or3_b32 v184, v184, v185, v186
  v_or3_b32 v188, v188, v189, v190
  v_or3_b32 v184, v184, v187, v191
  v_or_b32 v184, v184, v188
  s_nop 0
  v_readfirstlane_b32 s47, v184
  s_cmp_lg_u32 s47, 0
  s_cbranch_scc1 L_p2fb_18
L_p2fin_17:
  v_rcp_f32 v136, v136
  s_nop 0
  v_mul_f32 v104, v104, v136
  v_mul_f32 v105, v105, v136
  v_mul_f32 v106, v106, v136
  v_mul_f32 v107, v107, v136
  v_cvt_pk_bf16_f32 v56, v104, v105
  v_cvt_pk_bf16_f32 v57, v106, v107
  v_mul_f32 v108, v108, v136
  v_mul_f32 v109, v109, v136
  v_mul_f32 v110, v110, v136
  v_mul_f32 v111, v111, v136
  v_cvt_pk_bf16_f32 v58, v108, v109
  v_cvt_pk_bf16_f32 v59, v110, v111
  v_mul_f32 v112, v112, v136
  v_mul_f32 v113, v113, v136
  v_mul_f32 v114, v114, v136
  v_mul_f32 v115, v115, v136
  v_cvt_pk_bf16_f32 v60, v112, v113
  v_cvt_pk_bf16_f32 v61, v114, v115
  v_mul_f32 v116, v116, v136
  v_mul_f32 v117, v117, v136
  v_mul_f32 v118, v118, v136
  v_mul_f32 v119, v119, v136
  v_cvt_pk_bf16_f32 v62, v116, v117
  v_cvt_pk_bf16_f32 v63, v118, v119
  s_lshl_b32 s25, s24, 16
  s_add_u32 s45, s45, s25
  v_permlane32_swap_b32 v56, v58
  v_permlane32_swap_b32 v57, v59
  buffer_store_dwordx4 v[56:59], v2, s[12:15], s45 offen offset:0 sc1
  v_permlane32_swap_b32 v60, v62
  v_permlane32_swap_b32 v61, v63
  buffer_store_dwordx4 v[60:63], v2, s[12:15], s45 offen offset:1024 sc1
  s_branch L_p2end_19
L_p2fb_18:
  s_mov_b32 s46, 1
  s_mov_b32 s101, 99
  s_barrier
  v_mov_b32 v182, 0xff800000
  v_mov_b32 v183, 0xff800000
  s_lshl_b32 s40, s24, 21
  s_lshl_b32 s25, s21, 11
  s_add_u32 s40, s40, s25
  s_add_u32 s40, s40, 8388608
  s_mov_b32 s44, 0
L_p2fbl_23:
  buffer_load_dwordx4 v[24:27], v2, s[12:15], s40 offen offset:0 sc1
  buffer_load_dwordx4 v[28:31], v2, s[12:15], s40 offen offset:1024 sc1
  s_waitcnt vmcnt(0)
  v_mfma_f32_32x32x16_bf16 v[56:71], v[24:27], v[8:11], 0
  v_mfma_f32_32x32x16_bf16 v[56:71], v[28:31], v[12:15], v[56:71]
  v_mfma_f32_32x32x16_bf16 v[72:87], v[24:27], v[16:19], 0
  v_mfma_f32_32x32x16_bf16 v[72:87], v[28:31], v[20:23], v[72:87]
  s_nop 9
  v_max3_f32 v182, v182, v56, v57
  v_max3_f32 v182, v182, v58, v59
  v_max3_f32 v182, v182, v60, v61
  v_max3_f32 v182, v182, v62, v63
  v_max3_f32 v182, v182, v64, v65
  v_max3_f32 v182, v182, v66, v67
  v_max3_f32 v182, v182, v68, v69
  v_max3_f32 v182, v182, v70, v71
  v_max3_f32 v183, v183, v72, v73
  v_max3_f32 v183, v183, v74, v75
  v_max3_f32 v183, v183, v76, v77
  v_max3_f32 v183, v183, v78, v79
  v_max3_f32 v183, v183, v80, v81
  v_max3_f32 v183, v183, v82, v83
  v_max3_f32 v183, v183, v84, v85
  v_max3_f32 v183, v183, v86, v87
  s_add_u32 s40, s40, 65536
  s_add_u32 s44, s44, 1
  s_cmp_lt_u32 s44, 32
  s_cbranch_scc1 L_p2fbl_23
  v_mov_b32 v184, v182
  s_nop 1
  v_permlane32_swap_b32 v182, v184
  v_max_f32 v182, v182, v184
  v_mov_b32 v184, v183
  s_nop 1
  v_permlane32_swap_b32 v183, v184
  v_max_f32 v183, v183, v184
  s_lshl_b32 s25, s20, 9
  v_lshlrev_b32 v184, 3, v1
  v_add_u32 v185, s25, v184
  ds_write_b64 v185, v[182:183]
  s_xor_b32 s26, s20, 4
  s_lshl_b32 s25, s26, 9
  v_add_u32 v185, s25, v184
  s_waitcnt lgkmcnt(0)
  s_barrier
  ds_read_b64 v[186:187], v185
  s_waitcnt lgkmcnt(0)
  v_max_f32 v182, v182, v186
  v_max_f32 v183, v183, v187
  v_sub_f32 v144, 0, v182
  v_sub_f32 v160, 0, v183
  v_sub_f32 v145, 0, v182
  v_sub_f32 v161, 0, v183
  v_sub_f32 v146, 0, v182
  v_sub_f32 v162, 0, v183
  v_sub_f32 v147, 0, v182
  v_sub_f32 v163, 0, v183
  v_sub_f32 v148, 0, v182
  v_sub_f32 v164, 0, v183
  v_sub_f32 v149, 0, v182
  v_sub_f32 v165, 0, v183
  v_sub_f32 v150, 0, v182
  v_sub_f32 v166, 0, v183
  v_sub_f32 v151, 0, v182
  v_sub_f32 v167, 0, v183
  v_sub_f32 v152, 0, v182
  v_sub_f32 v168, 0, v183
  v_sub_f32 v153, 0, v182
  v_sub_f32 v169, 0, v183
  v_sub_f32 v154, 0, v182
  v_sub_f32 v170, 0, v183
  v_sub_f32 v155, 0, v182
  v_sub_f32 v171, 0, v183
  v_sub_f32 v156, 0, v182
  v_sub_f32 v172, 0, v183
  v_sub_f32 v157, 0, v182
  v_sub_f32 v173, 0, v183
  v_sub_f32 v158, 0, v182
  v_sub_f32 v174, 0, v183
  v_sub_f32 v159, 0, v182
  v_sub_f32 v175, 0, v183
  s_barrier
  s_branch L_p2main_15
L_p2end_19:
  s_lshl_b32 s27, s22, 7
  s_add_u32 s27, s27, 41682944
  s_waitcnt vmcnt(0)
  s_barrier
  s_cmp_lg_u32 s20, 0
  s_cbranch_scc1 L_nosig_24
  s_mov_b64 exec, 1
  v_mov_b32 v180, 1
  v_mov_b32 v181, 0
  buffer_atomic_add v180, v181, s[12:15], s27 offen sc1
  s_mov_b64 exec, -1
L_nosig_24:
  s_and_b32 s21, s2, 7
  s_lshr_b32 s22, s2, 3
  s_and_b32 s23, s21, 3
  s_lshl_b32 s23, s23, 2
  s_and_b32 s25, s22, 3
  s_add_u32 s23, s23, s25
  s_lshr_b32 s24, s21, 2
  s_lshl_b32 s24, s24, 3
  s_lshr_b32 s25, s22, 2
  s_add_u32 s24, s24, s25
  s_and_b32 s25, s20, 3
  s_lshr_b32 s26, s20, 2
  s_lshl_b32 s31, s23, 2
  s_add_u32 s31, s31, s25
  s_mul_i32 s31, s31, 65536
  s_lshl_b32 s28, s26, 12
  s_add_u32 s31, s31, s28
  s_add_u32 s31, s31, 16777216
  v_lshrrev_b32 v12, 4, v1
  v_and_b32 v13, 15, v1
  v_lshlrev_b32 v14, 4, v13
  v_lshl_add_u32 v14, v12, 9, v14
  s_lshl_b32 s28, s26, 8
  v_add_u32 v6, s28, v14
  v_xor_b32 v7, 256, v6
  v_and_b32 v14, 1, v12
  v_lshlrev_b32 v14, 1, v14
  v_lshrrev_b32 v15, 1, v12
  v_add_u32 v14, v14, v15
  v_lshlrev_b32 v10, 11, v13
  v_lshl_add_u32 v10, v14, 4, v10
  s_lshl_b32 s33, s23, 2
  s_add_u32 s33, s33, s25
  s_lshl_b32 s33, s33, 1
  s_add_u32 s33, s33, s26
  s_lshl_b32 s35, s33, 4
  s_lshl_b32 s33, s33, 15
  s_lshl_b32 s28, s24, 7
  s_add_u32 s33, s33, s28
  v_lshlrev_b32 v11, 9, v14
  v_lshl_add_u32 v11, v13, 4, v11
  s_lshl_b32 s34, s23, 2
  s_add_u32 s34, s34, s25
  s_lshl_b32 s34, s34, 16
  s_lshl_b32 s28, s24, 12
  s_add_u32 s34, s34, s28
  s_lshl_b32 s28, s26, 8
  s_add_u32 s34, s34, s28
  s_add_u32 s34, s34, 20971520
  s_lshl_b32 s28, s20, 10
  s_add_u32 s28, s28, 75776
  v_lshl_add_u32 v8, v12, 4, s28
  s_lshl_b32 s28, s20, 11
  s_add_u32 s28, s28, 147456
  v_lshl_add_u32 v9, v1, 4, s28
  v_bfe_u32 v13, v1, 2, 2
  v_lshrrev_b32 v14, 1, v12
  v_and_b32 v15, 1, v12
  v_lshlrev_b32 v14, 4, v14
  v_lshl_add_u32 v14, v15, 2, v14
  v_add_u32 v14, v14, v13
  v_lshlrev_b32 v14, 7, v14
  v_lshrrev_b32 v13, 1, v13
  v_lshl_add_u32 v13, v15, 1, v13
  v_and_b32 v15, 3, v1
  v_lshl_add_u32 v14, v15, 3, v14
  s_lshl_b32 s28, s26, 13
  s_add_u32 s28, s28, 98304
  v_add_u32 v14, s28, v14
  v_xor_b32 v15, 0, v13
  v_lshl_add_u32 v2, v15, 5, v14
  v_xor_b32 v15, 1, v13
  v_lshl_add_u32 v3, v15, 5, v14
  v_xor_b32 v15, 2, v13
  v_lshl_add_u32 v4, v15, 5, v14
  v_xor_b32 v15, 3, v13
  v_lshl_add_u32 v5, v15, 5, v14
  s_mov_b32 s16, s64
  s_mov_b32 s17, s65
  s_mov_b32 s18, 0x400000
  s_mov_b32 s19, 0x20000
  buffer_load_dwordx4 v[16:19], v10, s[16:19], s33 offen offset:0
  buffer_load_dwordx4 v[20:23], v10, s[16:19], s33 offen offset:64
  v_mov_b32 v56, 0
  v_mov_b32 v57, 0
  v_mov_b32 v58, 0
  v_mov_b32 v59, 0
  v_mov_b32 v60, 0
  v_mov_b32 v61, 0
  v_mov_b32 v62, 0
  v_mov_b32 v63, 0
  v_mov_b32 v64, 0
  v_mov_b32 v65, 0
  v_mov_b32 v66, 0
  v_mov_b32 v67, 0
  v_mov_b32 v68, 0
  v_mov_b32 v69, 0
  v_mov_b32 v70, 0
  v_mov_b32 v71, 0
  v_mov_b32 v72, 0
  v_mov_b32 v73, 0
  v_mov_b32 v74, 0
  v_mov_b32 v75, 0
  v_mov_b32 v76, 0
  v_mov_b32 v77, 0
  v_mov_b32 v78, 0
  v_mov_b32 v79, 0
  v_mov_b32 v80, 0
  v_mov_b32 v81, 0
  v_mov_b32 v82, 0
  v_mov_b32 v83, 0
  v_mov_b32 v84, 0
  v_mov_b32 v85, 0
  v_mov_b32 v86, 0
  v_mov_b32 v87, 0
  v_mov_b32 v88, 0
  v_mov_b32 v89, 0
  v_mov_b32 v90, 0
  v_mov_b32 v91, 0
  v_mov_b32 v92, 0
  v_mov_b32 v93, 0
  v_mov_b32 v94, 0
  v_mov_b32 v95, 0
  s_and_b32 s21, s2, 7
  s_lshr_b32 s22, s2, 3
  s_and_b32 s27, s21, 1
  s_lshl_b32 s27, s27, 2
  s_and_b32 s28, s22, 3
  s_add_u32 s27, s27, s28
  s_lshr_b32 s29, s21, 1
  s_lshl_b32 s29, s29, 3
  s_lshr_b32 s28, s22, 2
  s_add_u32 s29, s29, s28
  s_mul_i32 s40, s29, 224
  s_min_u32 s27, s20, 6
  s_lshl_b32 s42, s27, 10
  s_lshl_b32 s27, s27, 6
  v_add_u32 v15, s27, v1
  v_mul_u32_u24 v12, 4682, v15
  v_lshrrev_b32 v12, 16, v12
  v_mul_u32_u24 v13, 14, v12
  v_sub_u32 v13, v15, v13
  v_and_b32 v14, 0x33, v12
  v_bfe_u32 v15, v12, 2, 1
  v_lshl_add_u32 v14, v15, 3, v14
  v_bfe_u32 v15, v12, 3, 1
  v_lshl_add_u32 v14, v15, 2, v14
  v_mul_u32_u24 v14, 7168, v14
  v_lshl_add_u32 v202, v13, 4, v14
  s_mov_b32 s52, s72
  s_mov_b32 s53, s73
  s_mov_b32 s54, 0x700000
  s_mov_b32 s55, 0x20000
  s_mov_b32 s56, s74
  s_mov_b32 s57, s75
  s_mov_b32 s58, 0x700000
  s_mov_b32 s59, 0x20000
  v_lshrrev_b32 v12, 3, v1
  v_and_b32 v13, 7, v1
  v_lshlrev_b32 v13, 4, v13
  v_lshl_add_u32 v13, v12, 8, v13
  s_lshl_b32 s28, s26, 7
  v_add_u32 v13, s28, v13
  v_and_b32 v14, 15, v1
  v_lshlrev_b32 v14, 2, v14
  s_lshr_b32 s27, s23, 1
  s_lshl_b32 s27, s27, 7
  s_add_u32 s27, s27, 41682944
  s_cmp_lg_u32 s20, 0
  s_cbranch_scc1 L_wdone_25
  v_mov_b32 v25, 0
  s_mov_b32 s28, 0
L_wspin_26:
  buffer_load_dword v24, v25, s[12:15], s27 offen sc1
  s_add_u32 s28, s28, 1
  s_waitcnt vmcnt(0)
  v_readfirstlane_b32 s29, v24
  s_cmp_eq_u32 s29, 32
  s_cbranch_scc1 L_wdone_25
  s_cmp_gt_u32 s28, 262144
  s_cbranch_scc1 L_wdone_25
  s_sleep 1
  s_branch L_wspin_26
L_wdone_25:
  s_barrier
  s_lshl_b32 s28, s20, 10
  s_add_u32 m0, s28, 75776
  s_mov_b32 s28, 41746432
  buffer_load_dwordx4 v13, s[12:15], s28 offen sc1 lds
  buffer_load_dwordx4 v[104:107], v6, s[12:15], s31 offen sc1
  buffer_load_dwordx4 v[108:111], v7, s[12:15], s31 offen sc1
  s_add_u32 s31, s31, 2048
  buffer_load_dwordx4 v[112:115], v6, s[12:15], s31 offen sc1
  buffer_load_dwordx4 v[116:119], v7, s[12:15], s31 offen sc1
  s_add_u32 s31, s31, 6144
  buffer_load_dwordx4 v[120:123], v6, s[12:15], s31 offen sc1
  buffer_load_dwordx4 v[124:127], v7, s[12:15], s31 offen sc1
  s_add_u32 s31, s31, 2048
  buffer_load_dwordx4 v[128:131], v6, s[12:15], s31 offen sc1
  buffer_load_dwordx4 v[132:135], v7, s[12:15], s31 offen sc1
  s_add_u32 s31, s31, 6144
  s_lshl_b32 s28, s35, 2
  s_add_u32 s28, s28, 41811968
  buffer_load_dword v15, v14, s[12:15], s28 offen sc1
  ds_read_b64_tr_b16 v[24:25], v2 offset:0
  ds_read_b64_tr_b16 v[26:27], v2 offset:1024
  ds_read_b64_tr_b16 v[28:29], v3 offset:0
  ds_read_b64_tr_b16 v[30:31], v3 offset:1024
  ds_read_b64_tr_b16 v[32:33], v4 offset:0
  ds_read_b64_tr_b16 v[34:35], v4 offset:1024
  ds_read_b64_tr_b16 v[36:37], v5 offset:0
  ds_read_b64_tr_b16 v[38:39], v5 offset:1024
  s_waitcnt vmcnt(9)
  ds_read_b128 v[96:99], v8 offset:0
  s_waitcnt vmcnt(7) lgkmcnt(0)
  v_mfma_f32_16x16x32_bf16 v[56:59], v[24:27], v[104:107], v[56:59]
  ds_read_b64_tr_b16 v[40:41], v2 offset:4096
  v_mfma_f32_16x16x32_bf16 v[72:75], v[24:27], v[108:111], v[72:75]
  ds_read_b64_tr_b16 v[42:43], v2 offset:5120
  v_mfma_f32_16x16x32_bf16 v[60:63], v[28:31], v[104:107], v[60:63]
  ds_read_b64_tr_b16 v[44:45], v3 offset:4096
  v_mfma_f32_16x16x32_bf16 v[76:79], v[28:31], v[108:111], v[76:79]
  ds_read_b64_tr_b16 v[46:47], v3 offset:5120
  v_mfma_f32_16x16x32_bf16 v[64:67], v[32:35], v[104:107], v[64:67]
  ds_read_b64_tr_b16 v[48:49], v4 offset:4096
  v_mfma_f32_16x16x32_bf16 v[80:83], v[32:35], v[108:111], v[80:83]
  ds_read_b64_tr_b16 v[50:51], v4 offset:5120
  v_mfma_f32_16x16x32_bf16 v[68:71], v[36:39], v[104:107], v[68:71]
  ds_read_b64_tr_b16 v[52:53], v5 offset:4096
  v_mfma_f32_16x16x32_bf16 v[84:87], v[36:39], v[108:111], v[84:87]
  ds_read_b64_tr_b16 v[54:55], v5 offset:5120
  v_mfma_f32_16x16x32_bf16 v[88:91], v[96:99], v[104:107], v[88:91]
  ds_read_b128 v[100:103], v8 offset:64
  v_mfma_f32_16x16x32_bf16 v[92:95], v[96:99], v[108:111], v[92:95]
  buffer_load_dwordx4 v[104:107], v6, s[12:15], s31 offen sc1
  buffer_load_dwordx4 v[108:111], v7, s[12:15], s31 offen sc1
  s_add_u32 s31, s31, 2048
  s_waitcnt vmcnt(7) lgkmcnt(0)
  s_barrier
  v_mfma_f32_16x16x32_bf16 v[56:59], v[40:43], v[112:115], v[56:59]
  ds_read_b64_tr_b16 v[24:25], v2 offset:16384
  s_add_u32 m0, s51, 0
  v_mfma_f32_16x16x32_bf16 v[72:75], v[40:43], v[116:119], v[72:75]
  ds_read_b64_tr_b16 v[26:27], v2 offset:17408
  buffer_load_dwordx4 v200, s[8:11], s50 offen lds
  v_mfma_f32_16x16x32_bf16 v[60:63], v[44:47], v[112:115], v[60:63]
  ds_read_b64_tr_b16 v[28:29], v3 offset:16384
  s_add_u32 m0, s51, 1024
  v_mfma_f32_16x16x32_bf16 v[76:79], v[44:47], v[116:119], v[76:79]
  ds_read_b64_tr_b16 v[30:31], v3 offset:17408
  buffer_load_dwordx4 v201, s[8:11], s50 offen lds
  v_mfma_f32_16x16x32_bf16 v[64:67], v[48:51], v[112:115], v[64:67]
  ds_read_b64_tr_b16 v[32:33], v4 offset:16384
  s_add_u32 s50, s50, 262144
  v_mfma_f32_16x16x32_bf16 v[80:83], v[48:51], v[116:119], v[80:83]
  ds_read_b64_tr_b16 v[34:35], v4 offset:17408
  v_mfma_f32_16x16x32_bf16 v[68:71], v[52:55], v[112:115], v[68:71]
  ds_read_b64_tr_b16 v[36:37], v5 offset:16384
  v_mfma_f32_16x16x32_bf16 v[84:87], v[52:55], v[116:119], v[84:87]
  ds_read_b64_tr_b16 v[38:39], v5 offset:17408
  v_mfma_f32_16x16x32_bf16 v[88:91], v[100:103], v[112:115], v[88:91]
  ds_read_b128 v[96:99], v8 offset:128
  v_mfma_f32_16x16x32_bf16 v[92:95], v[100:103], v[116:119], v[92:95]
  buffer_load_dwordx4 v[112:115], v6, s[12:15], s31 offen sc1
  buffer_load_dwordx4 v[116:119], v7, s[12:15], s31 offen sc1
  s_add_u32 s31, s31, 6144
  s_waitcnt vmcnt(9) lgkmcnt(0)
  v_mfma_f32_16x16x32_bf16 v[56:59], v[24:27], v[120:123], v[56:59]
  ds_read_b64_tr_b16 v[40:41], v2 offset:20480
  v_mfma_f32_16x16x32_bf16 v[72:75], v[24:27], v[124:127], v[72:75]
  ds_read_b64_tr_b16 v[42:43], v2 offset:21504
  v_mfma_f32_16x16x32_bf16 v[60:63], v[28:31], v[120:123], v[60:63]
  ds_read_b64_tr_b16 v[44:45], v3 offset:20480
  v_mfma_f32_16x16x32_bf16 v[76:79], v[28:31], v[124:127], v[76:79]
  ds_read_b64_tr_b16 v[46:47], v3 offset:21504
  v_mfma_f32_16x16x32_bf16 v[64:67], v[32:35], v[120:123], v[64:67]
  ds_read_b64_tr_b16 v[48:49], v4 offset:20480
  v_mfma_f32_16x16x32_bf16 v[80:83], v[32:35], v[124:127], v[80:83]
  ds_read_b64_tr_b16 v[50:51], v4 offset:21504
  v_mfma_f32_16x16x32_bf16 v[68:71], v[36:39], v[120:123], v[68:71]
  ds_read_b64_tr_b16 v[52:53], v5 offset:20480
  v_mfma_f32_16x16x32_bf16 v[84:87], v[36:39], v[124:127], v[84:87]
  ds_read_b64_tr_b16 v[54:55], v5 offset:21504
  v_mfma_f32_16x16x32_bf16 v[88:91], v[96:99], v[120:123], v[88:91]
  ds_read_b128 v[100:103], v8 offset:192
  v_mfma_f32_16x16x32_bf16 v[92:95], v[96:99], v[124:127], v[92:95]
  buffer_load_dwordx4 v[120:123], v6, s[12:15], s31 offen sc1
  buffer_load_dwordx4 v[124:127], v7, s[12:15], s31 offen sc1
  s_add_u32 s31, s31, 2048
  s_waitcnt vmcnt(9) lgkmcnt(0)
  s_barrier
  v_mfma_f32_16x16x32_bf16 v[56:59], v[40:43], v[128:131], v[56:59]
  ds_read_b64_tr_b16 v[24:25], v2 offset:32768
  s_add_u32 m0, s51, 16384
  v_mfma_f32_16x16x32_bf16 v[72:75], v[40:43], v[132:135], v[72:75]
  ds_read_b64_tr_b16 v[26:27], v2 offset:33792
  buffer_load_dwordx4 v200, s[8:11], s50 offen lds
  v_mfma_f32_16x16x32_bf16 v[60:63], v[44:47], v[128:131], v[60:63]
  ds_read_b64_tr_b16 v[28:29], v3 offset:32768
  s_add_u32 m0, s51, 17408
  v_mfma_f32_16x16x32_bf16 v[76:79], v[44:47], v[132:135], v[76:79]
  ds_read_b64_tr_b16 v[30:31], v3 offset:33792
  buffer_load_dwordx4 v201, s[8:11], s50 offen lds
  v_mfma_f32_16x16x32_bf16 v[64:67], v[48:51], v[128:131], v[64:67]
  ds_read_b64_tr_b16 v[32:33], v4 offset:32768
  s_add_u32 s50, s50, 262144
  v_mfma_f32_16x16x32_bf16 v[80:83], v[48:51], v[132:135], v[80:83]
  ds_read_b64_tr_b16 v[34:35], v4 offset:33792
  v_mfma_f32_16x16x32_bf16 v[68:71], v[52:55], v[128:131], v[68:71]
  ds_read_b64_tr_b16 v[36:37], v5 offset:32768
  v_mfma_f32_16x16x32_bf16 v[84:87], v[52:55], v[132:135], v[84:87]
  ds_read_b64_tr_b16 v[38:39], v5 offset:33792
  v_mfma_f32_16x16x32_bf16 v[88:91], v[100:103], v[128:131], v[88:91]
  ds_read_b128 v[96:99], v8 offset:256
  v_mfma_f32_16x16x32_bf16 v[92:95], v[100:103], v[132:135], v[92:95]
  buffer_load_dwordx4 v[128:131], v6, s[12:15], s31 offen sc1
  buffer_load_dwordx4 v[132:135], v7, s[12:15], s31 offen sc1
  s_add_u32 s31, s31, 6144
  s_waitcnt vmcnt(10) lgkmcnt(0)
  v_mfma_f32_16x16x32_bf16 v[56:59], v[24:27], v[104:107], v[56:59]
  ds_read_b64_tr_b16 v[40:41], v2 offset:36864
  v_mfma_f32_16x16x32_bf16 v[72:75], v[24:27], v[108:111], v[72:75]
  ds_read_b64_tr_b16 v[42:43], v2 offset:37888
  v_mfma_f32_16x16x32_bf16 v[60:63], v[28:31], v[104:107], v[60:63]
  ds_read_b64_tr_b16 v[44:45], v3 offset:36864
  v_mfma_f32_16x16x32_bf16 v[76:79], v[28:31], v[108:111], v[76:79]
  ds_read_b64_tr_b16 v[46:47], v3 offset:37888
  v_mfma_f32_16x16x32_bf16 v[64:67], v[32:35], v[104:107], v[64:67]
  ds_read_b64_tr_b16 v[48:49], v4 offset:36864
  v_mfma_f32_16x16x32_bf16 v[80:83], v[32:35], v[108:111], v[80:83]
  ds_read_b64_tr_b16 v[50:51], v4 offset:37888
  v_mfma_f32_16x16x32_bf16 v[68:71], v[36:39], v[104:107], v[68:71]
  ds_read_b64_tr_b16 v[52:53], v5 offset:36864
  v_mfma_f32_16x16x32_bf16 v[84:87], v[36:39], v[108:111], v[84:87]
  ds_read_b64_tr_b16 v[54:55], v5 offset:37888
  v_mfma_f32_16x16x32_bf16 v[88:91], v[96:99], v[104:107], v[88:91]
  ds_read_b128 v[100:103], v8 offset:320
  v_mfma_f32_16x16x32_bf16 v[92:95], v[96:99], v[108:111], v[92:95]
  buffer_load_dwordx4 v[104:107], v6, s[12:15], s31 offen sc1
  buffer_load_dwordx4 v[108:111], v7, s[12:15], s31 offen sc1
  s_add_u32 s31, s31, 2048
  s_waitcnt vmcnt(8) lgkmcnt(0)
  s_barrier
  v_mfma_f32_16x16x32_bf16 v[56:59], v[40:43], v[112:115], v[56:59]
  ds_read_b64_tr_b16 v[24:25], v2 offset:49152
  s_add_u32 m0, s51, 32768
  v_mfma_f32_16x16x32_bf16 v[72:75], v[40:43], v[116:119], v[72:75]
  ds_read_b64_tr_b16 v[26:27], v2 offset:50176
  buffer_load_dwordx4 v200, s[8:11], s50 offen lds
  v_mfma_f32_16x16x32_bf16 v[60:63], v[44:47], v[112:115], v[60:63]
  ds_read_b64_tr_b16 v[28:29], v3 offset:49152
  s_add_u32 m0, s51, 33792
  v_mfma_f32_16x16x32_bf16 v[76:79], v[44:47], v[116:119], v[76:79]
  ds_read_b64_tr_b16 v[30:31], v3 offset:50176
  buffer_load_dwordx4 v201, s[8:11], s50 offen lds
  v_mfma_f32_16x16x32_bf16 v[64:67], v[48:51], v[112:115], v[64:67]
  ds_read_b64_tr_b16 v[32:33], v4 offset:49152
  s_add_u32 s50, s50, 262144
  v_mfma_f32_16x16x32_bf16 v[80:83], v[48:51], v[116:119], v[80:83]
  ds_read_b64_tr_b16 v[34:35], v4 offset:50176
  v_mfma_f32_16x16x32_bf16 v[68:71], v[52:55], v[112:115], v[68:71]
  ds_read_b64_tr_b16 v[36:37], v5 offset:49152
  v_mfma_f32_16x16x32_bf16 v[84:87], v[52:55], v[116:119], v[84:87]
  ds_read_b64_tr_b16 v[38:39], v5 offset:50176
  v_mfma_f32_16x16x32_bf16 v[88:91], v[100:103], v[112:115], v[88:91]
  ds_read_b128 v[96:99], v8 offset:384
  v_mfma_f32_16x16x32_bf16 v[92:95], v[100:103], v[116:119], v[92:95]
  buffer_load_dwordx4 v[112:115], v6, s[12:15], s31 offen sc1
  buffer_load_dwordx4 v[116:119], v7, s[12:15], s31 offen sc1
  s_add_u32 s31, s31, 6144
  s_waitcnt vmcnt(10) lgkmcnt(0)
  v_mfma_f32_16x16x32_bf16 v[56:59], v[24:27], v[120:123], v[56:59]
  ds_read_b64_tr_b16 v[40:41], v2 offset:53248
  v_mfma_f32_16x16x32_bf16 v[72:75], v[24:27], v[124:127], v[72:75]
  ds_read_b64_tr_b16 v[42:43], v2 offset:54272
  v_mfma_f32_16x16x32_bf16 v[60:63], v[28:31], v[120:123], v[60:63]
  ds_read_b64_tr_b16 v[44:45], v3 offset:53248
  v_mfma_f32_16x16x32_bf16 v[76:79], v[28:31], v[124:127], v[76:79]
  ds_read_b64_tr_b16 v[46:47], v3 offset:54272
  v_mfma_f32_16x16x32_bf16 v[64:67], v[32:35], v[120:123], v[64:67]
  ds_read_b64_tr_b16 v[48:49], v4 offset:53248
  v_mfma_f32_16x16x32_bf16 v[80:83], v[32:35], v[124:127], v[80:83]
  ds_read_b64_tr_b16 v[50:51], v4 offset:54272
  v_mfma_f32_16x16x32_bf16 v[68:71], v[36:39], v[120:123], v[68:71]
  ds_read_b64_tr_b16 v[52:53], v5 offset:53248
  v_mfma_f32_16x16x32_bf16 v[84:87], v[36:39], v[124:127], v[84:87]
  ds_read_b64_tr_b16 v[54:55], v5 offset:54272
  v_mfma_f32_16x16x32_bf16 v[88:91], v[96:99], v[120:123], v[88:91]
  ds_read_b128 v[100:103], v8 offset:448
  v_mfma_f32_16x16x32_bf16 v[92:95], v[96:99], v[124:127], v[92:95]
  buffer_load_dwordx4 v[120:123], v6, s[12:15], s31 offen sc1
  buffer_load_dwordx4 v[124:127], v7, s[12:15], s31 offen sc1
  s_add_u32 s31, s31, 2048
  s_waitcnt vmcnt(8) lgkmcnt(0)
  s_barrier
  v_mfma_f32_16x16x32_bf16 v[56:59], v[40:43], v[128:131], v[56:59]
  ds_read_b64_tr_b16 v[24:25], v2 offset:0
  s_add_u32 m0, s51, 49152
  v_mfma_f32_16x16x32_bf16 v[72:75], v[40:43], v[132:135], v[72:75]
  ds_read_b64_tr_b16 v[26:27], v2 offset:1024
  buffer_load_dwordx4 v200, s[8:11], s50 offen lds
  v_mfma_f32_16x16x32_bf16 v[60:63], v[44:47], v[128:131], v[60:63]
  ds_read_b64_tr_b16 v[28:29], v3 offset:0
  s_add_u32 m0, s51, 50176
  v_mfma_f32_16x16x32_bf16 v[76:79], v[44:47], v[132:135], v[76:79]
  ds_read_b64_tr_b16 v[30:31], v3 offset:1024
  buffer_load_dwordx4 v201, s[8:11], s50 offen lds
  v_mfma_f32_16x16x32_bf16 v[64:67], v[48:51], v[128:131], v[64:67]
  ds_read_b64_tr_b16 v[32:33], v4 offset:0
  s_add_u32 s50, s50, 262144
  v_mfma_f32_16x16x32_bf16 v[80:83], v[48:51], v[132:135], v[80:83]
  ds_read_b64_tr_b16 v[34:35], v4 offset:1024
  v_mfma_f32_16x16x32_bf16 v[68:71], v[52:55], v[128:131], v[68:71]
  ds_read_b64_tr_b16 v[36:37], v5 offset:0
  v_mfma_f32_16x16x32_bf16 v[84:87], v[52:55], v[132:135], v[84:87]
  ds_read_b64_tr_b16 v[38:39], v5 offset:1024
  v_mfma_f32_16x16x32_bf16 v[88:91], v[100:103], v[128:131], v[88:91]
  ds_read_b128 v[96:99], v8 offset:512
  v_mfma_f32_16x16x32_bf16 v[92:95], v[100:103], v[132:135], v[92:95]
  buffer_load_dwordx4 v[128:131], v6, s[12:15], s31 offen sc1
  buffer_load_dwordx4 v[132:135], v7, s[12:15], s31 offen sc1
  s_add_u32 s31, s31, 6144
  s_waitcnt vmcnt(10) lgkmcnt(0)
  v_mfma_f32_16x16x32_bf16 v[56:59], v[24:27], v[104:107], v[56:59]
  ds_read_b64_tr_b16 v[40:41], v2 offset:4096
  v_mfma_f32_16x16x32_bf16 v[72:75], v[24:27], v[108:111], v[72:75]
  ds_read_b64_tr_b16 v[42:43], v2 offset:5120
  v_mfma_f32_16x16x32_bf16 v[60:63], v[28:31], v[104:107], v[60:63]
  ds_read_b64_tr_b16 v[44:45], v3 offset:4096
  v_mfma_f32_16x16x32_bf16 v[76:79], v[28:31], v[108:111], v[76:79]
  ds_read_b64_tr_b16 v[46:47], v3 offset:5120
  v_mfma_f32_16x16x32_bf16 v[64:67], v[32:35], v[104:107], v[64:67]
  ds_read_b64_tr_b16 v[48:49], v4 offset:4096
  v_mfma_f32_16x16x32_bf16 v[80:83], v[32:35], v[108:111], v[80:83]
  ds_read_b64_tr_b16 v[50:51], v4 offset:5120
  v_mfma_f32_16x16x32_bf16 v[68:71], v[36:39], v[104:107], v[68:71]
  ds_read_b64_tr_b16 v[52:53], v5 offset:4096
  v_mfma_f32_16x16x32_bf16 v[84:87], v[36:39], v[108:111], v[84:87]
  ds_read_b64_tr_b16 v[54:55], v5 offset:5120
  v_mfma_f32_16x16x32_bf16 v[88:91], v[96:99], v[104:107], v[88:91]
  ds_read_b128 v[100:103], v8 offset:576
  v_mfma_f32_16x16x32_bf16 v[92:95], v[96:99], v[108:111], v[92:95]
  buffer_load_dwordx4 v[104:107], v6, s[12:15], s31 offen sc1
  buffer_load_dwordx4 v[108:111], v7, s[12:15], s31 offen sc1
  s_add_u32 s31, s31, 2048
  s_waitcnt vmcnt(8) lgkmcnt(0)
  s_barrier
  v_mfma_f32_16x16x32_bf16 v[56:59], v[40:43], v[112:115], v[56:59]
  ds_read_b64_tr_b16 v[24:25], v2 offset:16384
  v_mfma_f32_16x16x32_bf16 v[72:75], v[40:43], v[116:119], v[72:75]
  ds_read_b64_tr_b16 v[26:27], v2 offset:17408
  v_mfma_f32_16x16x32_bf16 v[60:63], v[44:47], v[112:115], v[60:63]
  ds_read_b64_tr_b16 v[28:29], v3 offset:16384
  v_mfma_f32_16x16x32_bf16 v[76:79], v[44:47], v[116:119], v[76:79]
  ds_read_b64_tr_b16 v[30:31], v3 offset:17408
  v_mfma_f32_16x16x32_bf16 v[64:67], v[48:51], v[112:115], v[64:67]
  ds_read_b64_tr_b16 v[32:33], v4 offset:16384
  v_mfma_f32_16x16x32_bf16 v[80:83], v[48:51], v[116:119], v[80:83]
  ds_read_b64_tr_b16 v[34:35], v4 offset:17408
  v_mfma_f32_16x16x32_bf16 v[68:71], v[52:55], v[112:115], v[68:71]
  ds_read_b64_tr_b16 v[36:37], v5 offset:16384
  v_mfma_f32_16x16x32_bf16 v[84:87], v[52:55], v[116:119], v[84:87]
  ds_read_b64_tr_b16 v[38:39], v5 offset:17408
  v_mfma_f32_16x16x32_bf16 v[88:91], v[100:103], v[112:115], v[88:91]
  ds_read_b128 v[96:99], v8 offset:640
  v_mfma_f32_16x16x32_bf16 v[92:95], v[100:103], v[116:119], v[92:95]
  buffer_load_dwordx4 v[112:115], v6, s[12:15], s31 offen sc1
  buffer_load_dwordx4 v[116:119], v7, s[12:15], s31 offen sc1
  s_add_u32 s31, s31, 6144
  s_waitcnt vmcnt(8) lgkmcnt(0)
  v_mfma_f32_16x16x32_bf16 v[56:59], v[24:27], v[120:123], v[56:59]
  ds_read_b64_tr_b16 v[40:41], v2 offset:20480
  v_mfma_f32_16x16x32_bf16 v[72:75], v[24:27], v[124:127], v[72:75]
  ds_read_b64_tr_b16 v[42:43], v2 offset:21504
  v_mfma_f32_16x16x32_bf16 v[60:63], v[28:31], v[120:123], v[60:63]
  ds_read_b64_tr_b16 v[44:45], v3 offset:20480
  v_mfma_f32_16x16x32_bf16 v[76:79], v[28:31], v[124:127], v[76:79]
  ds_read_b64_tr_b16 v[46:47], v3 offset:21504
  v_mfma_f32_16x16x32_bf16 v[64:67], v[32:35], v[120:123], v[64:67]
  ds_read_b64_tr_b16 v[48:49], v4 offset:20480
  v_mfma_f32_16x16x32_bf16 v[80:83], v[32:35], v[124:127], v[80:83]
  ds_read_b64_tr_b16 v[50:51], v4 offset:21504
  v_mfma_f32_16x16x32_bf16 v[68:71], v[36:39], v[120:123], v[68:71]
  ds_read_b64_tr_b16 v[52:53], v5 offset:20480
  v_mfma_f32_16x16x32_bf16 v[84:87], v[36:39], v[124:127], v[84:87]
  ds_read_b64_tr_b16 v[54:55], v5 offset:21504
  v_mfma_f32_16x16x32_bf16 v[88:91], v[96:99], v[120:123], v[88:91]
  ds_read_b128 v[100:103], v8 offset:704
  v_mfma_f32_16x16x32_bf16 v[92:95], v[96:99], v[124:127], v[92:95]
  buffer_load_dwordx4 v[120:123], v6, s[12:15], s31 offen sc1
  buffer_load_dwordx4 v[124:127], v7, s[12:15], s31 offen sc1
  s_add_u32 s31, s31, 2048
  s_waitcnt vmcnt(6) lgkmcnt(0)
  s_barrier
  v_mfma_f32_16x16x32_bf16 v[56:59], v[40:43], v[128:131], v[56:59]
  ds_read_b64_tr_b16 v[24:25], v2 offset:32768
  v_mfma_f32_16x16x32_bf16 v[72:75], v[40:43], v[132:135], v[72:75]
  ds_read_b64_tr_b16 v[26:27], v2 offset:33792
  v_mfma_f32_16x16x32_bf16 v[60:63], v[44:47], v[128:131], v[60:63]
  ds_read_b64_tr_b16 v[28:29], v3 offset:32768
  v_mfma_f32_16x16x32_bf16 v[76:79], v[44:47], v[132:135], v[76:79]
  ds_read_b64_tr_b16 v[30:31], v3 offset:33792
  v_mfma_f32_16x16x32_bf16 v[64:67], v[48:51], v[128:131], v[64:67]
  ds_read_b64_tr_b16 v[32:33], v4 offset:32768
  v_mfma_f32_16x16x32_bf16 v[80:83], v[48:51], v[132:135], v[80:83]
  ds_read_b64_tr_b16 v[34:35], v4 offset:33792
  v_mfma_f32_16x16x32_bf16 v[68:71], v[52:55], v[128:131], v[68:71]
  ds_read_b64_tr_b16 v[36:37], v5 offset:32768
  v_mfma_f32_16x16x32_bf16 v[84:87], v[52:55], v[132:135], v[84:87]
  ds_read_b64_tr_b16 v[38:39], v5 offset:33792
  v_mfma_f32_16x16x32_bf16 v[88:91], v[100:103], v[128:131], v[88:91]
  ds_read_b128 v[96:99], v8 offset:768
  v_mfma_f32_16x16x32_bf16 v[92:95], v[100:103], v[132:135], v[92:95]
  buffer_load_dwordx4 v[128:131], v6, s[12:15], s31 offen sc1
  buffer_load_dwordx4 v[132:135], v7, s[12:15], s31 offen sc1
  s_add_u32 s31, s31, 6144
  s_waitcnt vmcnt(6) lgkmcnt(0)
  v_mfma_f32_16x16x32_bf16 v[56:59], v[24:27], v[104:107], v[56:59]
  ds_read_b64_tr_b16 v[40:41], v2 offset:36864
  s_add_u32 s41, s40, 0
  s_add_u32 m0, s42, 0
  s_nop 0
  buffer_load_dwordx4 v202, s[52:55], s41 offen lds
  v_mfma_f32_16x16x32_bf16 v[72:75], v[24:27], v[108:111], v[72:75]
  ds_read_b64_tr_b16 v[42:43], v2 offset:37888
  s_add_u32 m0, s42, 7168
  s_nop 0
  buffer_load_dwordx4 v202, s[56:59], s41 offen lds
  v_mfma_f32_16x16x32_bf16 v[60:63], v[28:31], v[104:107], v[60:63]
  ds_read_b64_tr_b16 v[44:45], v3 offset:36864
  s_add_u32 s41, s40, 229376
  s_add_u32 m0, s42, 30720
  s_nop 0
  buffer_load_dwordx4 v202, s[52:55], s41 offen lds
  v_mfma_f32_16x16x32_bf16 v[76:79], v[28:31], v[108:111], v[76:79]
  ds_read_b64_tr_b16 v[46:47], v3 offset:37888
  s_add_u32 m0, s42, 37888
  s_nop 0
  buffer_load_dwordx4 v202, s[56:59], s41 offen lds
  v_mfma_f32_16x16x32_bf16 v[64:67], v[32:35], v[104:107], v[64:67]
  ds_read_b64_tr_b16 v[48:49], v4 offset:36864
  s_add_u32 s41, s40, 458752
  s_add_u32 m0, s42, 61440
  s_nop 0
  buffer_load_dwordx4 v202, s[52:55], s41 offen lds
  v_mfma_f32_16x16x32_bf16 v[80:83], v[32:35], v[108:111], v[80:83]
  ds_read_b64_tr_b16 v[50:51], v4 offset:37888
  s_add_u32 m0, s42, 68608
  s_nop 0
  buffer_load_dwordx4 v202, s[56:59], s41 offen lds
  v_mfma_f32_16x16x32_bf16 v[68:71], v[36:39], v[104:107], v[68:71]
  ds_read_b64_tr_b16 v[52:53], v5 offset:36864
  v_mfma_f32_16x16x32_bf16 v[84:87], v[36:39], v[108:111], v[84:87]
  ds_read_b64_tr_b16 v[54:55], v5 offset:37888
  v_mfma_f32_16x16x32_bf16 v[88:91], v[96:99], v[104:107], v[88:91]
  ds_read_b128 v[100:103], v8 offset:832
  v_mfma_f32_16x16x32_bf16 v[92:95], v[96:99], v[108:111], v[92:95]
  s_waitcnt vmcnt(10) lgkmcnt(0)
  s_barrier
  v_mfma_f32_16x16x32_bf16 v[56:59], v[40:43], v[112:115], v[56:59]
  ds_read_b64_tr_b16 v[24:25], v2 offset:49152
  v_mfma_f32_16x16x32_bf16 v[72:75], v[40:43], v[116:119], v[72:75]
  ds_read_b64_tr_b16 v[26:27], v2 offset:50176
  v_mfma_f32_16x16x32_bf16 v[60:63], v[44:47], v[112:115], v[60:63]
  ds_read_b64_tr_b16 v[28:29], v3 offset:49152
  v_mfma_f32_16x16x32_bf16 v[76:79], v[44:47], v[116:119], v[76:79]
  ds_read_b64_tr_b16 v[30:31], v3 offset:50176
  v_mfma_f32_16x16x32_bf16 v[64:67], v[48:51], v[112:115], v[64:67]
  ds_read_b64_tr_b16 v[32:33], v4 offset:49152
  v_mfma_f32_16x16x32_bf16 v[80:83], v[48:51], v[116:119], v[80:83]
  ds_read_b64_tr_b16 v[34:35], v4 offset:50176
  v_mfma_f32_16x16x32_bf16 v[68:71], v[52:55], v[112:115], v[68:71]
  ds_read_b64_tr_b16 v[36:37], v5 offset:49152
  v_mfma_f32_16x16x32_bf16 v[84:87], v[52:55], v[116:119], v[84:87]
  ds_read_b64_tr_b16 v[38:39], v5 offset:50176
  v_mfma_f32_16x16x32_bf16 v[88:91], v[100:103], v[112:115], v[88:91]
  ds_read_b128 v[96:99], v8 offset:896
  v_mfma_f32_16x16x32_bf16 v[92:95], v[100:103], v[116:119], v[92:95]
  s_waitcnt vmcnt(8) lgkmcnt(0)
  v_mfma_f32_16x16x32_bf16 v[56:59], v[24:27], v[120:123], v[56:59]
  ds_read_b64_tr_b16 v[40:41], v2 offset:53248
  v_mfma_f32_16x16x32_bf16 v[72:75], v[24:27], v[124:127], v[72:75]
  ds_read_b64_tr_b16 v[42:43], v2 offset:54272
  v_mfma_f32_16x16x32_bf16 v[60:63], v[28:31], v[120:123], v[60:63]
  ds_read_b64_tr_b16 v[44:45], v3 offset:53248
  v_mfma_f32_16x16x32_bf16 v[76:79], v[28:31], v[124:127], v[76:79]
  ds_read_b64_tr_b16 v[46:47], v3 offset:54272
  v_mfma_f32_16x16x32_bf16 v[64:67], v[32:35], v[120:123], v[64:67]
  ds_read_b64_tr_b16 v[48:49], v4 offset:53248
  v_mfma_f32_16x16x32_bf16 v[80:83], v[32:35], v[124:127], v[80:83]
  ds_read_b64_tr_b16 v[50:51], v4 offset:54272
  v_mfma_f32_16x16x32_bf16 v[68:71], v[36:39], v[120:123], v[68:71]
  ds_read_b64_tr_b16 v[52:53], v5 offset:53248
  v_mfma_f32_16x16x32_bf16 v[84:87], v[36:39], v[124:127], v[84:87]
  ds_read_b64_tr_b16 v[54:55], v5 offset:54272
  v_mfma_f32_16x16x32_bf16 v[88:91], v[96:99], v[120:123], v[88:91]
  ds_read_b128 v[100:103], v8 offset:960
  v_mfma_f32_16x16x32_bf16 v[92:95], v[96:99], v[124:127], v[92:95]
  s_waitcnt vmcnt(6) lgkmcnt(0)
  v_mfma_f32_16x16x32_bf16 v[56:59], v[40:43], v[128:131], v[56:59]
  v_mfma_f32_16x16x32_bf16 v[72:75], v[40:43], v[132:135], v[72:75]
  v_mfma_f32_16x16x32_bf16 v[60:63], v[44:47], v[128:131], v[60:63]
  v_mfma_f32_16x16x32_bf16 v[76:79], v[44:47], v[132:135], v[76:79]
  v_mfma_f32_16x16x32_bf16 v[64:67], v[48:51], v[128:131], v[64:67]
  v_mfma_f32_16x16x32_bf16 v[80:83], v[48:51], v[132:135], v[80:83]
  v_mfma_f32_16x16x32_bf16 v[68:71], v[52:55], v[128:131], v[68:71]
  v_mfma_f32_16x16x32_bf16 v[84:87], v[52:55], v[132:135], v[84:87]
  v_mfma_f32_16x16x32_bf16 v[88:91], v[100:103], v[128:131], v[88:91]
  v_mfma_f32_16x16x32_bf16 v[92:95], v[100:103], v[132:135], v[92:95]
  s_and_b32 s27, s20, 3
  s_lshl_b32 s27, s27, 12
  s_mul_i32 s28, s26, 30720
  s_add_u32 s27, s27, s28
  s_add_u32 s27, s27, 14336
  v_lshlrev_b32 v12, 4, v1
  v_add_u32 v13, s27, v12
  s_and_b32 s27, s20, 3
  s_lshl_b32 s27, s27, 12
  s_xor_b32 s28, s26, 1
  s_mul_i32 s28, s28, 30720
  s_add_u32 s27, s27, s28
  s_add_u32 s27, s27, 14336
  v_add_u32 v14, s27, v12
  s_lshl_b32 s27, s20, 8
  s_add_u32 s27, s27, 83968
  v_lshl_add_u32 v8, v1, 2, s27
  ds_write_b32 v8, v92
  v_xor_b32 v8, 1024, v8
  ds_write_b128 v13, v[72:75] offset:0
  ds_write_b128 v13, v[76:79] offset:1024
  ds_write_b128 v13, v[80:83] offset:2048
  ds_write_b128 v13, v[84:87] offset:3072
  s_waitcnt lgkmcnt(0)
  s_barrier
  ds_read_b128 v[72:75], v14 offset:0
  ds_read_b128 v[76:79], v14 offset:1024
  ds_read_b128 v[80:83], v14 offset:2048
  ds_read_b128 v[84:87], v14 offset:3072
  ds_read_b32 v92, v8
  s_add_u32 s41, s40, 688128
  s_add_u32 m0, s42, 92160
  s_nop 0
  buffer_load_dwordx4 v202, s[52:55], s41 offen lds
  s_add_u32 m0, s42, 99328
  s_nop 0
  buffer_load_dwordx4 v202, s[56:59], s41 offen lds
  s_waitcnt lgkmcnt(0)
  v_add_f32 v56, v56, v72
  v_add_f32 v57, v57, v73
  v_add_f32 v58, v58, v74
  v_add_f32 v59, v59, v75
  v_add_f32 v60, v60, v76
  v_add_f32 v61, v61, v77
  v_add_f32 v62, v62, v78
  v_add_f32 v63, v63, v79
  v_add_f32 v64, v64, v80
  v_add_f32 v65, v65, v81
  v_add_f32 v66, v66, v82
  v_add_f32 v67, v67, v83
  v_add_f32 v68, v68, v84
  v_add_f32 v69, v69, v85
  v_add_f32 v70, v70, v86
  v_add_f32 v71, v71, v87
  v_permlane16_swap_b32 v56, v60
  v_permlane16_swap_b32 v57, v61
  v_permlane16_swap_b32 v58, v62
  v_permlane16_swap_b32 v59, v63
  v_permlane16_swap_b32 v64, v68
  v_permlane16_swap_b32 v65, v69
  v_permlane16_swap_b32 v66, v70
  v_permlane16_swap_b32 v67, v71
  v_mov_b32 v12, 0xffff0000
  s_waitcnt vmcnt(8)
  v_add_f32 v88, v88, v92
  v_add_f32 v88, v88, v15
  v_sub_f32 v88, 0, v88
  v_lshlrev_b32 v24, 16, v16
  v_and_b32 v25, v12, v16
  v_lshlrev_b32 v26, 16, v17
  v_and_b32 v27, v12, v17
  v_lshlrev_b32 v28, 16, v18
  v_and_b32 v29, v12, v18
  v_lshlrev_b32 v30, 16, v19
  v_and_b32 v31, v12, v19
  v_add_f32 v56, v56, v24
  v_add_f32 v57, v57, v25
  v_add_f32 v58, v58, v26
  v_add_f32 v59, v59, v27
  v_add_f32 v60, v60, v28
  v_add_f32 v61, v61, v29
  v_add_f32 v62, v62, v30
  v_add_f32 v63, v63, v31
  v_cvt_pk_bf16_f32 v16, v56, v57
  v_cvt_pk_bf16_f32 v17, v58, v59
  v_cvt_pk_bf16_f32 v18, v60, v61
  v_cvt_pk_bf16_f32 v19, v62, v63
  ds_write_b128 v9, v[16:19] offset:0
  v_add_f32 v56, v56, v88
  v_add_f32 v57, v57, v88
  v_add_f32 v58, v58, v88
  v_add_f32 v59, v59, v88
  v_add_f32 v60, v60, v88
  v_add_f32 v61, v61, v88
  v_add_f32 v62, v62, v88
  v_add_f32 v63, v63, v88
  v_cvt_pk_bf16_f32 v32, v56, v57
  v_cvt_pk_bf16_f32 v33, v58, v59
  v_cvt_pk_bf16_f32 v34, v60, v61
  v_cvt_pk_bf16_f32 v35, v62, v63
  buffer_store_dwordx4 v[32:35], v11, s[12:15], s34 offen offset:0 sc1
  v_lshlrev_b32 v24, 16, v20
  v_and_b32 v25, v12, v20
  v_lshlrev_b32 v26, 16, v21
  v_and_b32 v27, v12, v21
  v_lshlrev_b32 v28, 16, v22
  v_and_b32 v29, v12, v22
  v_lshlrev_b32 v30, 16, v23
  v_and_b32 v31, v12, v23
  v_add_f32 v64, v64, v24
  v_add_f32 v65, v65, v25
  v_add_f32 v66, v66, v26
  v_add_f32 v67, v67, v27
  v_add_f32 v68, v68, v28
  v_add_f32 v69, v69, v29
  v_add_f32 v70, v70, v30
  v_add_f32 v71, v71, v31
  v_cvt_pk_bf16_f32 v20, v64, v65
  v_cvt_pk_bf16_f32 v21, v66, v67
  v_cvt_pk_bf16_f32 v22, v68, v69
  v_cvt_pk_bf16_f32 v23, v70, v71
  ds_write_b128 v9, v[20:23] offset:1024
  v_add_f32 v64, v64, v88
  v_add_f32 v65, v65, v88
  v_add_f32 v66, v66, v88
  v_add_f32 v67, v67, v88
  v_add_f32 v68, v68, v88
  v_add_f32 v69, v69, v88
  v_add_f32 v70, v70, v88
  v_add_f32 v71, v71, v88
  v_cvt_pk_bf16_f32 v36, v64, v65
  v_cvt_pk_bf16_f32 v37, v66, v67
  v_cvt_pk_bf16_f32 v38, v68, v69
  v_cvt_pk_bf16_f32 v39, v70, v71
  buffer_store_dwordx4 v[36:39], v11, s[12:15], s34 offen offset:2048 sc1
  v_mul_f32 v24, v56, v56
  v_mul_f32 v25, v57, v57
  v_mul_f32 v26, v58, v58
  v_mul_f32 v27, v59, v59
  v_fma_f32 v24, v60, v60, v24
  v_fma_f32 v25, v61, v61, v25
  v_fma_f32 v26, v62, v62, v26
  v_fma_f32 v27, v63, v63, v27
  v_fma_f32 v24, v64, v64, v24
  v_fma_f32 v25, v65, v65, v25
  v_fma_f32 v26, v66, v66, v26
  v_fma_f32 v27, v67, v67, v27
  v_fma_f32 v24, v68, v68, v24
  v_fma_f32 v25, v69, v69, v25
  v_fma_f32 v26, v70, v70, v26
  v_fma_f32 v27, v71, v71, v27
  v_add_f32 v24, v24, v25
  v_add_f32 v26, v26, v27
  v_add_f32 v24, v24, v26
  v_mov_b32 v26, v24
  s_nop 1
  v_permlane16_swap_b32 v24, v26
  v_add_f32 v24, v24, v26
  v_mov_b32 v26, v24
  s_nop 1
  v_permlane32_swap_b32 v24, v26
  v_add_f32 v24, v24, v26
  v_and_b32 v12, 15, v1
  v_lshlrev_b32 v12, 2, v12
  s_lshl_b32 s27, s35, 2
  s_lshl_b32 s28, s24, 13
  s_add_u32 s27, s27, s28
  s_add_u32 s27, s27, 39845888
  s_mov_b64 exec, 0xffff
  buffer_store_dword v24, v12, s[12:15], s27 offen sc1
  s_mov_b64 exec, -1
  s_lshr_b32 s27, s23, 1
  s_lshl_b32 s27, s27, 7
  s_add_u32 s27, s27, 41683968
  s_waitcnt lgkmcnt(0)
  s_waitcnt vmcnt(0)
  s_barrier
  s_cmp_lg_u32 s20, 0
  s_cbranch_scc1 L_nosig_27
  s_mov_b64 exec, 1
  v_mov_b32 v16, 1
  v_mov_b32 v17, 0
  buffer_atomic_add v16, v17, s[12:15], s27 offen sc1
  s_mov_b64 exec, -1
L_nosig_27:
  s_and_b32 s21, s2, 7
  s_lshr_b32 s22, s2, 3
  s_and_b32 s27, s21, 3
  s_lshl_b32 s27, s27, 2
  s_and_b32 s28, s22, 3
  s_add_u32 s27, s27, s28
  s_lshr_b32 s29, s21, 2
  s_lshl_b32 s29, s29, 3
  s_lshr_b32 s28, s22, 2
  s_add_u32 s29, s29, s28
  v_lshrrev_b32 v12, 3, v1
  v_and_b32 v13, 7, v1
  v_lshrrev_b32 v14, 2, v12
  v_and_b32 v15, 3, v12
  v_lshl_add_u32 v14, v14, 3, v15
  v_mul_u32_u24 v14, 128, v14
  v_lshrrev_b32 v15, 1, v13
  v_lshrrev_b32 v12, 1, v12
  v_xor_b32 v15, v15, v12
  v_and_b32 v13, 1, v13
  v_lshl_add_u32 v15, v15, 1, v13
  v_lshl_add_u32 v240, v15, 4, v14
  v_add_u32 v241, 512, v240
  s_lshr_b32 s27, s20, 1
  s_lshl_b32 s27, s27, 5
  s_and_b32 s28, s20, 1
  s_lshl_b32 s28, s28, 4
  s_add_u32 s27, s27, s28
  s_and_b32 s27, s20, 3
  s_lshl_b32 s27, s27, 4
  s_and_b32 s28, s29, 1
  s_mul_i32 s28, s28, 1792
  s_add_u32 s27, s27, s28
  s_lshr_b32 s28, s20, 2
  s_xor_b32 s28, s28, 1
  s_xor_b32 s29, s29, s28
  s_lshl_b32 s50, s27, 7
  s_mul_i32 s28, s29, 458752
  s_add_u32 s50, s50, s28
  s_add_u32 s50, s50, 50331648
  s_lshl_b32 s51, s20, 11
  s_and_b32 s21, s2, 7
  s_lshr_b32 s22, s2, 3
  s_and_b32 s23, s21, 1
  s_lshl_b32 s23, s23, 2
  s_and_b32 s25, s22, 3
  s_add_u32 s23, s23, s25
  s_lshr_b32 s24, s21, 1
  s_lshl_b32 s24, s24, 3
  s_lshr_b32 s25, s22, 2
  s_add_u32 s24, s24, s25
  s_and_b32 s25, s20, 3
  s_lshr_b32 s26, s20, 2
  v_lshlrev_b32 v11, 4, v1
  v_lshrrev_b32 v12, 4, v1
  v_bfe_u32 v13, v1, 2, 2
  v_lshrrev_b32 v14, 1, v12
  v_and_b32 v15, 1, v12
  v_lshlrev_b32 v14, 4, v14
  v_lshl_add_u32 v14, v15, 2, v14
  v_add_u32 v14, v14, v13
  v_mul_u32_u24 v14, 224, v14
  v_and_b32 v15, 3, v1
  v_lshl_add_u32 v14, v15, 3, v14
  s_lshl_b32 s27, s26, 7
  v_add_u32 v2, s27, v14
  v_add_u32 v3, 61440, v2
  v_and_b32 v13, 15, v1
  v_lshlrev_b32 v13, 4, v13
  v_lshl_add_u32 v13, v12, 9, v13
  s_lshl_b32 s27, s25, 12
  s_add_u32 s27, s27, 14336
  v_add_u32 v4, s27, v13
  v_add_u32 v5, 61440, v4
  s_lshl_b32 s31, s23, 19
  s_add_u32 s31, s31, 20971520
  s_mul_i32 s30, s24, 224
  s_add_u32 s30, s30, 917504
  v_mov_b32 v112, 0
  v_mov_b32 v113, 0
  v_mov_b32 v114, 0
  v_mov_b32 v115, 0
  v_mov_b32 v116, 0
  v_mov_b32 v117, 0
  v_mov_b32 v118, 0
  v_mov_b32 v119, 0
  v_mov_b32 v120, 0
  v_mov_b32 v121, 0
  v_mov_b32 v122, 0
  v_mov_b32 v123, 0
  v_mov_b32 v124, 0
  v_mov_b32 v125, 0
  v_mov_b32 v126, 0
  v_mov_b32 v127, 0
  v_mov_b32 v128, 0
  v_mov_b32 v129, 0
  v_mov_b32 v130, 0
  v_mov_b32 v131, 0
  v_mov_b32 v132, 0
  v_mov_b32 v133, 0
  v_mov_b32 v134, 0
  v_mov_b32 v135, 0
  v_mov_b32 v136, 0
  v_mov_b32 v137, 0
  v_mov_b32 v138, 0
  v_mov_b32 v139, 0
  v_mov_b32 v140, 0
  v_mov_b32 v141, 0
  v_mov_b32 v142, 0
  v_mov_b32 v143, 0
  v_mov_b32 v144, 0
  v_mov_b32 v145, 0
  v_mov_b32 v146, 0
  v_mov_b32 v147, 0
  v_mov_b32 v148, 0
  v_mov_b32 v149, 0
  v_mov_b32 v150, 0
  v_mov_b32 v151, 0
  v_mov_b32 v152, 0
  v_mov_b32 v153, 0
  v_mov_b32 v154, 0
  v_mov_b32 v155, 0
  v_mov_b32 v156, 0
  v_mov_b32 v157, 0
  v_mov_b32 v158, 0
  v_mov_b32 v159, 0
  v_mov_b32 v160, 0
  v_mov_b32 v161, 0
  v_mov_b32 v162, 0
  v_mov_b32 v163, 0
  v_mov_b32 v164, 0
  v_mov_b32 v165, 0
  v_mov_b32 v166, 0
  v_mov_b32 v167, 0
  v_mov_b32 v168, 0
  v_mov_b32 v169, 0
  v_mov_b32 v170, 0
  v_mov_b32 v171, 0
  v_mov_b32 v172, 0
  v_mov_b32 v173, 0
  v_mov_b32 v174, 0
  v_mov_b32 v175, 0
  v_mov_b32 v176, 0
  v_mov_b32 v177, 0
  v_mov_b32 v178, 0
  v_mov_b32 v179, 0
  v_mov_b32 v180, 0
  v_mov_b32 v181, 0
  v_mov_b32 v182, 0
  v_mov_b32 v183, 0
  v_mov_b32 v184, 0
  v_mov_b32 v185, 0
  v_mov_b32 v186, 0
  v_mov_b32 v187, 0
  v_mov_b32 v188, 0
  v_mov_b32 v189, 0
  v_mov_b32 v190, 0
  v_mov_b32 v191, 0
  v_mov_b32 v192, 0
  v_mov_b32 v193, 0
  v_mov_b32 v194, 0
  v_mov_b32 v195, 0
  v_mov_b32 v196, 0
  v_mov_b32 v197, 0
  v_mov_b32 v198, 0
  v_mov_b32 v199, 0
  v_mov_b32 v200, 0
  v_mov_b32 v201, 0
  v_mov_b32 v202, 0
  v_mov_b32 v203, 0
  v_mov_b32 v204, 0
  v_mov_b32 v205, 0
  v_mov_b32 v206, 0
  v_mov_b32 v207, 0
  v_mov_b32 v208, 0
  v_mov_b32 v209, 0
  v_mov_b32 v210, 0
  v_mov_b32 v211, 0
  v_mov_b32 v212, 0
  v_mov_b32 v213, 0
  v_mov_b32 v214, 0
  v_mov_b32 v215, 0
  v_mov_b32 v216, 0
  v_mov_b32 v217, 0
  v_mov_b32 v218, 0
  v_mov_b32 v219, 0
  v_mov_b32 v220, 0
  v_mov_b32 v221, 0
  v_mov_b32 v222, 0
  v_mov_b32 v223, 0
  v_mov_b32 v224, 0
  v_mov_b32 v225, 0
  v_mov_b32 v226, 0
  v_mov_b32 v227, 0
  v_mov_b32 v228, 0
  v_mov_b32 v229, 0
  v_mov_b32 v230, 0
  v_mov_b32 v231, 0
  v_mov_b32 v232, 0
  v_mov_b32 v233, 0
  v_mov_b32 v234, 0
  v_mov_b32 v235, 0
  v_mov_b32 v236, 0
  v_mov_b32 v237, 0
  v_mov_b32 v238, 0
  v_mov_b32 v239, 0
  v_lshrrev_b32 v12, 5, v1
  v_lshlrev_b32 v12, 16, v12
  v_and_b32 v13, 31, v1
  s_lshl_b32 s27, s20, 5
  v_add_u32 v13, s27, v13
  v_lshl_add_u32 v250, v13, 2, v12
  v_lshlrev_b32 v251, 4, v13
  v_add_u32 v251, 122880, v251
  s_lshl_b32 s37, s23, 10
  s_add_u32 s37, s37, 39845888
  s_bitcmp1_b32 s25, 1
  s_cselect_b32 s4, s74, s72
  s_cselect_b32 s5, s75, s73
  s_mov_b32 s8, s4
  s_mov_b32 s9, s5
  s_mov_b32 s10, 0x700000
  s_mov_b32 s11, 0x20000
  s_cmp_eq_u32 s26, 0
  s_cbranch_scc0 L_p4setB_28
  s_mul_i32 s27, s20, 3
  s_add_u32 s27, s27, 0
  s_lshr_b32 s28, s27, 1
  s_lshl_b32 s28, s28, 16
  s_and_b32 s29, s27, 1
  s_lshl_b32 s29, s29, 10
  s_add_u32 s28, s28, s29
  v_add_u32 v6, s28, v11
  s_mul_i32 s27, s20, 3
  s_add_u32 s27, s27, 1
  s_lshr_b32 s28, s27, 1
  s_lshl_b32 s28, s28, 16
  s_and_b32 s29, s27, 1
  s_lshl_b32 s29, s29, 10
  s_add_u32 s28, s28, s29
  v_add_u32 v7, s28, v11
  s_mul_i32 s27, s20, 3
  s_add_u32 s27, s27, 2
  s_lshr_b32 s28, s27, 1
  s_lshl_b32 s28, s28, 16
  s_and_b32 s29, s27, 1
  s_lshl_b32 s29, s29, 10
  s_add_u32 s28, s28, s29
  v_add_u32 v8, s28, v11
  s_mul_i32 s32, s20, 3072
  s_add_u32 s32, s32, 14336
  s_branch L_p4setD_29
L_p4setB_28:
  s_and_b32 s27, s25, 1
  s_lshl_b32 s27, s27, 8
  v_add_u32 v15, 0, v1
  v_add_u32 v15, s27, v15
  v_mul_u32_u24 v12, 4682, v15
  v_lshrrev_b32 v12, 16, v12
  v_mul_u32_u24 v13, 14, v12
  v_sub_u32 v13, v15, v13
  v_and_b32 v14, 0x33, v12
  v_bfe_u32 v15, v12, 2, 1
  v_lshl_add_u32 v14, v15, 3, v14
  v_bfe_u32 v15, v12, 3, 1
  v_lshl_add_u32 v14, v15, 2, v14
  v_mul_u32_u24 v14, 7168, v14
  v_lshl_add_u32 v6, v13, 4, v14
  v_add_u32 v15, 64, v1
  v_add_u32 v15, s27, v15
  v_mul_u32_u24 v12, 4682, v15
  v_lshrrev_b32 v12, 16, v12
  v_mul_u32_u24 v13, 14, v12
  v_sub_u32 v13, v15, v13
  v_and_b32 v14, 0x33, v12
  v_bfe_u32 v15, v12, 2, 1
  v_lshl_add_u32 v14, v15, 3, v14
  v_bfe_u32 v15, v12, 3, 1
  v_lshl_add_u32 v14, v15, 2, v14
  v_mul_u32_u24 v14, 7168, v14
  v_lshl_add_u32 v7, v13, 4, v14
  v_add_u32 v15, 128, v1
  v_add_u32 v15, s27, v15
  v_mul_u32_u24 v12, 4682, v15
  v_lshrrev_b32 v12, 16, v12
  v_mul_u32_u24 v13, 14, v12
  v_sub_u32 v13, v15, v13
  v_and_b32 v14, 0x33, v12
  v_bfe_u32 v15, v12, 2, 1
  v_lshl_add_u32 v14, v15, 3, v14
  v_bfe_u32 v15, v12, 3, 1
  v_lshl_add_u32 v14, v15, 2, v14
  v_mul_u32_u24 v14, 7168, v14
  v_lshl_add_u32 v8, v13, 4, v14
  v_add_u32 v15, 192, v1
  v_add_u32 v15, s27, v15
  v_mul_u32_u24 v12, 4682, v15
  v_lshrrev_b32 v12, 16, v12
  v_mul_u32_u24 v13, 14, v12
  v_sub_u32 v13, v15, v13
  v_and_b32 v14, 0x33, v12
  v_bfe_u32 v15, v12, 2, 1
  v_lshl_add_u32 v14, v15, 3, v14
  v_bfe_u32 v15, v12, 3, 1
  v_lshl_add_u32 v14, v15, 2, v14
  v_mul_u32_u24 v14, 7168, v14
  v_lshl_add_u32 v9, v13, 4, v14
  s_add_u32 s27, s25, 12
  s_lshr_b32 s28, s27, 1
  s_lshl_b32 s28, s28, 16
  s_and_b32 s29, s27, 1
  s_lshl_b32 s29, s29, 10
  s_add_u32 s28, s28, s29
  v_add_u32 v10, s28, v11
  s_lshl_b32 s33, s27, 10
  s_add_u32 s33, s33, 14336
  s_lshr_b32 s32, s25, 1
  s_mul_i32 s32, s32, 7168
  s_and_b32 s27, s25, 1
  s_lshl_b32 s27, s27, 12
  s_add_u32 s32, s32, s27
L_p4setD_29:
  s_lshl_b32 s27, s23, 3
  s_lshl_b32 s28, s25, 1
  s_add_u32 s27, s27, s28
  s_mul_i32 s27, s27, 448
  s_mul_i32 s28, s24, 14
  s_add_u32 s27, s27, s28
  s_lshl_b32 s28, s26, 3
  s_add_u32 s27, s27, s28
  s_lshl_b32 s27, s27, 9
  s_add_u32 s34, s27, 25165824
  s_add_u32 s35, s34, 229376
  v_add_u32 v13, 15, v1
  v_lshlrev_b32 v13, 7, v13
  s_lshl_b32 s27, s23, 7
  s_add_u32 s27, s27, 3072
  s_nop 0
  v_writelane_b32 v13, s27, 0
  s_mov_b32 s27, 41680896
  s_cmp_lg_u32 s20, 0
  s_cbranch_scc1 L_wdone_30
  s_mov_b64 exec, 0x1ff
  s_mov_b32 s28, 0
L_wspin_31:
  buffer_load_dword v12, v13, s[12:15], s27 offen sc1
  s_add_u32 s28, s28, 1
  s_waitcnt vmcnt(0)
  v_cmp_ne_u32 vcc, 32, v12
  s_cmp_eq_u64 vcc, 0
  s_cbranch_scc1 L_wdx_32
  s_cmp_gt_u32 s28, 262144
  s_cbranch_scc1 L_wdx_32
  s_sleep 1
  s_branch L_wspin_31
L_wdx_32:
  s_mov_b64 exec, -1
L_wdone_30:
  s_barrier
  s_cmp_eq_u32 s26, 0
  s_cbranch_scc0 L_p4B_34
  s_add_u32 m0, s32, 0
  s_nop 0
  buffer_load_dwordx4 v6, s[12:15], s31 offen sc1 lds
  s_add_u32 m0, s32, 1024
  s_nop 0
  buffer_load_dwordx4 v7, s[12:15], s31 offen sc1 lds
  s_add_u32 m0, s32, 2048
  s_nop 0
  buffer_load_dwordx4 v8, s[12:15], s31 offen sc1 lds
  s_add_u32 s31, s31, 2048
  s_add_u32 m0, s32, 30720
  s_nop 0
  buffer_load_dwordx4 v6, s[12:15], s31 offen sc1 lds
  s_add_u32 m0, s32, 31744
  s_nop 0
  buffer_load_dwordx4 v7, s[12:15], s31 offen sc1 lds
  s_add_u32 m0, s32, 32768
  s_nop 0
  buffer_load_dwordx4 v8, s[12:15], s31 offen sc1 lds
  s_add_u32 s31, s31, 2048
  s_add_u32 m0, s32, 61440
  s_nop 0
  buffer_load_dwordx4 v6, s[12:15], s31 offen sc1 lds
  s_add_u32 m0, s32, 62464
  s_nop 0
  buffer_load_dwordx4 v7, s[12:15], s31 offen sc1 lds
  s_add_u32 m0, s32, 63488
  s_nop 0
  buffer_load_dwordx4 v8, s[12:15], s31 offen sc1 lds
  s_add_u32 s31, s31, 2048
  s_add_u32 m0, s32, 92160
  s_nop 0
  buffer_load_dwordx4 v6, s[12:15], s31 offen sc1 lds
  s_add_u32 m0, s32, 93184
  s_nop 0
  buffer_load_dwordx4 v7, s[12:15], s31 offen sc1 lds
  s_add_u32 m0, s32, 94208
  s_nop 0
  buffer_load_dwordx4 v8, s[12:15], s31 offen sc1 lds
  s_add_u32 s31, s31, 2048
  s_mov_b32 s28, s37
  buffer_load_dword v242, v250, s[12:15], s28 offen sc1
  s_add_u32 s28, s28, 8192
  buffer_load_dword v243, v250, s[12:15], s28 offen sc1
  s_add_u32 s28, s28, 8192
  buffer_load_dword v244, v250, s[12:15], s28 offen sc1
  s_add_u32 s28, s28, 8192
  buffer_load_dword v245, v250, s[12:15], s28 offen sc1
  s_add_u32 s28, s28, 8192
  buffer_load_dword v246, v250, s[12:15], s28 offen sc1
  s_add_u32 s28, s28, 8192
  buffer_load_dword v247, v250, s[12:15], s28 offen sc1
  s_add_u32 s28, s28, 8192
  buffer_load_dword v248, v250, s[12:15], s28 offen sc1
  s_add_u32 s28, s28, 8192
  buffer_load_dword v249, v250, s[12:15], s28 offen sc1
  s_waitcnt vmcnt(17)
  s_barrier
  ds_read_b64_tr_b16 v[16:17], v2 offset:0
  ds_read_b64_tr_b16 v[18:19], v2 offset:1792
  ds_read_b128 v[80:83], v4 offset:0
  ds_read_b128 v[84:87], v4 offset:256
  ds_read_b128 v[88:91], v4 offset:2048
  ds_read_b128 v[92:95], v4 offset:2304
  ds_read_b64_tr_b16 v[20:21], v2 offset:7168
  ds_read_b64_tr_b16 v[22:23], v2 offset:8960
  ds_read_b64_tr_b16 v[24:25], v2 offset:32
  ds_read_b64_tr_b16 v[26:27], v2 offset:1824
  ds_read_b64_tr_b16 v[28:29], v2 offset:7200
  ds_read_b64_tr_b16 v[30:31], v2 offset:8992
  ds_read_b64_tr_b16 v[32:33], v2 offset:64
  ds_read_b64_tr_b16 v[34:35], v2 offset:1856
  ds_read_b64_tr_b16 v[36:37], v2 offset:7232
  ds_read_b64_tr_b16 v[38:39], v2 offset:9024
  ds_read_b64_tr_b16 v[40:41], v2 offset:96
  ds_read_b64_tr_b16 v[42:43], v2 offset:1888
  ds_read_b64_tr_b16 v[44:45], v2 offset:7264
  ds_read_b64_tr_b16 v[46:47], v2 offset:9056
  s_waitcnt vmcnt(14) lgkmcnt(0)
  s_barrier
  v_mfma_f32_16x16x32_bf16 v[112:115], v[16:19], v[80:83], v[112:115]
  ds_read_b64_tr_b16 v[48:49], v2 offset:30720
  v_mfma_f32_16x16x32_bf16 v[116:119], v[16:19], v[84:87], v[116:119]
  ds_read_b64_tr_b16 v[50:51], v2 offset:32512
  s_add_u32 m0, s32, 0
  v_mfma_f32_16x16x32_bf16 v[120:123], v[16:19], v[88:91], v[120:123]
  ds_read_b128 v[96:99], v4 offset:30720
  buffer_load_dwordx4 v6, s[12:15], s31 offen sc1 lds
  v_mfma_f32_16x16x32_bf16 v[124:127], v[16:19], v[92:95], v[124:127]
  ds_read_b128 v[100:103], v4 offset:30976
  v_mfma_f32_16x16x32_bf16 v[128:131], v[20:23], v[80:83], v[128:131]
  ds_read_b128 v[104:107], v4 offset:32768
  v_mfma_f32_16x16x32_bf16 v[132:135], v[20:23], v[84:87], v[132:135]
  ds_read_b128 v[108:111], v4 offset:33024
  v_mfma_f32_16x16x32_bf16 v[136:139], v[20:23], v[88:91], v[136:139]
  ds_read_b64_tr_b16 v[52:53], v2 offset:37888
  v_mfma_f32_16x16x32_bf16 v[140:143], v[20:23], v[92:95], v[140:143]
  ds_read_b64_tr_b16 v[54:55], v2 offset:39680
  v_mfma_f32_16x16x32_bf16 v[144:147], v[24:27], v[80:83], v[144:147]
  ds_read_b64_tr_b16 v[56:57], v2 offset:30752
  v_mfma_f32_16x16x32_bf16 v[148:151], v[24:27], v[84:87], v[148:151]
  ds_read_b64_tr_b16 v[58:59], v2 offset:32544
  v_mfma_f32_16x16x32_bf16 v[152:155], v[24:27], v[88:91], v[152:155]
  ds_read_b64_tr_b16 v[60:61], v2 offset:37920
  s_add_u32 m0, s32, 1024
  v_mfma_f32_16x16x32_bf16 v[156:159], v[24:27], v[92:95], v[156:159]
  ds_read_b64_tr_b16 v[62:63], v2 offset:39712
  buffer_load_dwordx4 v7, s[12:15], s31 offen sc1 lds
  v_mfma_f32_16x16x32_bf16 v[160:163], v[28:31], v[80:83], v[160:163]
  ds_read_b64_tr_b16 v[64:65], v2 offset:30784
  v_mfma_f32_16x16x32_bf16 v[164:167], v[28:31], v[84:87], v[164:167]
  ds_read_b64_tr_b16 v[66:67], v2 offset:32576
  v_mfma_f32_16x16x32_bf16 v[168:171], v[28:31], v[88:91], v[168:171]
  ds_read_b64_tr_b16 v[68:69], v2 offset:37952
  v_mfma_f32_16x16x32_bf16 v[172:175], v[28:31], v[92:95], v[172:175]
  ds_read_b64_tr_b16 v[70:71], v2 offset:39744
  v_mfma_f32_16x16x32_bf16 v[176:179], v[32:35], v[80:83], v[176:179]
  ds_read_b64_tr_b16 v[72:73], v2 offset:30816
  v_mfma_f32_16x16x32_bf16 v[180:183], v[32:35], v[84:87], v[180:183]
  ds_read_b64_tr_b16 v[74:75], v2 offset:32608
  v_mfma_f32_16x16x32_bf16 v[184:187], v[32:35], v[88:91], v[184:187]
  ds_read_b64_tr_b16 v[76:77], v2 offset:37984
  v_mfma_f32_16x16x32_bf16 v[188:191], v[32:35], v[92:95], v[188:191]
  ds_read_b64_tr_b16 v[78:79], v2 offset:39776
  s_add_u32 m0, s32, 2048
  v_mfma_f32_16x16x32_bf16 v[192:195], v[36:39], v[80:83], v[192:195]
  buffer_load_dwordx4 v8, s[12:15], s31 offen sc1 lds
  v_mfma_f32_16x16x32_bf16 v[196:199], v[36:39], v[84:87], v[196:199]
  v_mfma_f32_16x16x32_bf16 v[200:203], v[36:39], v[88:91], v[200:203]
  v_mfma_f32_16x16x32_bf16 v[204:207], v[36:39], v[92:95], v[204:207]
  v_mfma_f32_16x16x32_bf16 v[208:211], v[40:43], v[80:83], v[208:211]
  v_mfma_f32_16x16x32_bf16 v[212:215], v[40:43], v[84:87], v[212:215]
  v_mfma_f32_16x16x32_bf16 v[216:219], v[40:43], v[88:91], v[216:219]
  v_mfma_f32_16x16x32_bf16 v[220:223], v[40:43], v[92:95], v[220:223]
  v_mfma_f32_16x16x32_bf16 v[224:227], v[44:47], v[80:83], v[224:227]
  v_mfma_f32_16x16x32_bf16 v[228:231], v[44:47], v[84:87], v[228:231]
  v_mfma_f32_16x16x32_bf16 v[232:235], v[44:47], v[88:91], v[232:235]
  v_mfma_f32_16x16x32_bf16 v[236:239], v[44:47], v[92:95], v[236:239]
  s_add_u32 s31, s31, 2048
  s_add_u32 s30, s30, 229376
  s_waitcnt vmcnt(14) lgkmcnt(0)
  s_barrier
  v_mfma_f32_16x16x32_bf16 v[112:115], v[48:51], v[96:99], v[112:115]
  ds_read_b64_tr_b16 v[16:17], v3 offset:0
  v_mfma_f32_16x16x32_bf16 v[116:119], v[48:51], v[100:103], v[116:119]
  ds_read_b64_tr_b16 v[18:19], v3 offset:1792
  s_add_u32 m0, s32, 30720
  v_mfma_f32_16x16x32_bf16 v[120:123], v[48:51], v[104:107], v[120:123]
  ds_read_b128 v[80:83], v5 offset:0
  buffer_load_dwordx4 v6, s[12:15], s31 offen sc1 lds
  v_mfma_f32_16x16x32_bf16 v[124:127], v[48:51], v[108:111], v[124:127]
  ds_read_b128 v[84:87], v5 offset:256
  v_mfma_f32_16x16x32_bf16 v[128:131], v[52:55], v[96:99], v[128:131]
  ds_read_b128 v[88:91], v5 offset:2048
  v_mfma_f32_16x16x32_bf16 v[132:135], v[52:55], v[100:103], v[132:135]
  ds_read_b128 v[92:95], v5 offset:2304
  v_mfma_f32_16x16x32_bf16 v[136:139], v[52:55], v[104:107], v[136:139]
  ds_read_b64_tr_b16 v[20:21], v3 offset:7168
  v_mfma_f32_16x16x32_bf16 v[140:143], v[52:55], v[108:111], v[140:143]
  ds_read_b64_tr_b16 v[22:23], v3 offset:8960
  v_mfma_f32_16x16x32_bf16 v[144:147], v[56:59], v[96:99], v[144:147]
  ds_read_b64_tr_b16 v[24:25], v3 offset:32
  v_mfma_f32_16x16x32_bf16 v[148:151], v[56:59], v[100:103], v[148:151]
  ds_read_b64_tr_b16 v[26:27], v3 offset:1824
  v_mfma_f32_16x16x32_bf16 v[152:155], v[56:59], v[104:107], v[152:155]
  ds_read_b64_tr_b16 v[28:29], v3 offset:7200
  s_add_u32 m0, s32, 31744
  v_mfma_f32_16x16x32_bf16 v[156:159], v[56:59], v[108:111], v[156:159]
  ds_read_b64_tr_b16 v[30:31], v3 offset:8992
  buffer_load_dwordx4 v7, s[12:15], s31 offen sc1 lds
  v_mfma_f32_16x16x32_bf16 v[160:163], v[60:63], v[96:99], v[160:163]
  ds_read_b64_tr_b16 v[32:33], v3 offset:64
  v_mfma_f32_16x16x32_bf16 v[164:167], v[60:63], v[100:103], v[164:167]
  ds_read_b64_tr_b16 v[34:35], v3 offset:1856
  v_mfma_f32_16x16x32_bf16 v[168:171], v[60:63], v[104:107], v[168:171]
  ds_read_b64_tr_b16 v[36:37], v3 offset:7232
  v_mfma_f32_16x16x32_bf16 v[172:175], v[60:63], v[108:111], v[172:175]
  ds_read_b64_tr_b16 v[38:39], v3 offset:9024
  v_mfma_f32_16x16x32_bf16 v[176:179], v[64:67], v[96:99], v[176:179]
  ds_read_b64_tr_b16 v[40:41], v3 offset:96
  v_mfma_f32_16x16x32_bf16 v[180:183], v[64:67], v[100:103], v[180:183]
  ds_read_b64_tr_b16 v[42:43], v3 offset:1888
  v_mfma_f32_16x16x32_bf16 v[184:187], v[64:67], v[104:107], v[184:187]
  ds_read_b64_tr_b16 v[44:45], v3 offset:7264
  v_mfma_f32_16x16x32_bf16 v[188:191], v[64:67], v[108:111], v[188:191]
  ds_read_b64_tr_b16 v[46:47], v3 offset:9056
  s_add_u32 m0, s32, 32768
  v_mfma_f32_16x16x32_bf16 v[192:195], v[68:71], v[96:99], v[192:195]
  buffer_load_dwordx4 v8, s[12:15], s31 offen sc1 lds
  v_mfma_f32_16x16x32_bf16 v[196:199], v[68:71], v[100:103], v[196:199]
  v_mfma_f32_16x16x32_bf16 v[200:203], v[68:71], v[104:107], v[200:203]
  v_mfma_f32_16x16x32_bf16 v[204:207], v[68:71], v[108:111], v[204:207]
  v_mfma_f32_16x16x32_bf16 v[208:211], v[72:75], v[96:99], v[208:211]
  v_mfma_f32_16x16x32_bf16 v[212:215], v[72:75], v[100:103], v[212:215]
  v_mfma_f32_16x16x32_bf16 v[216:219], v[72:75], v[104:107], v[216:219]
  v_mfma_f32_16x16x32_bf16 v[220:223], v[72:75], v[108:111], v[220:223]
  v_mfma_f32_16x16x32_bf16 v[224:227], v[76:79], v[96:99], v[224:227]
  v_mfma_f32_16x16x32_bf16 v[228:231], v[76:79], v[100:103], v[228:231]
  v_mfma_f32_16x16x32_bf16 v[232:235], v[76:79], v[104:107], v[232:235]
  v_mfma_f32_16x16x32_bf16 v[236:239], v[76:79], v[108:111], v[236:239]
  s_add_u32 s31, s31, 2048
  s_add_u32 s30, s30, 229376
  s_waitcnt vmcnt(14) lgkmcnt(0)
  s_barrier
  v_mfma_f32_16x16x32_bf16 v[112:115], v[16:19], v[80:83], v[112:115]
  ds_read_b64_tr_b16 v[48:49], v3 offset:30720
  v_mfma_f32_16x16x32_bf16 v[116:119], v[16:19], v[84:87], v[116:119]
  ds_read_b64_tr_b16 v[50:51], v3 offset:32512
  s_add_u32 m0, s32, 61440
  v_mfma_f32_16x16x32_bf16 v[120:123], v[16:19], v[88:91], v[120:123]
  ds_read_b128 v[96:99], v5 offset:30720
  buffer_load_dwordx4 v6, s[12:15], s31 offen sc1 lds
  v_mfma_f32_16x16x32_bf16 v[124:127], v[16:19], v[92:95], v[124:127]
  ds_read_b128 v[100:103], v5 offset:30976
  v_mfma_f32_16x16x32_bf16 v[128:131], v[20:23], v[80:83], v[128:131]
  ds_read_b128 v[104:107], v5 offset:32768
  v_mfma_f32_16x16x32_bf16 v[132:135], v[20:23], v[84:87], v[132:135]
  ds_read_b128 v[108:111], v5 offset:33024
  v_mfma_f32_16x16x32_bf16 v[136:139], v[20:23], v[88:91], v[136:139]
  ds_read_b64_tr_b16 v[52:53], v3 offset:37888
  v_mfma_f32_16x16x32_bf16 v[140:143], v[20:23], v[92:95], v[140:143]
  ds_read_b64_tr_b16 v[54:55], v3 offset:39680
  v_mfma_f32_16x16x32_bf16 v[144:147], v[24:27], v[80:83], v[144:147]
  ds_read_b64_tr_b16 v[56:57], v3 offset:30752
  v_mfma_f32_16x16x32_bf16 v[148:151], v[24:27], v[84:87], v[148:151]
  ds_read_b64_tr_b16 v[58:59], v3 offset:32544
  v_mfma_f32_16x16x32_bf16 v[152:155], v[24:27], v[88:91], v[152:155]
  ds_read_b64_tr_b16 v[60:61], v3 offset:37920
  s_add_u32 m0, s32, 62464
  v_mfma_f32_16x16x32_bf16 v[156:159], v[24:27], v[92:95], v[156:159]
  ds_read_b64_tr_b16 v[62:63], v3 offset:39712
  buffer_load_dwordx4 v7, s[12:15], s31 offen sc1 lds
  v_mfma_f32_16x16x32_bf16 v[160:163], v[28:31], v[80:83], v[160:163]
  ds_read_b64_tr_b16 v[64:65], v3 offset:30784
  v_mfma_f32_16x16x32_bf16 v[164:167], v[28:31], v[84:87], v[164:167]
  ds_read_b64_tr_b16 v[66:67], v3 offset:32576
  v_mfma_f32_16x16x32_bf16 v[168:171], v[28:31], v[88:91], v[168:171]
  ds_read_b64_tr_b16 v[68:69], v3 offset:37952
  v_mfma_f32_16x16x32_bf16 v[172:175], v[28:31], v[92:95], v[172:175]
  ds_read_b64_tr_b16 v[70:71], v3 offset:39744
  v_mfma_f32_16x16x32_bf16 v[176:179], v[32:35], v[80:83], v[176:179]
  ds_read_b64_tr_b16 v[72:73], v3 offset:30816
  v_mfma_f32_16x16x32_bf16 v[180:183], v[32:35], v[84:87], v[180:183]
  ds_read_b64_tr_b16 v[74:75], v3 offset:32608
  v_mfma_f32_16x16x32_bf16 v[184:187], v[32:35], v[88:91], v[184:187]
  ds_read_b64_tr_b16 v[76:77], v3 offset:37984
  v_mfma_f32_16x16x32_bf16 v[188:191], v[32:35], v[92:95], v[188:191]
  ds_read_b64_tr_b16 v[78:79], v3 offset:39776
  s_add_u32 m0, s32, 63488
  v_mfma_f32_16x16x32_bf16 v[192:195], v[36:39], v[80:83], v[192:195]
  buffer_load_dwordx4 v8, s[12:15], s31 offen sc1 lds
  v_mfma_f32_16x16x32_bf16 v[196:199], v[36:39], v[84:87], v[196:199]
  v_mfma_f32_16x16x32_bf16 v[200:203], v[36:39], v[88:91], v[200:203]
  v_mfma_f32_16x16x32_bf16 v[204:207], v[36:39], v[92:95], v[204:207]
  v_mfma_f32_16x16x32_bf16 v[208:211], v[40:43], v[80:83], v[208:211]
  v_mfma_f32_16x16x32_bf16 v[212:215], v[40:43], v[84:87], v[212:215]
  v_mfma_f32_16x16x32_bf16 v[216:219], v[40:43], v[88:91], v[216:219]
  v_mfma_f32_16x16x32_bf16 v[220:223], v[40:43], v[92:95], v[220:223]
  v_mfma_f32_16x16x32_bf16 v[224:227], v[44:47], v[80:83], v[224:227]
  v_mfma_f32_16x16x32_bf16 v[228:231], v[44:47], v[84:87], v[228:231]
  v_mfma_f32_16x16x32_bf16 v[232:235], v[44:47], v[88:91], v[232:235]
  v_mfma_f32_16x16x32_bf16 v[236:239], v[44:47], v[92:95], v[236:239]
  s_add_u32 s31, s31, 2048
  s_add_u32 s30, s30, 229376
  s_waitcnt vmcnt(6) lgkmcnt(0)
  s_barrier
  v_mfma_f32_16x16x32_bf16 v[112:115], v[48:51], v[96:99], v[112:115]
  ds_read_b64_tr_b16 v[16:17], v2 offset:0
  v_mfma_f32_16x16x32_bf16 v[116:119], v[48:51], v[100:103], v[116:119]
  ds_read_b64_tr_b16 v[18:19], v2 offset:1792
  s_add_u32 m0, s32, 92160
  v_mfma_f32_16x16x32_bf16 v[120:123], v[48:51], v[104:107], v[120:123]
  ds_read_b128 v[80:83], v4 offset:0
  buffer_load_dwordx4 v6, s[12:15], s31 offen sc1 lds
  v_mfma_f32_16x16x32_bf16 v[124:127], v[48:51], v[108:111], v[124:127]
  ds_read_b128 v[84:87], v4 offset:256
  v_mfma_f32_16x16x32_bf16 v[128:131], v[52:55], v[96:99], v[128:131]
  ds_read_b128 v[88:91], v4 offset:2048
  v_add_f32 v242, v242, v243
  v_mfma_f32_16x16x32_bf16 v[132:135], v[52:55], v[100:103], v[132:135]
  ds_read_b128 v[92:95], v4 offset:2304
  v_add_f32 v244, v244, v245
  v_mfma_f32_16x16x32_bf16 v[136:139], v[52:55], v[104:107], v[136:139]
  ds_read_b64_tr_b16 v[20:21], v2 offset:7168
  v_add_f32 v246, v246, v247
  v_mfma_f32_16x16x32_bf16 v[140:143], v[52:55], v[108:111], v[140:143]
  ds_read_b64_tr_b16 v[22:23], v2 offset:8960
  v_add_f32 v248, v248, v249
  v_mfma_f32_16x16x32_bf16 v[144:147], v[56:59], v[96:99], v[144:147]
  ds_read_b64_tr_b16 v[24:25], v2 offset:32
  v_add_f32 v242, v242, v244
  v_mfma_f32_16x16x32_bf16 v[148:151], v[56:59], v[100:103], v[148:151]
  ds_read_b64_tr_b16 v[26:27], v2 offset:1824
  v_add_f32 v246, v246, v248
  v_mfma_f32_16x16x32_bf16 v[152:155], v[56:59], v[104:107], v[152:155]
  ds_read_b64_tr_b16 v[28:29], v2 offset:7200
  s_add_u32 m0, s32, 93184
  v_add_f32 v242, v242, v246
  v_mfma_f32_16x16x32_bf16 v[156:159], v[56:59], v[108:111], v[156:159]
  ds_read_b64_tr_b16 v[30:31], v2 offset:8992
  buffer_load_dwordx4 v7, s[12:15], s31 offen sc1 lds
  v_mov_b32 v243, v242
  v_mfma_f32_16x16x32_bf16 v[160:163], v[60:63], v[96:99], v[160:163]
  ds_read_b64_tr_b16 v[32:33], v2 offset:64
  s_nop 1
  v_mfma_f32_16x16x32_bf16 v[164:167], v[60:63], v[100:103], v[164:167]
  ds_read_b64_tr_b16 v[34:35], v2 offset:1856
  v_permlane32_swap_b32 v242, v243
  v_mfma_f32_16x16x32_bf16 v[168:171], v[60:63], v[104:107], v[168:171]
  ds_read_b64_tr_b16 v[36:37], v2 offset:7232
  v_add_f32 v242, v242, v243
  v_mfma_f32_16x16x32_bf16 v[172:175], v[60:63], v[108:111], v[172:175]
  ds_read_b64_tr_b16 v[38:39], v2 offset:9024
  v_mov_b32 v245, 0x3a800000
  v_mfma_f32_16x16x32_bf16 v[176:179], v[64:67], v[96:99], v[176:179]
  ds_read_b64_tr_b16 v[40:41], v2 offset:96
  v_mov_b32 v247, 0x3727c5ac
  v_mfma_f32_16x16x32_bf16 v[180:183], v[64:67], v[100:103], v[180:183]
  ds_read_b64_tr_b16 v[42:43], v2 offset:1888
  v_fma_f32 v244, v242, v245, v247
  v_mfma_f32_16x16x32_bf16 v[184:187], v[64:67], v[104:107], v[184:187]
  ds_read_b64_tr_b16 v[44:45], v2 offset:7264
  v_rsq_f32 v246, v244
  v_mfma_f32_16x16x32_bf16 v[188:191], v[64:67], v[108:111], v[188:191]
  ds_read_b64_tr_b16 v[46:47], v2 offset:9056
  s_add_u32 m0, s32, 94208
  v_mov_b32 v245, 0
  v_mfma_f32_16x16x32_bf16 v[192:195], v[68:71], v[96:99], v[192:195]
  buffer_load_dwordx4 v8, s[12:15], s31 offen sc1 lds
  v_mul_f32 v243, 0xc0135761, v246
  v_mfma_f32_16x16x32_bf16 v[196:199], v[68:71], v[100:103], v[196:199]
  v_mul_f32 v247, v246, v246
  v_mfma_f32_16x16x32_bf16 v[200:203], v[68:71], v[104:107], v[200:203]
  v_mul_f32 v242, 0x3d372713, v243
  v_mfma_f32_16x16x32_bf16 v[204:207], v[68:71], v[108:111], v[204:207]
  v_mul_f32 v242, v242, v247
  v_mfma_f32_16x16x32_bf16 v[208:211], v[72:75], v[96:99], v[208:211]
  ds_write_b128 v251, v[242:245]
  v_mfma_f32_16x16x32_bf16 v[212:215], v[72:75], v[100:103], v[212:215]
  v_mfma_f32_16x16x32_bf16 v[216:219], v[72:75], v[104:107], v[216:219]
  v_mfma_f32_16x16x32_bf16 v[220:223], v[72:75], v[108:111], v[220:223]
  v_mfma_f32_16x16x32_bf16 v[224:227], v[76:79], v[96:99], v[224:227]
  v_mfma_f32_16x16x32_bf16 v[228:231], v[76:79], v[100:103], v[228:231]
  v_mfma_f32_16x16x32_bf16 v[232:235], v[76:79], v[104:107], v[232:235]
  v_mfma_f32_16x16x32_bf16 v[236:239], v[76:79], v[108:111], v[236:239]
  s_add_u32 s31, s31, 2048
  s_add_u32 s30, s30, 229376
  s_mov_b32 s36, 0
L_p4A_36:
  s_waitcnt vmcnt(6) lgkmcnt(0)
  s_barrier
  v_mfma_f32_16x16x32_bf16 v[112:115], v[16:19], v[80:83], v[112:115]
  ds_read_b64_tr_b16 v[48:49], v2 offset:30720
  v_mfma_f32_16x16x32_bf16 v[116:119], v[16:19], v[84:87], v[116:119]
  ds_read_b64_tr_b16 v[50:51], v2 offset:32512
  s_add_u32 m0, s32, 0
  v_mfma_f32_16x16x32_bf16 v[120:123], v[16:19], v[88:91], v[120:123]
  ds_read_b128 v[96:99], v4 offset:30720
  buffer_load_dwordx4 v6, s[12:15], s31 offen sc1 lds
  v_mfma_f32_16x16x32_bf16 v[124:127], v[16:19], v[92:95], v[124:127]
  ds_read_b128 v[100:103], v4 offset:30976
  v_mfma_f32_16x16x32_bf16 v[128:131], v[20:23], v[80:83], v[128:131]
  ds_read_b128 v[104:107], v4 offset:32768
  v_mfma_f32_16x16x32_bf16 v[132:135], v[20:23], v[84:87], v[132:135]
  ds_read_b128 v[108:111], v4 offset:33024
  v_mfma_f32_16x16x32_bf16 v[136:139], v[20:23], v[88:91], v[136:139]
  ds_read_b64_tr_b16 v[52:53], v2 offset:37888
  v_mfma_f32_16x16x32_bf16 v[140:143], v[20:23], v[92:95], v[140:143]
  ds_read_b64_tr_b16 v[54:55], v2 offset:39680
  v_mfma_f32_16x16x32_bf16 v[144:147], v[24:27], v[80:83], v[144:147]
  ds_read_b64_tr_b16 v[56:57], v2 offset:30752
  v_mfma_f32_16x16x32_bf16 v[148:151], v[24:27], v[84:87], v[148:151]
  ds_read_b64_tr_b16 v[58:59], v2 offset:32544
  v_mfma_f32_16x16x32_bf16 v[152:155], v[24:27], v[88:91], v[152:155]
  ds_read_b64_tr_b16 v[60:61], v2 offset:37920
  s_add_u32 m0, s32, 1024
  v_mfma_f32_16x16x32_bf16 v[156:159], v[24:27], v[92:95], v[156:159]
  ds_read_b64_tr_b16 v[62:63], v2 offset:39712
  buffer_load_dwordx4 v7, s[12:15], s31 offen sc1 lds
  v_mfma_f32_16x16x32_bf16 v[160:163], v[28:31], v[80:83], v[160:163]
  ds_read_b64_tr_b16 v[64:65], v2 offset:30784
  v_mfma_f32_16x16x32_bf16 v[164:167], v[28:31], v[84:87], v[164:167]
  ds_read_b64_tr_b16 v[66:67], v2 offset:32576
  v_mfma_f32_16x16x32_bf16 v[168:171], v[28:31], v[88:91], v[168:171]
  ds_read_b64_tr_b16 v[68:69], v2 offset:37952
  v_mfma_f32_16x16x32_bf16 v[172:175], v[28:31], v[92:95], v[172:175]
  ds_read_b64_tr_b16 v[70:71], v2 offset:39744
  v_mfma_f32_16x16x32_bf16 v[176:179], v[32:35], v[80:83], v[176:179]
  ds_read_b64_tr_b16 v[72:73], v2 offset:30816
  v_mfma_f32_16x16x32_bf16 v[180:183], v[32:35], v[84:87], v[180:183]
  ds_read_b64_tr_b16 v[74:75], v2 offset:32608
  v_mfma_f32_16x16x32_bf16 v[184:187], v[32:35], v[88:91], v[184:187]
  ds_read_b64_tr_b16 v[76:77], v2 offset:37984
  v_mfma_f32_16x16x32_bf16 v[188:191], v[32:35], v[92:95], v[188:191]
  ds_read_b64_tr_b16 v[78:79], v2 offset:39776
  s_add_u32 m0, s32, 2048
  v_mfma_f32_16x16x32_bf16 v[192:195], v[36:39], v[80:83], v[192:195]
  buffer_load_dwordx4 v8, s[12:15], s31 offen sc1 lds
  v_mfma_f32_16x16x32_bf16 v[196:199], v[36:39], v[84:87], v[196:199]
  v_mfma_f32_16x16x32_bf16 v[200:203], v[36:39], v[88:91], v[200:203]
  v_mfma_f32_16x16x32_bf16 v[204:207], v[36:39], v[92:95], v[204:207]
  v_mfma_f32_16x16x32_bf16 v[208:211], v[40:43], v[80:83], v[208:211]
  v_mfma_f32_16x16x32_bf16 v[212:215], v[40:43], v[84:87], v[212:215]
  v_mfma_f32_16x16x32_bf16 v[216:219], v[40:43], v[88:91], v[216:219]
  v_mfma_f32_16x16x32_bf16 v[220:223], v[40:43], v[92:95], v[220:223]
  v_mfma_f32_16x16x32_bf16 v[224:227], v[44:47], v[80:83], v[224:227]
  v_mfma_f32_16x16x32_bf16 v[228:231], v[44:47], v[84:87], v[228:231]
  v_mfma_f32_16x16x32_bf16 v[232:235], v[44:47], v[88:91], v[232:235]
  v_mfma_f32_16x16x32_bf16 v[236:239], v[44:47], v[92:95], v[236:239]
  s_add_u32 s31, s31, 2048
  s_add_u32 s30, s30, 229376
  s_waitcnt vmcnt(6) lgkmcnt(0)
  s_barrier
  v_mfma_f32_16x16x32_bf16 v[112:115], v[48:51], v[96:99], v[112:115]
  ds_read_b64_tr_b16 v[16:17], v3 offset:0
  v_mfma_f32_16x16x32_bf16 v[116:119], v[48:51], v[100:103], v[116:119]
  ds_read_b64_tr_b16 v[18:19], v3 offset:1792
  s_add_u32 m0, s32, 30720
  v_mfma_f32_16x16x32_bf16 v[120:123], v[48:51], v[104:107], v[120:123]
  ds_read_b128 v[80:83], v5 offset:0
  buffer_load_dwordx4 v6, s[12:15], s31 offen sc1 lds
  v_mfma_f32_16x16x32_bf16 v[124:127], v[48:51], v[108:111], v[124:127]
  ds_read_b128 v[84:87], v5 offset:256
  v_mfma_f32_16x16x32_bf16 v[128:131], v[52:55], v[96:99], v[128:131]
  ds_read_b128 v[88:91], v5 offset:2048
  v_mfma_f32_16x16x32_bf16 v[132:135], v[52:55], v[100:103], v[132:135]
  ds_read_b128 v[92:95], v5 offset:2304
  v_mfma_f32_16x16x32_bf16 v[136:139], v[52:55], v[104:107], v[136:139]
  ds_read_b64_tr_b16 v[20:21], v3 offset:7168
  v_mfma_f32_16x16x32_bf16 v[140:143], v[52:55], v[108:111], v[140:143]
  ds_read_b64_tr_b16 v[22:23], v3 offset:8960
  v_mfma_f32_16x16x32_bf16 v[144:147], v[56:59], v[96:99], v[144:147]
  ds_read_b64_tr_b16 v[24:25], v3 offset:32
  v_mfma_f32_16x16x32_bf16 v[148:151], v[56:59], v[100:103], v[148:151]
  ds_read_b64_tr_b16 v[26:27], v3 offset:1824
  v_mfma_f32_16x16x32_bf16 v[152:155], v[56:59], v[104:107], v[152:155]
  ds_read_b64_tr_b16 v[28:29], v3 offset:7200
  s_add_u32 m0, s32, 31744
  v_mfma_f32_16x16x32_bf16 v[156:159], v[56:59], v[108:111], v[156:159]
  ds_read_b64_tr_b16 v[30:31], v3 offset:8992
  buffer_load_dwordx4 v7, s[12:15], s31 offen sc1 lds
  v_mfma_f32_16x16x32_bf16 v[160:163], v[60:63], v[96:99], v[160:163]
  ds_read_b64_tr_b16 v[32:33], v3 offset:64
  v_mfma_f32_16x16x32_bf16 v[164:167], v[60:63], v[100:103], v[164:167]
  ds_read_b64_tr_b16 v[34:35], v3 offset:1856
  v_mfma_f32_16x16x32_bf16 v[168:171], v[60:63], v[104:107], v[168:171]
  ds_read_b64_tr_b16 v[36:37], v3 offset:7232
  v_mfma_f32_16x16x32_bf16 v[172:175], v[60:63], v[108:111], v[172:175]
  ds_read_b64_tr_b16 v[38:39], v3 offset:9024
  v_mfma_f32_16x16x32_bf16 v[176:179], v[64:67], v[96:99], v[176:179]
  ds_read_b64_tr_b16 v[40:41], v3 offset:96
  v_mfma_f32_16x16x32_bf16 v[180:183], v[64:67], v[100:103], v[180:183]
  ds_read_b64_tr_b16 v[42:43], v3 offset:1888
  v_mfma_f32_16x16x32_bf16 v[184:187], v[64:67], v[104:107], v[184:187]
  ds_read_b64_tr_b16 v[44:45], v3 offset:7264
  v_mfma_f32_16x16x32_bf16 v[188:191], v[64:67], v[108:111], v[188:191]
  ds_read_b64_tr_b16 v[46:47], v3 offset:9056
  s_add_u32 m0, s32, 32768
  v_mfma_f32_16x16x32_bf16 v[192:195], v[68:71], v[96:99], v[192:195]
  buffer_load_dwordx4 v8, s[12:15], s31 offen sc1 lds
  v_mfma_f32_16x16x32_bf16 v[196:199], v[68:71], v[100:103], v[196:199]
  v_mfma_f32_16x16x32_bf16 v[200:203], v[68:71], v[104:107], v[200:203]
  v_mfma_f32_16x16x32_bf16 v[204:207], v[68:71], v[108:111], v[204:207]
  v_mfma_f32_16x16x32_bf16 v[208:211], v[72:75], v[96:99], v[208:211]
  v_mfma_f32_16x16x32_bf16 v[212:215], v[72:75], v[100:103], v[212:215]
  v_mfma_f32_16x16x32_bf16 v[216:219], v[72:75], v[104:107], v[216:219]
  v_mfma_f32_16x16x32_bf16 v[220:223], v[72:75], v[108:111], v[220:223]
  v_mfma_f32_16x16x32_bf16 v[224:227], v[76:79], v[96:99], v[224:227]
  v_mfma_f32_16x16x32_bf16 v[228:231], v[76:79], v[100:103], v[228:231]
  v_mfma_f32_16x16x32_bf16 v[232:235], v[76:79], v[104:107], v[232:235]
  v_mfma_f32_16x16x32_bf16 v[236:239], v[76:79], v[108:111], v[236:239]
  s_add_u32 s31, s31, 2048
  s_add_u32 s30, s30, 229376
  s_waitcnt vmcnt(6) lgkmcnt(0)
  s_barrier
  v_mfma_f32_16x16x32_bf16 v[112:115], v[16:19], v[80:83], v[112:115]
  ds_read_b64_tr_b16 v[48:49], v3 offset:30720
  v_mfma_f32_16x16x32_bf16 v[116:119], v[16:19], v[84:87], v[116:119]
  ds_read_b64_tr_b16 v[50:51], v3 offset:32512
  s_add_u32 m0, s32, 61440
  v_mfma_f32_16x16x32_bf16 v[120:123], v[16:19], v[88:91], v[120:123]
  ds_read_b128 v[96:99], v5 offset:30720
  buffer_load_dwordx4 v6, s[12:15], s31 offen sc1 lds
  v_mfma_f32_16x16x32_bf16 v[124:127], v[16:19], v[92:95], v[124:127]
  ds_read_b128 v[100:103], v5 offset:30976
  v_mfma_f32_16x16x32_bf16 v[128:131], v[20:23], v[80:83], v[128:131]
  ds_read_b128 v[104:107], v5 offset:32768
  v_mfma_f32_16x16x32_bf16 v[132:135], v[20:23], v[84:87], v[132:135]
  ds_read_b128 v[108:111], v5 offset:33024
  v_mfma_f32_16x16x32_bf16 v[136:139], v[20:23], v[88:91], v[136:139]
  ds_read_b64_tr_b16 v[52:53], v3 offset:37888
  v_mfma_f32_16x16x32_bf16 v[140:143], v[20:23], v[92:95], v[140:143]
  ds_read_b64_tr_b16 v[54:55], v3 offset:39680
  v_mfma_f32_16x16x32_bf16 v[144:147], v[24:27], v[80:83], v[144:147]
  ds_read_b64_tr_b16 v[56:57], v3 offset:30752
  v_mfma_f32_16x16x32_bf16 v[148:151], v[24:27], v[84:87], v[148:151]
  ds_read_b64_tr_b16 v[58:59], v3 offset:32544
  v_mfma_f32_16x16x32_bf16 v[152:155], v[24:27], v[88:91], v[152:155]
  ds_read_b64_tr_b16 v[60:61], v3 offset:37920
  s_add_u32 m0, s32, 62464
  v_mfma_f32_16x16x32_bf16 v[156:159], v[24:27], v[92:95], v[156:159]
  ds_read_b64_tr_b16 v[62:63], v3 offset:39712
  buffer_load_dwordx4 v7, s[12:15], s31 offen sc1 lds
  v_mfma_f32_16x16x32_bf16 v[160:163], v[28:31], v[80:83], v[160:163]
  ds_read_b64_tr_b16 v[64:65], v3 offset:30784
  v_mfma_f32_16x16x32_bf16 v[164:167], v[28:31], v[84:87], v[164:167]
  ds_read_b64_tr_b16 v[66:67], v3 offset:32576
  v_mfma_f32_16x16x32_bf16 v[168:171], v[28:31], v[88:91], v[168:171]
  ds_read_b64_tr_b16 v[68:69], v3 offset:37952
  v_mfma_f32_16x16x32_bf16 v[172:175], v[28:31], v[92:95], v[172:175]
  ds_read_b64_tr_b16 v[70:71], v3 offset:39744
  v_mfma_f32_16x16x32_bf16 v[176:179], v[32:35], v[80:83], v[176:179]
  ds_read_b64_tr_b16 v[72:73], v3 offset:30816
  v_mfma_f32_16x16x32_bf16 v[180:183], v[32:35], v[84:87], v[180:183]
  ds_read_b64_tr_b16 v[74:75], v3 offset:32608
  v_mfma_f32_16x16x32_bf16 v[184:187], v[32:35], v[88:91], v[184:187]
  ds_read_b64_tr_b16 v[76:77], v3 offset:37984
  v_mfma_f32_16x16x32_bf16 v[188:191], v[32:35], v[92:95], v[188:191]
  ds_read_b64_tr_b16 v[78:79], v3 offset:39776
  s_add_u32 m0, s32, 63488
  v_mfma_f32_16x16x32_bf16 v[192:195], v[36:39], v[80:83], v[192:195]
  buffer_load_dwordx4 v8, s[12:15], s31 offen sc1 lds
  v_mfma_f32_16x16x32_bf16 v[196:199], v[36:39], v[84:87], v[196:199]
  v_mfma_f32_16x16x32_bf16 v[200:203], v[36:39], v[88:91], v[200:203]
  v_mfma_f32_16x16x32_bf16 v[204:207], v[36:39], v[92:95], v[204:207]
  v_mfma_f32_16x16x32_bf16 v[208:211], v[40:43], v[80:83], v[208:211]
  v_mfma_f32_16x16x32_bf16 v[212:215], v[40:43], v[84:87], v[212:215]
  v_mfma_f32_16x16x32_bf16 v[216:219], v[40:43], v[88:91], v[216:219]
  v_mfma_f32_16x16x32_bf16 v[220:223], v[40:43], v[92:95], v[220:223]
  v_mfma_f32_16x16x32_bf16 v[224:227], v[44:47], v[80:83], v[224:227]
  v_mfma_f32_16x16x32_bf16 v[228:231], v[44:47], v[84:87], v[228:231]
  v_mfma_f32_16x16x32_bf16 v[232:235], v[44:47], v[88:91], v[232:235]
  v_mfma_f32_16x16x32_bf16 v[236:239], v[44:47], v[92:95], v[236:239]
  s_add_u32 s31, s31, 2048
  s_add_u32 s30, s30, 229376
  s_waitcnt vmcnt(6) lgkmcnt(0)
  s_barrier
  v_mfma_f32_16x16x32_bf16 v[112:115], v[48:51], v[96:99], v[112:115]
  ds_read_b64_tr_b16 v[16:17], v2 offset:0
  v_mfma_f32_16x16x32_bf16 v[116:119], v[48:51], v[100:103], v[116:119]
  ds_read_b64_tr_b16 v[18:19], v2 offset:1792
  s_add_u32 m0, s32, 92160
  v_mfma_f32_16x16x32_bf16 v[120:123], v[48:51], v[104:107], v[120:123]
  ds_read_b128 v[80:83], v4 offset:0
  buffer_load_dwordx4 v6, s[12:15], s31 offen sc1 lds
  v_mfma_f32_16x16x32_bf16 v[124:127], v[48:51], v[108:111], v[124:127]
  ds_read_b128 v[84:87], v4 offset:256
  v_mfma_f32_16x16x32_bf16 v[128:131], v[52:55], v[96:99], v[128:131]
  ds_read_b128 v[88:91], v4 offset:2048
  v_mfma_f32_16x16x32_bf16 v[132:135], v[52:55], v[100:103], v[132:135]
  ds_read_b128 v[92:95], v4 offset:2304
  v_mfma_f32_16x16x32_bf16 v[136:139], v[52:55], v[104:107], v[136:139]
  ds_read_b64_tr_b16 v[20:21], v2 offset:7168
  v_mfma_f32_16x16x32_bf16 v[140:143], v[52:55], v[108:111], v[140:143]
  ds_read_b64_tr_b16 v[22:23], v2 offset:8960
  v_mfma_f32_16x16x32_bf16 v[144:147], v[56:59], v[96:99], v[144:147]
  ds_read_b64_tr_b16 v[24:25], v2 offset:32
  v_mfma_f32_16x16x32_bf16 v[148:151], v[56:59], v[100:103], v[148:151]
  ds_read_b64_tr_b16 v[26:27], v2 offset:1824
  v_mfma_f32_16x16x32_bf16 v[152:155], v[56:59], v[104:107], v[152:155]
  ds_read_b64_tr_b16 v[28:29], v2 offset:7200
  s_add_u32 m0, s32, 93184
  v_mfma_f32_16x16x32_bf16 v[156:159], v[56:59], v[108:111], v[156:159]
  ds_read_b64_tr_b16 v[30:31], v2 offset:8992
  buffer_load_dwordx4 v7, s[12:15], s31 offen sc1 lds
  v_mfma_f32_16x16x32_bf16 v[160:163], v[60:63], v[96:99], v[160:163]
  ds_read_b64_tr_b16 v[32:33], v2 offset:64
  v_mfma_f32_16x16x32_bf16 v[164:167], v[60:63], v[100:103], v[164:167]
  ds_read_b64_tr_b16 v[34:35], v2 offset:1856
  v_mfma_f32_16x16x32_bf16 v[168:171], v[60:63], v[104:107], v[168:171]
  ds_read_b64_tr_b16 v[36:37], v2 offset:7232
  v_mfma_f32_16x16x32_bf16 v[172:175], v[60:63], v[108:111], v[172:175]
  ds_read_b64_tr_b16 v[38:39], v2 offset:9024
  v_mfma_f32_16x16x32_bf16 v[176:179], v[64:67], v[96:99], v[176:179]
  ds_read_b64_tr_b16 v[40:41], v2 offset:96
  v_mfma_f32_16x16x32_bf16 v[180:183], v[64:67], v[100:103], v[180:183]
  ds_read_b64_tr_b16 v[42:43], v2 offset:1888
  v_mfma_f32_16x16x32_bf16 v[184:187], v[64:67], v[104:107], v[184:187]
  ds_read_b64_tr_b16 v[44:45], v2 offset:7264
  v_mfma_f32_16x16x32_bf16 v[188:191], v[64:67], v[108:111], v[188:191]
  ds_read_b64_tr_b16 v[46:47], v2 offset:9056
  s_add_u32 m0, s32, 94208
  v_mfma_f32_16x16x32_bf16 v[192:195], v[68:71], v[96:99], v[192:195]
  buffer_load_dwordx4 v8, s[12:15], s31 offen sc1 lds
  v_mfma_f32_16x16x32_bf16 v[196:199], v[68:71], v[100:103], v[196:199]
  v_mfma_f32_16x16x32_bf16 v[200:203], v[68:71], v[104:107], v[200:203]
  v_mfma_f32_16x16x32_bf16 v[204:207], v[68:71], v[108:111], v[204:207]
  v_mfma_f32_16x16x32_bf16 v[208:211], v[72:75], v[96:99], v[208:211]
  v_mfma_f32_16x16x32_bf16 v[212:215], v[72:75], v[100:103], v[212:215]
  v_mfma_f32_16x16x32_bf16 v[216:219], v[72:75], v[104:107], v[216:219]
  v_mfma_f32_16x16x32_bf16 v[220:223], v[72:75], v[108:111], v[220:223]
  v_mfma_f32_16x16x32_bf16 v[224:227], v[76:79], v[96:99], v[224:227]
  v_mfma_f32_16x16x32_bf16 v[228:231], v[76:79], v[100:103], v[228:231]
  v_mfma_f32_16x16x32_bf16 v[232:235], v[76:79], v[104:107], v[232:235]
  v_mfma_f32_16x16x32_bf16 v[236:239], v[76:79], v[108:111], v[236:239]
  s_add_u32 s31, s31, 2048
  s_add_u32 s30, s30, 229376
  s_add_u32 s36, s36, 1
  s_cmp_lt_u32 s36, 6
  s_cbranch_scc1 L_p4A_36
  s_waitcnt vmcnt(6) lgkmcnt(0)
  s_barrier
  v_mfma_f32_16x16x32_bf16 v[112:115], v[16:19], v[80:83], v[112:115]
  ds_read_b64_tr_b16 v[48:49], v2 offset:30720
  v_mfma_f32_16x16x32_bf16 v[116:119], v[16:19], v[84:87], v[116:119]
  ds_read_b64_tr_b16 v[50:51], v2 offset:32512
  s_add_u32 m0, s51, 0
  v_mfma_f32_16x16x32_bf16 v[120:123], v[16:19], v[88:91], v[120:123]
  ds_read_b128 v[96:99], v4 offset:30720
  buffer_load_dwordx4 v240, s[12:15], s50 offen sc1 lds
  v_mfma_f32_16x16x32_bf16 v[124:127], v[16:19], v[92:95], v[124:127]
  ds_read_b128 v[100:103], v4 offset:30976
  v_mfma_f32_16x16x32_bf16 v[128:131], v[20:23], v[80:83], v[128:131]
  ds_read_b128 v[104:107], v4 offset:32768
  v_mfma_f32_16x16x32_bf16 v[132:135], v[20:23], v[84:87], v[132:135]
  ds_read_b128 v[108:111], v4 offset:33024
  v_mfma_f32_16x16x32_bf16 v[136:139], v[20:23], v[88:91], v[136:139]
  ds_read_b64_tr_b16 v[52:53], v2 offset:37888
  v_mfma_f32_16x16x32_bf16 v[140:143], v[20:23], v[92:95], v[140:143]
  ds_read_b64_tr_b16 v[54:55], v2 offset:39680
  v_mfma_f32_16x16x32_bf16 v[144:147], v[24:27], v[80:83], v[144:147]
  ds_read_b64_tr_b16 v[56:57], v2 offset:30752
  v_mfma_f32_16x16x32_bf16 v[148:151], v[24:27], v[84:87], v[148:151]
  ds_read_b64_tr_b16 v[58:59], v2 offset:32544
  v_mfma_f32_16x16x32_bf16 v[152:155], v[24:27], v[88:91], v[152:155]
  ds_read_b64_tr_b16 v[60:61], v2 offset:37920
  v_mfma_f32_16x16x32_bf16 v[156:159], v[24:27], v[92:95], v[156:159]
  ds_read_b64_tr_b16 v[62:63], v2 offset:39712
  v_mfma_f32_16x16x32_bf16 v[160:163], v[28:31], v[80:83], v[160:163]
  ds_read_b64_tr_b16 v[64:65], v2 offset:30784
  v_mfma_f32_16x16x32_bf16 v[164:167], v[28:31], v[84:87], v[164:167]
  ds_read_b64_tr_b16 v[66:67], v2 offset:32576
  v_mfma_f32_16x16x32_bf16 v[168:171], v[28:31], v[88:91], v[168:171]
  ds_read_b64_tr_b16 v[68:69], v2 offset:37952
  v_mfma_f32_16x16x32_bf16 v[172:175], v[28:31], v[92:95], v[172:175]
  ds_read_b64_tr_b16 v[70:71], v2 offset:39744
  s_add_u32 m0, s51, 1024
  v_mfma_f32_16x16x32_bf16 v[176:179], v[32:35], v[80:83], v[176:179]
  ds_read_b64_tr_b16 v[72:73], v2 offset:30816
  buffer_load_dwordx4 v241, s[12:15], s50 offen sc1 lds
  s_add_u32 s50, s50, 8192
  v_mfma_f32_16x16x32_bf16 v[180:183], v[32:35], v[84:87], v[180:183]
  ds_read_b64_tr_b16 v[74:75], v2 offset:32608
  v_mfma_f32_16x16x32_bf16 v[184:187], v[32:35], v[88:91], v[184:187]
  ds_read_b64_tr_b16 v[76:77], v2 offset:37984
  v_mfma_f32_16x16x32_bf16 v[188:191], v[32:35], v[92:95], v[188:191]
  ds_read_b64_tr_b16 v[78:79], v2 offset:39776
  v_mfma_f32_16x16x32_bf16 v[192:195], v[36:39], v[80:83], v[192:195]
  v_mfma_f32_16x16x32_bf16 v[196:199], v[36:39], v[84:87], v[196:199]
  v_mfma_f32_16x16x32_bf16 v[200:203], v[36:39], v[88:91], v[200:203]
  v_mfma_f32_16x16x32_bf16 v[204:207], v[36:39], v[92:95], v[204:207]
  v_mfma_f32_16x16x32_bf16 v[208:211], v[40:43], v[80:83], v[208:211]
  v_mfma_f32_16x16x32_bf16 v[212:215], v[40:43], v[84:87], v[212:215]
  v_mfma_f32_16x16x32_bf16 v[216:219], v[40:43], v[88:91], v[216:219]
  v_mfma_f32_16x16x32_bf16 v[220:223], v[40:43], v[92:95], v[220:223]
  v_mfma_f32_16x16x32_bf16 v[224:227], v[44:47], v[80:83], v[224:227]
  v_mfma_f32_16x16x32_bf16 v[228:231], v[44:47], v[84:87], v[228:231]
  v_mfma_f32_16x16x32_bf16 v[232:235], v[44:47], v[88:91], v[232:235]
  v_mfma_f32_16x16x32_bf16 v[236:239], v[44:47], v[92:95], v[236:239]
  s_waitcnt vmcnt(5) lgkmcnt(0)
  s_barrier
  v_mfma_f32_16x16x32_bf16 v[112:115], v[48:51], v[96:99], v[112:115]
  ds_read_b64_tr_b16 v[16:17], v3 offset:0
  v_mfma_f32_16x16x32_bf16 v[116:119], v[48:51], v[100:103], v[116:119]
  ds_read_b64_tr_b16 v[18:19], v3 offset:1792
  s_add_u32 m0, s51, 16384
  v_mfma_f32_16x16x32_bf16 v[120:123], v[48:51], v[104:107], v[120:123]
  ds_read_b128 v[80:83], v5 offset:0
  buffer_load_dwordx4 v240, s[12:15], s50 offen sc1 lds
  v_mfma_f32_16x16x32_bf16 v[124:127], v[48:51], v[108:111], v[124:127]
  ds_read_b128 v[84:87], v5 offset:256
  v_mfma_f32_16x16x32_bf16 v[128:131], v[52:55], v[96:99], v[128:131]
  ds_read_b128 v[88:91], v5 offset:2048
  v_mfma_f32_16x16x32_bf16 v[132:135], v[52:55], v[100:103], v[132:135]
  ds_read_b128 v[92:95], v5 offset:2304
  v_mfma_f32_16x16x32_bf16 v[136:139], v[52:55], v[104:107], v[136:139]
  ds_read_b64_tr_b16 v[20:21], v3 offset:7168
  v_mfma_f32_16x16x32_bf16 v[140:143], v[52:55], v[108:111], v[140:143]
  ds_read_b64_tr_b16 v[22:23], v3 offset:8960
  v_mfma_f32_16x16x32_bf16 v[144:147], v[56:59], v[96:99], v[144:147]
  ds_read_b64_tr_b16 v[24:25], v3 offset:32
  s_add_u32 m0, s51, 17408
  v_mfma_f32_16x16x32_bf16 v[148:151], v[56:59], v[100:103], v[148:151]
  ds_read_b64_tr_b16 v[26:27], v3 offset:1824
  buffer_load_dwordx4 v241, s[12:15], s50 offen sc1 lds
  s_add_u32 s50, s50, 8192
  v_mfma_f32_16x16x32_bf16 v[152:155], v[56:59], v[104:107], v[152:155]
  ds_read_b64_tr_b16 v[28:29], v3 offset:7200
  v_mfma_f32_16x16x32_bf16 v[156:159], v[56:59], v[108:111], v[156:159]
  ds_read_b64_tr_b16 v[30:31], v3 offset:8992
  v_mfma_f32_16x16x32_bf16 v[160:163], v[60:63], v[96:99], v[160:163]
  ds_read_b64_tr_b16 v[32:33], v3 offset:64
  v_mfma_f32_16x16x32_bf16 v[164:167], v[60:63], v[100:103], v[164:167]
  ds_read_b64_tr_b16 v[34:35], v3 offset:1856
  v_mfma_f32_16x16x32_bf16 v[168:171], v[60:63], v[104:107], v[168:171]
  ds_read_b64_tr_b16 v[36:37], v3 offset:7232
  v_mfma_f32_16x16x32_bf16 v[172:175], v[60:63], v[108:111], v[172:175]
  ds_read_b64_tr_b16 v[38:39], v3 offset:9024
  s_add_u32 m0, s51, 32768
  v_mfma_f32_16x16x32_bf16 v[176:179], v[64:67], v[96:99], v[176:179]
  ds_read_b64_tr_b16 v[40:41], v3 offset:96
  buffer_load_dwordx4 v240, s[12:15], s50 offen sc1 lds
  v_mfma_f32_16x16x32_bf16 v[180:183], v[64:67], v[100:103], v[180:183]
  ds_read_b64_tr_b16 v[42:43], v3 offset:1888
  v_mfma_f32_16x16x32_bf16 v[184:187], v[64:67], v[104:107], v[184:187]
  ds_read_b64_tr_b16 v[44:45], v3 offset:7264
  v_mfma_f32_16x16x32_bf16 v[188:191], v[64:67], v[108:111], v[188:191]
  ds_read_b64_tr_b16 v[46:47], v3 offset:9056
  v_mfma_f32_16x16x32_bf16 v[192:195], v[68:71], v[96:99], v[192:195]
  v_mfma_f32_16x16x32_bf16 v[196:199], v[68:71], v[100:103], v[196:199]
  v_mfma_f32_16x16x32_bf16 v[200:203], v[68:71], v[104:107], v[200:203]
  s_add_u32 m0, s51, 33792
  v_mfma_f32_16x16x32_bf16 v[204:207], v[68:71], v[108:111], v[204:207]
  buffer_load_dwordx4 v241, s[12:15], s50 offen sc1 lds
  s_add_u32 s50, s50, 8192
  v_mfma_f32_16x16x32_bf16 v[208:211], v[72:75], v[96:99], v[208:211]
  v_mfma_f32_16x16x32_bf16 v[212:215], v[72:75], v[100:103], v[212:215]
  v_mfma_f32_16x16x32_bf16 v[216:219], v[72:75], v[104:107], v[216:219]
  v_mfma_f32_16x16x32_bf16 v[220:223], v[72:75], v[108:111], v[220:223]
  v_mfma_f32_16x16x32_bf16 v[224:227], v[76:79], v[96:99], v[224:227]
  v_mfma_f32_16x16x32_bf16 v[228:231], v[76:79], v[100:103], v[228:231]
  v_mfma_f32_16x16x32_bf16 v[232:235], v[76:79], v[104:107], v[232:235]
  v_mfma_f32_16x16x32_bf16 v[236:239], v[76:79], v[108:111], v[236:239]
  s_waitcnt vmcnt(6) lgkmcnt(0)
  s_barrier
  v_mfma_f32_16x16x32_bf16 v[112:115], v[16:19], v[80:83], v[112:115]
  ds_read_b64_tr_b16 v[48:49], v3 offset:30720
  v_mfma_f32_16x16x32_bf16 v[116:119], v[16:19], v[84:87], v[116:119]
  ds_read_b64_tr_b16 v[50:51], v3 offset:32512
  v_mfma_f32_16x16x32_bf16 v[120:123], v[16:19], v[88:91], v[120:123]
  ds_read_b128 v[96:99], v5 offset:30720
  v_mfma_f32_16x16x32_bf16 v[124:127], v[16:19], v[92:95], v[124:127]
  ds_read_b128 v[100:103], v5 offset:30976
  v_mfma_f32_16x16x32_bf16 v[128:131], v[20:23], v[80:83], v[128:131]
  ds_read_b128 v[104:107], v5 offset:32768
  v_mfma_f32_16x16x32_bf16 v[132:135], v[20:23], v[84:87], v[132:135]
  ds_read_b128 v[108:111], v5 offset:33024
  v_mfma_f32_16x16x32_bf16 v[136:139], v[20:23], v[88:91], v[136:139]
  ds_read_b64_tr_b16 v[52:53], v3 offset:37888
  v_mfma_f32_16x16x32_bf16 v[140:143], v[20:23], v[92:95], v[140:143]
  ds_read_b64_tr_b16 v[54:55], v3 offset:39680
  v_mfma_f32_16x16x32_bf16 v[144:147], v[24:27], v[80:83], v[144:147]
  ds_read_b64_tr_b16 v[56:57], v3 offset:30752
  v_mfma_f32_16x16x32_bf16 v[148:151], v[24:27], v[84:87], v[148:151]
  ds_read_b64_tr_b16 v[58:59], v3 offset:32544
  v_mfma_f32_16x16x32_bf16 v[152:155], v[24:27], v[88:91], v[152:155]
  ds_read_b64_tr_b16 v[60:61], v3 offset:37920
  v_mfma_f32_16x16x32_bf16 v[156:159], v[24:27], v[92:95], v[156:159]
  ds_read_b64_tr_b16 v[62:63], v3 offset:39712
  v_mfma_f32_16x16x32_bf16 v[160:163], v[28:31], v[80:83], v[160:163]
  ds_read_b64_tr_b16 v[64:65], v3 offset:30784
  v_mfma_f32_16x16x32_bf16 v[164:167], v[28:31], v[84:87], v[164:167]
  ds_read_b64_tr_b16 v[66:67], v3 offset:32576
  v_mfma_f32_16x16x32_bf16 v[168:171], v[28:31], v[88:91], v[168:171]
  ds_read_b64_tr_b16 v[68:69], v3 offset:37952
  v_mfma_f32_16x16x32_bf16 v[172:175], v[28:31], v[92:95], v[172:175]
  ds_read_b64_tr_b16 v[70:71], v3 offset:39744
  v_mfma_f32_16x16x32_bf16 v[176:179], v[32:35], v[80:83], v[176:179]
  ds_read_b64_tr_b16 v[72:73], v3 offset:30816
  v_mfma_f32_16x16x32_bf16 v[180:183], v[32:35], v[84:87], v[180:183]
  ds_read_b64_tr_b16 v[74:75], v3 offset:32608
  v_mfma_f32_16x16x32_bf16 v[184:187], v[32:35], v[88:91], v[184:187]
  ds_read_b64_tr_b16 v[76:77], v3 offset:37984
  v_mfma_f32_16x16x32_bf16 v[188:191], v[32:35], v[92:95], v[188:191]
  ds_read_b64_tr_b16 v[78:79], v3 offset:39776
  v_mfma_f32_16x16x32_bf16 v[192:195], v[36:39], v[80:83], v[192:195]
  v_mfma_f32_16x16x32_bf16 v[196:199], v[36:39], v[84:87], v[196:199]
  v_mfma_f32_16x16x32_bf16 v[200:203], v[36:39], v[88:91], v[200:203]
  v_mfma_f32_16x16x32_bf16 v[204:207], v[36:39], v[92:95], v[204:207]
  v_mfma_f32_16x16x32_bf16 v[208:211], v[40:43], v[80:83], v[208:211]
  v_mfma_f32_16x16x32_bf16 v[212:215], v[40:43], v[84:87], v[212:215]
  v_mfma_f32_16x16x32_bf16 v[216:219], v[40:43], v[88:91], v[216:219]
  v_mfma_f32_16x16x32_bf16 v[220:223], v[40:43], v[92:95], v[220:223]
  v_mfma_f32_16x16x32_bf16 v[224:227], v[44:47], v[80:83], v[224:227]
  v_mfma_f32_16x16x32_bf16 v[228:231], v[44:47], v[84:87], v[228:231]
  v_mfma_f32_16x16x32_bf16 v[232:235], v[44:47], v[88:91], v[232:235]
  v_mfma_f32_16x16x32_bf16 v[236:239], v[44:47], v[92:95], v[236:239]
  s_waitcnt lgkmcnt(0)
  v_mfma_f32_16x16x32_bf16 v[112:115], v[48:51], v[96:99], v[112:115]
  v_mfma_f32_16x16x32_bf16 v[116:119], v[48:51], v[100:103], v[116:119]
  v_mfma_f32_16x16x32_bf16 v[120:123], v[48:51], v[104:107], v[120:123]
  v_mfma_f32_16x16x32_bf16 v[124:127], v[48:51], v[108:111], v[124:127]
  v_mfma_f32_16x16x32_bf16 v[128:131], v[52:55], v[96:99], v[128:131]
  v_mfma_f32_16x16x32_bf16 v[132:135], v[52:55], v[100:103], v[132:135]
  v_mfma_f32_16x16x32_bf16 v[136:139], v[52:55], v[104:107], v[136:139]
  v_mfma_f32_16x16x32_bf16 v[140:143], v[52:55], v[108:111], v[140:143]
  v_mfma_f32_16x16x32_bf16 v[144:147], v[56:59], v[96:99], v[144:147]
  v_mfma_f32_16x16x32_bf16 v[148:151], v[56:59], v[100:103], v[148:151]
  v_mfma_f32_16x16x32_bf16 v[152:155], v[56:59], v[104:107], v[152:155]
  v_mfma_f32_16x16x32_bf16 v[156:159], v[56:59], v[108:111], v[156:159]
  v_mfma_f32_16x16x32_bf16 v[160:163], v[60:63], v[96:99], v[160:163]
  v_mfma_f32_16x16x32_bf16 v[164:167], v[60:63], v[100:103], v[164:167]
  v_mfma_f32_16x16x32_bf16 v[168:171], v[60:63], v[104:107], v[168:171]
  v_mfma_f32_16x16x32_bf16 v[172:175], v[60:63], v[108:111], v[172:175]
  v_mfma_f32_16x16x32_bf16 v[176:179], v[64:67], v[96:99], v[176:179]
  v_mfma_f32_16x16x32_bf16 v[180:183], v[64:67], v[100:103], v[180:183]
  v_mfma_f32_16x16x32_bf16 v[184:187], v[64:67], v[104:107], v[184:187]
  v_mfma_f32_16x16x32_bf16 v[188:191], v[64:67], v[108:111], v[188:191]
  v_mfma_f32_16x16x32_bf16 v[192:195], v[68:71], v[96:99], v[192:195]
  v_mfma_f32_16x16x32_bf16 v[196:199], v[68:71], v[100:103], v[196:199]
  v_mfma_f32_16x16x32_bf16 v[200:203], v[68:71], v[104:107], v[200:203]
  v_mfma_f32_16x16x32_bf16 v[204:207], v[68:71], v[108:111], v[204:207]
  v_mfma_f32_16x16x32_bf16 v[208:211], v[72:75], v[96:99], v[208:211]
  v_mfma_f32_16x16x32_bf16 v[212:215], v[72:75], v[100:103], v[212:215]
  v_mfma_f32_16x16x32_bf16 v[216:219], v[72:75], v[104:107], v[216:219]
  v_mfma_f32_16x16x32_bf16 v[220:223], v[72:75], v[108:111], v[220:223]
  v_mfma_f32_16x16x32_bf16 v[224:227], v[76:79], v[96:99], v[224:227]
  v_mfma_f32_16x16x32_bf16 v[228:231], v[76:79], v[100:103], v[228:231]
  v_mfma_f32_16x16x32_bf16 v[232:235], v[76:79], v[104:107], v[232:235]
  v_mfma_f32_16x16x32_bf16 v[236:239], v[76:79], v[108:111], v[236:239]
  v_and_b32 v12, 15, v1
  v_lshlrev_b32 v12, 4, v12
  s_lshl_b32 s27, s25, 10
  s_add_u32 s27, s27, 122880
  v_add_u32 v12, s27, v12
  ds_read_b128 v[16:19], v12 offset:0
  ds_read_b128 v[20:23], v12 offset:256
  ds_read_b128 v[24:27], v12 offset:512
  ds_read_b128 v[28:31], v12 offset:768
  s_waitcnt vmcnt(0) lgkmcnt(0)
  s_waitcnt vmcnt(0)
  s_barrier
  v_pk_mul_f32 v[32:33], v[112:113], v[112:113]
  v_pk_mul_f32 v[34:35], v[114:115], v[114:115]
  v_pk_mul_f32 v[36:37], v[116:117], v[116:117]
  v_pk_mul_f32 v[38:39], v[118:119], v[118:119]
  v_pk_fma_f32 v[32:33], v[32:33], v[16:17], v[16:17] op_sel:[0,0,1] op_sel_hi:[1,0,1]
  v_pk_fma_f32 v[34:35], v[34:35], v[16:17], v[16:17] op_sel:[0,0,1] op_sel_hi:[1,0,1]
  v_pk_fma_f32 v[36:37], v[36:37], v[20:21], v[20:21] op_sel:[0,0,1] op_sel_hi:[1,0,1]
  v_pk_fma_f32 v[38:39], v[38:39], v[20:21], v[20:21] op_sel:[0,0,1] op_sel_hi:[1,0,1]
  v_pk_mul_f32 v[32:33], v[32:33], v[112:113]
  v_pk_mul_f32 v[34:35], v[34:35], v[114:115]
  v_pk_mul_f32 v[36:37], v[36:37], v[116:117]
  v_pk_mul_f32 v[38:39], v[38:39], v[118:119]
  v_exp_f32 v32, v32
  v_exp_f32 v33, v33
  v_pk_mul_f32 v[128:129], v[128:129], v[112:113]
  v_exp_f32 v34, v34
  v_exp_f32 v35, v35
  v_pk_mul_f32 v[130:131], v[130:131], v[114:115]
  v_exp_f32 v36, v36
  v_exp_f32 v37, v37
  v_pk_mul_f32 v[132:133], v[132:133], v[116:117]
  v_exp_f32 v38, v38
  v_exp_f32 v39, v39
  v_pk_mul_f32 v[134:135], v[134:135], v[118:119]
  v_pk_fma_f32 v[32:33], v[32:33], v[18:19], v[18:19] op_sel:[0,0,0] op_sel_hi:[1,0,0]
  v_pk_fma_f32 v[34:35], v[34:35], v[18:19], v[18:19] op_sel:[0,0,0] op_sel_hi:[1,0,0]
  v_pk_fma_f32 v[36:37], v[36:37], v[22:23], v[22:23] op_sel:[0,0,0] op_sel_hi:[1,0,0]
  v_pk_fma_f32 v[38:39], v[38:39], v[22:23], v[22:23] op_sel:[0,0,0] op_sel_hi:[1,0,0]
  v_rcp_f32 v32, v32
  v_rcp_f32 v33, v33
  v_rcp_f32 v34, v34
  v_rcp_f32 v35, v35
  v_rcp_f32 v36, v36
  v_rcp_f32 v37, v37
  v_rcp_f32 v38, v38
  v_rcp_f32 v39, v39
  v_pk_mul_f32 v[128:129], v[128:129], v[32:33]
  v_pk_mul_f32 v[130:131], v[130:131], v[34:35]
  v_pk_mul_f32 v[132:133], v[132:133], v[36:37]
  v_pk_mul_f32 v[134:135], v[134:135], v[38:39]
  v_cvt_pk_bf16_f32 v48, v128, v129
  v_cvt_pk_bf16_f32 v49, v130, v131
  v_cvt_pk_bf16_f32 v50, v132, v133
  v_cvt_pk_bf16_f32 v51, v134, v135
  s_nop 0
  v_permlane16_swap_b32 v48, v50
  v_permlane16_swap_b32 v49, v51
  buffer_store_dwordx4 v[48:51], v11, s[12:15], s34 offen offset:0 sc1
  v_pk_mul_f32 v[40:41], v[120:121], v[120:121]
  v_pk_mul_f32 v[42:43], v[122:123], v[122:123]
  v_pk_mul_f32 v[44:45], v[124:125], v[124:125]
  v_pk_mul_f32 v[46:47], v[126:127], v[126:127]
  v_pk_fma_f32 v[40:41], v[40:41], v[24:25], v[24:25] op_sel:[0,0,1] op_sel_hi:[1,0,1]
  v_pk_fma_f32 v[42:43], v[42:43], v[24:25], v[24:25] op_sel:[0,0,1] op_sel_hi:[1,0,1]
  v_pk_fma_f32 v[44:45], v[44:45], v[28:29], v[28:29] op_sel:[0,0,1] op_sel_hi:[1,0,1]
  v_pk_fma_f32 v[46:47], v[46:47], v[28:29], v[28:29] op_sel:[0,0,1] op_sel_hi:[1,0,1]
  v_pk_mul_f32 v[40:41], v[40:41], v[120:121]
  v_pk_mul_f32 v[42:43], v[42:43], v[122:123]
  v_pk_mul_f32 v[44:45], v[44:45], v[124:125]
  v_pk_mul_f32 v[46:47], v[46:47], v[126:127]
  v_exp_f32 v40, v40
  v_exp_f32 v41, v41
  v_pk_mul_f32 v[136:137], v[136:137], v[120:121]
  v_exp_f32 v42, v42
  v_exp_f32 v43, v43
  v_pk_mul_f32 v[138:139], v[138:139], v[122:123]
  v_exp_f32 v44, v44
  v_exp_f32 v45, v45
  v_pk_mul_f32 v[140:141], v[140:141], v[124:125]
  v_exp_f32 v46, v46
  v_exp_f32 v47, v47
  v_pk_mul_f32 v[142:143], v[142:143], v[126:127]
  v_pk_fma_f32 v[40:41], v[40:41], v[26:27], v[26:27] op_sel:[0,0,0] op_sel_hi:[1,0,0]
  v_pk_fma_f32 v[42:43], v[42:43], v[26:27], v[26:27] op_sel:[0,0,0] op_sel_hi:[1,0,0]
  v_pk_fma_f32 v[44:45], v[44:45], v[30:31], v[30:31] op_sel:[0,0,0] op_sel_hi:[1,0,0]
  v_pk_fma_f32 v[46:47], v[46:47], v[30:31], v[30:31] op_sel:[0,0,0] op_sel_hi:[1,0,0]
  v_rcp_f32 v40, v40
  v_rcp_f32 v41, v41
  v_rcp_f32 v42, v42
  v_rcp_f32 v43, v43
  v_rcp_f32 v44, v44
  v_rcp_f32 v45, v45
  v_rcp_f32 v46, v46
  v_rcp_f32 v47, v47
  v_pk_mul_f32 v[136:137], v[136:137], v[40:41]
  v_pk_mul_f32 v[138:139], v[138:139], v[42:43]
  v_pk_mul_f32 v[140:141], v[140:141], v[44:45]
  v_pk_mul_f32 v[142:143], v[142:143], v[46:47]
  v_cvt_pk_bf16_f32 v52, v136, v137
  v_cvt_pk_bf16_f32 v53, v138, v139
  v_cvt_pk_bf16_f32 v54, v140, v141
  v_cvt_pk_bf16_f32 v55, v142, v143
  s_nop 0
  v_permlane16_swap_b32 v52, v54
  v_permlane16_swap_b32 v53, v55
  buffer_store_dwordx4 v[52:55], v11, s[12:15], s35 offen offset:0 sc1
  v_pk_mul_f32 v[32:33], v[144:145], v[144:145]
  v_pk_mul_f32 v[34:35], v[146:147], v[146:147]
  v_pk_mul_f32 v[36:37], v[148:149], v[148:149]
  v_pk_mul_f32 v[38:39], v[150:151], v[150:151]
  v_pk_fma_f32 v[32:33], v[32:33], v[16:17], v[16:17] op_sel:[0,0,1] op_sel_hi:[1,0,1]
  v_pk_fma_f32 v[34:35], v[34:35], v[16:17], v[16:17] op_sel:[0,0,1] op_sel_hi:[1,0,1]
  v_pk_fma_f32 v[36:37], v[36:37], v[20:21], v[20:21] op_sel:[0,0,1] op_sel_hi:[1,0,1]
  v_pk_fma_f32 v[38:39], v[38:39], v[20:21], v[20:21] op_sel:[0,0,1] op_sel_hi:[1,0,1]
  v_pk_mul_f32 v[32:33], v[32:33], v[144:145]
  v_pk_mul_f32 v[34:35], v[34:35], v[146:147]
  v_pk_mul_f32 v[36:37], v[36:37], v[148:149]
  v_pk_mul_f32 v[38:39], v[38:39], v[150:151]
  v_exp_f32 v32, v32
  v_exp_f32 v33, v33
  v_pk_mul_f32 v[160:161], v[160:161], v[144:145]
  v_exp_f32 v34, v34
  v_exp_f32 v35, v35
  v_pk_mul_f32 v[162:163], v[162:163], v[146:147]
  v_exp_f32 v36, v36
  v_exp_f32 v37, v37
  v_pk_mul_f32 v[164:165], v[164:165], v[148:149]
  v_exp_f32 v38, v38
  v_exp_f32 v39, v39
  v_pk_mul_f32 v[166:167], v[166:167], v[150:151]
  v_pk_fma_f32 v[32:33], v[32:33], v[18:19], v[18:19] op_sel:[0,0,0] op_sel_hi:[1,0,0]
  v_pk_fma_f32 v[34:35], v[34:35], v[18:19], v[18:19] op_sel:[0,0,0] op_sel_hi:[1,0,0]
  v_pk_fma_f32 v[36:37], v[36:37], v[22:23], v[22:23] op_sel:[0,0,0] op_sel_hi:[1,0,0]
  v_pk_fma_f32 v[38:39], v[38:39], v[22:23], v[22:23] op_sel:[0,0,0] op_sel_hi:[1,0,0]
  v_rcp_f32 v32, v32
  v_rcp_f32 v33, v33
  v_rcp_f32 v34, v34
  v_rcp_f32 v35, v35
  v_rcp_f32 v36, v36
  v_rcp_f32 v37, v37
  v_rcp_f32 v38, v38
  v_rcp_f32 v39, v39
  v_pk_mul_f32 v[160:161], v[160:161], v[32:33]
  v_pk_mul_f32 v[162:163], v[162:163], v[34:35]
  v_pk_mul_f32 v[164:165], v[164:165], v[36:37]
  v_pk_mul_f32 v[166:167], v[166:167], v[38:39]
  v_cvt_pk_bf16_f32 v56, v160, v161
  v_cvt_pk_bf16_f32 v57, v162, v163
  v_cvt_pk_bf16_f32 v58, v164, v165
  v_cvt_pk_bf16_f32 v59, v166, v167
  s_nop 0
  v_permlane16_swap_b32 v56, v58
  v_permlane16_swap_b32 v57, v59
  buffer_store_dwordx4 v[56:59], v11, s[12:15], s34 offen offset:1024 sc1
  v_pk_mul_f32 v[40:41], v[152:153], v[152:153]
  v_pk_mul_f32 v[42:43], v[154:155], v[154:155]
  v_pk_mul_f32 v[44:45], v[156:157], v[156:157]
  v_pk_mul_f32 v[46:47], v[158:159], v[158:159]
  v_pk_fma_f32 v[40:41], v[40:41], v[24:25], v[24:25] op_sel:[0,0,1] op_sel_hi:[1,0,1]
  v_pk_fma_f32 v[42:43], v[42:43], v[24:25], v[24:25] op_sel:[0,0,1] op_sel_hi:[1,0,1]
  v_pk_fma_f32 v[44:45], v[44:45], v[28:29], v[28:29] op_sel:[0,0,1] op_sel_hi:[1,0,1]
  v_pk_fma_f32 v[46:47], v[46:47], v[28:29], v[28:29] op_sel:[0,0,1] op_sel_hi:[1,0,1]
  v_pk_mul_f32 v[40:41], v[40:41], v[152:153]
  v_pk_mul_f32 v[42:43], v[42:43], v[154:155]
  v_pk_mul_f32 v[44:45], v[44:45], v[156:157]
  v_pk_mul_f32 v[46:47], v[46:47], v[158:159]
  v_exp_f32 v40, v40
  v_exp_f32 v41, v41
  v_pk_mul_f32 v[168:169], v[168:169], v[152:153]
  v_exp_f32 v42, v42
  v_exp_f32 v43, v43
  v_pk_mul_f32 v[170:171], v[170:171], v[154:155]
  v_exp_f32 v44, v44
  v_exp_f32 v45, v45
  v_pk_mul_f32 v[172:173], v[172:173], v[156:157]
  v_exp_f32 v46, v46
  v_exp_f32 v47, v47
  v_pk_mul_f32 v[174:175], v[174:175], v[158:159]
  v_pk_fma_f32 v[40:41], v[40:41], v[26:27], v[26:27] op_sel:[0,0,0] op_sel_hi:[1,0,0]
  v_pk_fma_f32 v[42:43], v[42:43], v[26:27], v[26:27] op_sel:[0,0,0] op_sel_hi:[1,0,0]
  v_pk_fma_f32 v[44:45], v[44:45], v[30:31], v[30:31] op_sel:[0,0,0] op_sel_hi:[1,0,0]
  v_pk_fma_f32 v[46:47], v[46:47], v[30:31], v[30:31] op_sel:[0,0,0] op_sel_hi:[1,0,0]
  v_rcp_f32 v40, v40
  v_rcp_f32 v41, v41
  v_rcp_f32 v42, v42
  v_rcp_f32 v43, v43
  v_rcp_f32 v44, v44
  v_rcp_f32 v45, v45
  v_rcp_f32 v46, v46
  v_rcp_f32 v47, v47
  v_pk_mul_f32 v[168:169], v[168:169], v[40:41]
  v_pk_mul_f32 v[170:171], v[170:171], v[42:43]
  v_pk_mul_f32 v[172:173], v[172:173], v[44:45]
  v_pk_mul_f32 v[174:175], v[174:175], v[46:47]
  v_cvt_pk_bf16_f32 v60, v168, v169
  v_cvt_pk_bf16_f32 v61, v170, v171
  v_cvt_pk_bf16_f32 v62, v172, v173
  v_cvt_pk_bf16_f32 v63, v174, v175
  s_nop 0
  v_permlane16_swap_b32 v60, v62
  v_permlane16_swap_b32 v61, v63
  buffer_store_dwordx4 v[60:63], v11, s[12:15], s35 offen offset:1024 sc1
  v_pk_mul_f32 v[32:33], v[176:177], v[176:177]
  v_pk_mul_f32 v[34:35], v[178:179], v[178:179]
  v_pk_mul_f32 v[36:37], v[180:181], v[180:181]
  v_pk_mul_f32 v[38:39], v[182:183], v[182:183]
  v_pk_fma_f32 v[32:33], v[32:33], v[16:17], v[16:17] op_sel:[0,0,1] op_sel_hi:[1,0,1]
  v_pk_fma_f32 v[34:35], v[34:35], v[16:17], v[16:17] op_sel:[0,0,1] op_sel_hi:[1,0,1]
  v_pk_fma_f32 v[36:37], v[36:37], v[20:21], v[20:21] op_sel:[0,0,1] op_sel_hi:[1,0,1]
  v_pk_fma_f32 v[38:39], v[38:39], v[20:21], v[20:21] op_sel:[0,0,1] op_sel_hi:[1,0,1]
  v_pk_mul_f32 v[32:33], v[32:33], v[176:177]
  v_pk_mul_f32 v[34:35], v[34:35], v[178:179]
  v_pk_mul_f32 v[36:37], v[36:37], v[180:181]
  v_pk_mul_f32 v[38:39], v[38:39], v[182:183]
  v_exp_f32 v32, v32
  v_exp_f32 v33, v33
  v_pk_mul_f32 v[192:193], v[192:193], v[176:177]
  v_exp_f32 v34, v34
  v_exp_f32 v35, v35
  v_pk_mul_f32 v[194:195], v[194:195], v[178:179]
  v_exp_f32 v36, v36
  v_exp_f32 v37, v37
  v_pk_mul_f32 v[196:197], v[196:197], v[180:181]
  v_exp_f32 v38, v38
  v_exp_f32 v39, v39
  v_pk_mul_f32 v[198:199], v[198:199], v[182:183]
  v_pk_fma_f32 v[32:33], v[32:33], v[18:19], v[18:19] op_sel:[0,0,0] op_sel_hi:[1,0,0]
  v_pk_fma_f32 v[34:35], v[34:35], v[18:19], v[18:19] op_sel:[0,0,0] op_sel_hi:[1,0,0]
  v_pk_fma_f32 v[36:37], v[36:37], v[22:23], v[22:23] op_sel:[0,0,0] op_sel_hi:[1,0,0]
  v_pk_fma_f32 v[38:39], v[38:39], v[22:23], v[22:23] op_sel:[0,0,0] op_sel_hi:[1,0,0]
  v_rcp_f32 v32, v32
  v_rcp_f32 v33, v33
  v_rcp_f32 v34, v34
  v_rcp_f32 v35, v35
  v_rcp_f32 v36, v36
  v_rcp_f32 v37, v37
  v_rcp_f32 v38, v38
  v_rcp_f32 v39, v39
  v_pk_mul_f32 v[192:193], v[192:193], v[32:33]
  v_pk_mul_f32 v[194:195], v[194:195], v[34:35]
  v_pk_mul_f32 v[196:197], v[196:197], v[36:37]
  v_pk_mul_f32 v[198:199], v[198:199], v[38:39]
  v_cvt_pk_bf16_f32 v48, v192, v193
  v_cvt_pk_bf16_f32 v49, v194, v195
  v_cvt_pk_bf16_f32 v50, v196, v197
  v_cvt_pk_bf16_f32 v51, v198, v199
  s_nop 0
  v_permlane16_swap_b32 v48, v50
  v_permlane16_swap_b32 v49, v51
  buffer_store_dwordx4 v[48:51], v11, s[12:15], s34 offen offset:2048 sc1
  v_pk_mul_f32 v[40:41], v[184:185], v[184:185]
  v_pk_mul_f32 v[42:43], v[186:187], v[186:187]
  v_pk_mul_f32 v[44:45], v[188:189], v[188:189]
  v_pk_mul_f32 v[46:47], v[190:191], v[190:191]
  v_pk_fma_f32 v[40:41], v[40:41], v[24:25], v[24:25] op_sel:[0,0,1] op_sel_hi:[1,0,1]
  v_pk_fma_f32 v[42:43], v[42:43], v[24:25], v[24:25] op_sel:[0,0,1] op_sel_hi:[1,0,1]
  v_pk_fma_f32 v[44:45], v[44:45], v[28:29], v[28:29] op_sel:[0,0,1] op_sel_hi:[1,0,1]
  v_pk_fma_f32 v[46:47], v[46:47], v[28:29], v[28:29] op_sel:[0,0,1] op_sel_hi:[1,0,1]
  v_pk_mul_f32 v[40:41], v[40:41], v[184:185]
  v_pk_mul_f32 v[42:43], v[42:43], v[186:187]
  v_pk_mul_f32 v[44:45], v[44:45], v[188:189]
  v_pk_mul_f32 v[46:47], v[46:47], v[190:191]
  v_exp_f32 v40, v40
  v_exp_f32 v41, v41
  v_pk_mul_f32 v[200:201], v[200:201], v[184:185]
  v_exp_f32 v42, v42
  v_exp_f32 v43, v43
  v_pk_mul_f32 v[202:203], v[202:203], v[186:187]
  v_exp_f32 v44, v44
  v_exp_f32 v45, v45
  v_pk_mul_f32 v[204:205], v[204:205], v[188:189]
  v_exp_f32 v46, v46
  v_exp_f32 v47, v47
  v_pk_mul_f32 v[206:207], v[206:207], v[190:191]
  v_pk_fma_f32 v[40:41], v[40:41], v[26:27], v[26:27] op_sel:[0,0,0] op_sel_hi:[1,0,0]
  v_pk_fma_f32 v[42:43], v[42:43], v[26:27], v[26:27] op_sel:[0,0,0] op_sel_hi:[1,0,0]
  v_pk_fma_f32 v[44:45], v[44:45], v[30:31], v[30:31] op_sel:[0,0,0] op_sel_hi:[1,0,0]
  v_pk_fma_f32 v[46:47], v[46:47], v[30:31], v[30:31] op_sel:[0,0,0] op_sel_hi:[1,0,0]
  v_rcp_f32 v40, v40
  v_rcp_f32 v41, v41
  v_rcp_f32 v42, v42
  v_rcp_f32 v43, v43
  v_rcp_f32 v44, v44
  v_rcp_f32 v45, v45
  v_rcp_f32 v46, v46
  v_rcp_f32 v47, v47
  v_pk_mul_f32 v[200:201], v[200:201], v[40:41]
  v_pk_mul_f32 v[202:203], v[202:203], v[42:43]
  v_pk_mul_f32 v[204:205], v[204:205], v[44:45]
  v_pk_mul_f32 v[206:207], v[206:207], v[46:47]
  v_cvt_pk_bf16_f32 v52, v200, v201
  v_cvt_pk_bf16_f32 v53, v202, v203
  v_cvt_pk_bf16_f32 v54, v204, v205
  v_cvt_pk_bf16_f32 v55, v206, v207
  s_nop 0
  v_permlane16_swap_b32 v52, v54
  v_permlane16_swap_b32 v53, v55
  buffer_store_dwordx4 v[52:55], v11, s[12:15], s35 offen offset:2048 sc1
  v_pk_mul_f32 v[32:33], v[208:209], v[208:209]
  v_pk_mul_f32 v[34:35], v[210:211], v[210:211]
  v_pk_mul_f32 v[36:37], v[212:213], v[212:213]
  v_pk_mul_f32 v[38:39], v[214:215], v[214:215]
  v_pk_fma_f32 v[32:33], v[32:33], v[16:17], v[16:17] op_sel:[0,0,1] op_sel_hi:[1,0,1]
  v_pk_fma_f32 v[34:35], v[34:35], v[16:17], v[16:17] op_sel:[0,0,1] op_sel_hi:[1,0,1]
  v_pk_fma_f32 v[36:37], v[36:37], v[20:21], v[20:21] op_sel:[0,0,1] op_sel_hi:[1,0,1]
  v_pk_fma_f32 v[38:39], v[38:39], v[20:21], v[20:21] op_sel:[0,0,1] op_sel_hi:[1,0,1]
  v_pk_mul_f32 v[32:33], v[32:33], v[208:209]
  v_pk_mul_f32 v[34:35], v[34:35], v[210:211]
  v_pk_mul_f32 v[36:37], v[36:37], v[212:213]
  v_pk_mul_f32 v[38:39], v[38:39], v[214:215]
  v_exp_f32 v32, v32
  v_exp_f32 v33, v33
  v_pk_mul_f32 v[224:225], v[224:225], v[208:209]
  v_exp_f32 v34, v34
  v_exp_f32 v35, v35
  v_pk_mul_f32 v[226:227], v[226:227], v[210:211]
  v_exp_f32 v36, v36
  v_exp_f32 v37, v37
  v_pk_mul_f32 v[228:229], v[228:229], v[212:213]
  v_exp_f32 v38, v38
  v_exp_f32 v39, v39
  v_pk_mul_f32 v[230:231], v[230:231], v[214:215]
  v_pk_fma_f32 v[32:33], v[32:33], v[18:19], v[18:19] op_sel:[0,0,0] op_sel_hi:[1,0,0]
  v_pk_fma_f32 v[34:35], v[34:35], v[18:19], v[18:19] op_sel:[0,0,0] op_sel_hi:[1,0,0]
  v_pk_fma_f32 v[36:37], v[36:37], v[22:23], v[22:23] op_sel:[0,0,0] op_sel_hi:[1,0,0]
  v_pk_fma_f32 v[38:39], v[38:39], v[22:23], v[22:23] op_sel:[0,0,0] op_sel_hi:[1,0,0]
  v_rcp_f32 v32, v32
  v_rcp_f32 v33, v33
  v_rcp_f32 v34, v34
  v_rcp_f32 v35, v35
  v_rcp_f32 v36, v36
  v_rcp_f32 v37, v37
  v_rcp_f32 v38, v38
  v_rcp_f32 v39, v39
  v_pk_mul_f32 v[224:225], v[224:225], v[32:33]
  v_pk_mul_f32 v[226:227], v[226:227], v[34:35]
  v_pk_mul_f32 v[228:229], v[228:229], v[36:37]
  v_pk_mul_f32 v[230:231], v[230:231], v[38:39]
  v_cvt_pk_bf16_f32 v56, v224, v225
  v_cvt_pk_bf16_f32 v57, v226, v227
  v_cvt_pk_bf16_f32 v58, v228, v229
  v_cvt_pk_bf16_f32 v59, v230, v231
  s_nop 0
  v_permlane16_swap_b32 v56, v58
  v_permlane16_swap_b32 v57, v59
  buffer_store_dwordx4 v[56:59], v11, s[12:15], s34 offen offset:3072 sc1
  v_pk_mul_f32 v[40:41], v[216:217], v[216:217]
  v_pk_mul_f32 v[42:43], v[218:219], v[218:219]
  v_pk_mul_f32 v[44:45], v[220:221], v[220:221]
  v_pk_mul_f32 v[46:47], v[222:223], v[222:223]
  v_pk_fma_f32 v[40:41], v[40:41], v[24:25], v[24:25] op_sel:[0,0,1] op_sel_hi:[1,0,1]
  v_pk_fma_f32 v[42:43], v[42:43], v[24:25], v[24:25] op_sel:[0,0,1] op_sel_hi:[1,0,1]
  v_pk_fma_f32 v[44:45], v[44:45], v[28:29], v[28:29] op_sel:[0,0,1] op_sel_hi:[1,0,1]
  v_pk_fma_f32 v[46:47], v[46:47], v[28:29], v[28:29] op_sel:[0,0,1] op_sel_hi:[1,0,1]
  v_pk_mul_f32 v[40:41], v[40:41], v[216:217]
  v_pk_mul_f32 v[42:43], v[42:43], v[218:219]
  v_pk_mul_f32 v[44:45], v[44:45], v[220:221]
  v_pk_mul_f32 v[46:47], v[46:47], v[222:223]
  v_exp_f32 v40, v40
  v_exp_f32 v41, v41
  v_pk_mul_f32 v[232:233], v[232:233], v[216:217]
  v_exp_f32 v42, v42
  v_exp_f32 v43, v43
  v_pk_mul_f32 v[234:235], v[234:235], v[218:219]
  v_exp_f32 v44, v44
  v_exp_f32 v45, v45
  v_pk_mul_f32 v[236:237], v[236:237], v[220:221]
  v_exp_f32 v46, v46
  v_exp_f32 v47, v47
  v_pk_mul_f32 v[238:239], v[238:239], v[222:223]
  v_pk_fma_f32 v[40:41], v[40:41], v[26:27], v[26:27] op_sel:[0,0,0] op_sel_hi:[1,0,0]
  v_pk_fma_f32 v[42:43], v[42:43], v[26:27], v[26:27] op_sel:[0,0,0] op_sel_hi:[1,0,0]
  v_pk_fma_f32 v[44:45], v[44:45], v[30:31], v[30:31] op_sel:[0,0,0] op_sel_hi:[1,0,0]
  v_pk_fma_f32 v[46:47], v[46:47], v[30:31], v[30:31] op_sel:[0,0,0] op_sel_hi:[1,0,0]
  v_rcp_f32 v40, v40
  v_rcp_f32 v41, v41
  v_rcp_f32 v42, v42
  v_rcp_f32 v43, v43
  v_rcp_f32 v44, v44
  v_rcp_f32 v45, v45
  v_rcp_f32 v46, v46
  v_rcp_f32 v47, v47
  v_pk_mul_f32 v[232:233], v[232:233], v[40:41]
  v_pk_mul_f32 v[234:235], v[234:235], v[42:43]
  v_pk_mul_f32 v[236:237], v[236:237], v[44:45]
  v_pk_mul_f32 v[238:239], v[238:239], v[46:47]
  v_cvt_pk_bf16_f32 v60, v232, v233
  v_cvt_pk_bf16_f32 v61, v234, v235
  v_cvt_pk_bf16_f32 v62, v236, v237
  v_cvt_pk_bf16_f32 v63, v238, v239
  s_nop 0
  v_permlane16_swap_b32 v60, v62
  v_permlane16_swap_b32 v61, v63
  buffer_store_dwordx4 v[60:63], v11, s[12:15], s35 offen offset:3072 sc1
  s_branch L_p4join_33
L_p4B_34:
  s_bitcmp1_b32 s25, 0
  s_cbranch_scc1 L_p4B1_35
  s_add_u32 m0, s33, 0
  s_nop 0
  buffer_load_dwordx4 v10, s[12:15], s31 offen sc1 lds
  s_add_u32 s31, s31, 2048
  s_add_u32 m0, s33, 30720
  s_nop 0
  buffer_load_dwordx4 v10, s[12:15], s31 offen sc1 lds
  s_add_u32 s31, s31, 2048
  s_add_u32 m0, s33, 61440
  s_nop 0
  buffer_load_dwordx4 v10, s[12:15], s31 offen sc1 lds
  s_add_u32 s31, s31, 2048
  s_add_u32 m0, s33, 92160
  s_nop 0
  buffer_load_dwordx4 v10, s[12:15], s31 offen sc1 lds
  s_add_u32 s31, s31, 2048
  s_mov_b32 s28, s37
  buffer_load_dword v242, v250, s[12:15], s28 offen sc1
  s_add_u32 s28, s28, 8192
  buffer_load_dword v243, v250, s[12:15], s28 offen sc1
  s_add_u32 s28, s28, 8192
  buffer_load_dword v244, v250, s[12:15], s28 offen sc1
  s_add_u32 s28, s28, 8192
  buffer_load_dword v245, v250, s[12:15], s28 offen sc1
  s_add_u32 s28, s28, 8192
  buffer_load_dword v246, v250, s[12:15], s28 offen sc1
  s_add_u32 s28, s28, 8192
  buffer_load_dword v247, v250, s[12:15], s28 offen sc1
  s_add_u32 s28, s28, 8192
  buffer_load_dword v248, v250, s[12:15], s28 offen sc1
  s_add_u32 s28, s28, 8192
  buffer_load_dword v249, v250, s[12:15], s28 offen sc1
  s_waitcnt vmcnt(11)
  s_barrier
  ds_read_b64_tr_b16 v[16:17], v2 offset:0
  ds_read_b64_tr_b16 v[18:19], v2 offset:1792
  ds_read_b128 v[80:83], v4 offset:0
  ds_read_b128 v[84:87], v4 offset:256
  ds_read_b128 v[88:91], v4 offset:2048
  ds_read_b128 v[92:95], v4 offset:2304
  ds_read_b64_tr_b16 v[20:21], v2 offset:7168
  ds_read_b64_tr_b16 v[22:23], v2 offset:8960
  ds_read_b64_tr_b16 v[24:25], v2 offset:32
  ds_read_b64_tr_b16 v[26:27], v2 offset:1824
  ds_read_b64_tr_b16 v[28:29], v2 offset:7200
  ds_read_b64_tr_b16 v[30:31], v2 offset:8992
  ds_read_b64_tr_b16 v[32:33], v2 offset:64
  ds_read_b64_tr_b16 v[34:35], v2 offset:1856
  ds_read_b64_tr_b16 v[36:37], v2 offset:7232
  ds_read_b64_tr_b16 v[38:39], v2 offset:9024
  s_waitcnt vmcnt(10) lgkmcnt(0)
  s_barrier
  v_mfma_f32_16x16x32_bf16 v[112:115], v[16:19], v[80:83], v[112:115]
  ds_read_b64_tr_b16 v[48:49], v2 offset:30720
  v_mfma_f32_16x16x32_bf16 v[116:119], v[16:19], v[84:87], v[116:119]
  ds_read_b64_tr_b16 v[50:51], v2 offset:32512
  s_add_u32 m0, s32, 0
  v_mfma_f32_16x16x32_bf16 v[120:123], v[16:19], v[88:91], v[120:123]
  ds_read_b128 v[96:99], v4 offset:30720
  buffer_load_dwordx4 v6, s[8:11], s30 offen lds
  v_mfma_f32_16x16x32_bf16 v[124:127], v[16:19], v[92:95], v[124:127]
  ds_read_b128 v[100:103], v4 offset:30976
  v_mfma_f32_16x16x32_bf16 v[128:131], v[20:23], v[80:83], v[128:131]
  ds_read_b128 v[104:107], v4 offset:32768
  v_mfma_f32_16x16x32_bf16 v[132:135], v[20:23], v[84:87], v[132:135]
  ds_read_b128 v[108:111], v4 offset:33024
  s_add_u32 m0, s32, 1024
  v_mfma_f32_16x16x32_bf16 v[136:139], v[20:23], v[88:91], v[136:139]
  ds_read_b64_tr_b16 v[52:53], v2 offset:37888
  buffer_load_dwordx4 v7, s[8:11], s30 offen lds
  v_mfma_f32_16x16x32_bf16 v[140:143], v[20:23], v[92:95], v[140:143]
  ds_read_b64_tr_b16 v[54:55], v2 offset:39680
  v_mfma_f32_16x16x32_bf16 v[144:147], v[24:27], v[80:83], v[144:147]
  ds_read_b64_tr_b16 v[56:57], v2 offset:30752
  v_mfma_f32_16x16x32_bf16 v[148:151], v[24:27], v[84:87], v[148:151]
  ds_read_b64_tr_b16 v[58:59], v2 offset:32544
  s_add_u32 m0, s32, 2048
  v_mfma_f32_16x16x32_bf16 v[152:155], v[24:27], v[88:91], v[152:155]
  ds_read_b64_tr_b16 v[60:61], v2 offset:37920
  buffer_load_dwordx4 v8, s[8:11], s30 offen lds
  v_mfma_f32_16x16x32_bf16 v[156:159], v[24:27], v[92:95], v[156:159]
  ds_read_b64_tr_b16 v[62:63], v2 offset:39712
  v_mfma_f32_16x16x32_bf16 v[160:163], v[28:31], v[80:83], v[160:163]
  ds_read_b64_tr_b16 v[64:65], v2 offset:30784
  v_mfma_f32_16x16x32_bf16 v[164:167], v[28:31], v[84:87], v[164:167]
  ds_read_b64_tr_b16 v[66:67], v2 offset:32576
  s_add_u32 m0, s32, 3072
  v_mfma_f32_16x16x32_bf16 v[168:171], v[28:31], v[88:91], v[168:171]
  ds_read_b64_tr_b16 v[68:69], v2 offset:37952
  buffer_load_dwordx4 v9, s[8:11], s30 offen lds
  v_mfma_f32_16x16x32_bf16 v[172:175], v[28:31], v[92:95], v[172:175]
  ds_read_b64_tr_b16 v[70:71], v2 offset:39744
  v_mfma_f32_16x16x32_bf16 v[176:179], v[32:35], v[80:83], v[176:179]
  v_mfma_f32_16x16x32_bf16 v[180:183], v[32:35], v[84:87], v[180:183]
  s_add_u32 m0, s33, 0
  v_mfma_f32_16x16x32_bf16 v[184:187], v[32:35], v[88:91], v[184:187]
  buffer_load_dwordx4 v10, s[12:15], s31 offen sc1 lds
  v_mfma_f32_16x16x32_bf16 v[188:191], v[32:35], v[92:95], v[188:191]
  v_mfma_f32_16x16x32_bf16 v[192:195], v[36:39], v[80:83], v[192:195]
  v_mfma_f32_16x16x32_bf16 v[196:199], v[36:39], v[84:87], v[196:199]
  v_mfma_f32_16x16x32_bf16 v[200:203], v[36:39], v[88:91], v[200:203]
  v_mfma_f32_16x16x32_bf16 v[204:207], v[36:39], v[92:95], v[204:207]
  s_add_u32 s31, s31, 2048
  s_add_u32 s30, s30, 229376
  s_waitcnt vmcnt(14) lgkmcnt(0)
  s_barrier
  v_mfma_f32_16x16x32_bf16 v[112:115], v[48:51], v[96:99], v[112:115]
  ds_read_b64_tr_b16 v[16:17], v3 offset:0
  v_mfma_f32_16x16x32_bf16 v[116:119], v[48:51], v[100:103], v[116:119]
  ds_read_b64_tr_b16 v[18:19], v3 offset:1792
  s_add_u32 m0, s32, 30720
  v_mfma_f32_16x16x32_bf16 v[120:123], v[48:51], v[104:107], v[120:123]
  ds_read_b128 v[80:83], v5 offset:0
  buffer_load_dwordx4 v6, s[8:11], s30 offen lds
  v_mfma_f32_16x16x32_bf16 v[124:127], v[48:51], v[108:111], v[124:127]
  ds_read_b128 v[84:87], v5 offset:256
  v_mfma_f32_16x16x32_bf16 v[128:131], v[52:55], v[96:99], v[128:131]
  ds_read_b128 v[88:91], v5 offset:2048
  v_mfma_f32_16x16x32_bf16 v[132:135], v[52:55], v[100:103], v[132:135]
  ds_read_b128 v[92:95], v5 offset:2304
  s_add_u32 m0, s32, 31744
  v_mfma_f32_16x16x32_bf16 v[136:139], v[52:55], v[104:107], v[136:139]
  ds_read_b64_tr_b16 v[20:21], v3 offset:7168
  buffer_load_dwordx4 v7, s[8:11], s30 offen lds
  v_mfma_f32_16x16x32_bf16 v[140:143], v[52:55], v[108:111], v[140:143]
  ds_read_b64_tr_b16 v[22:23], v3 offset:8960
  v_mfma_f32_16x16x32_bf16 v[144:147], v[56:59], v[96:99], v[144:147]
  ds_read_b64_tr_b16 v[24:25], v3 offset:32
  v_mfma_f32_16x16x32_bf16 v[148:151], v[56:59], v[100:103], v[148:151]
  ds_read_b64_tr_b16 v[26:27], v3 offset:1824
  s_add_u32 m0, s32, 32768
  v_mfma_f32_16x16x32_bf16 v[152:155], v[56:59], v[104:107], v[152:155]
  ds_read_b64_tr_b16 v[28:29], v3 offset:7200
  buffer_load_dwordx4 v8, s[8:11], s30 offen lds
  v_mfma_f32_16x16x32_bf16 v[156:159], v[56:59], v[108:111], v[156:159]
  ds_read_b64_tr_b16 v[30:31], v3 offset:8992
  v_mfma_f32_16x16x32_bf16 v[160:163], v[60:63], v[96:99], v[160:163]
  ds_read_b64_tr_b16 v[32:33], v3 offset:64
  v_mfma_f32_16x16x32_bf16 v[164:167], v[60:63], v[100:103], v[164:167]
  ds_read_b64_tr_b16 v[34:35], v3 offset:1856
  s_add_u32 m0, s32, 33792
  v_mfma_f32_16x16x32_bf16 v[168:171], v[60:63], v[104:107], v[168:171]
  ds_read_b64_tr_b16 v[36:37], v3 offset:7232
  buffer_load_dwordx4 v9, s[8:11], s30 offen lds
  v_mfma_f32_16x16x32_bf16 v[172:175], v[60:63], v[108:111], v[172:175]
  ds_read_b64_tr_b16 v[38:39], v3 offset:9024
  v_mfma_f32_16x16x32_bf16 v[176:179], v[64:67], v[96:99], v[176:179]
  v_mfma_f32_16x16x32_bf16 v[180:183], v[64:67], v[100:103], v[180:183]
  s_add_u32 m0, s33, 30720
  v_mfma_f32_16x16x32_bf16 v[184:187], v[64:67], v[104:107], v[184:187]
  buffer_load_dwordx4 v10, s[12:15], s31 offen sc1 lds
  v_mfma_f32_16x16x32_bf16 v[188:191], v[64:67], v[108:111], v[188:191]
  v_mfma_f32_16x16x32_bf16 v[192:195], v[68:71], v[96:99], v[192:195]
  v_mfma_f32_16x16x32_bf16 v[196:199], v[68:71], v[100:103], v[196:199]
  v_mfma_f32_16x16x32_bf16 v[200:203], v[68:71], v[104:107], v[200:203]
  v_mfma_f32_16x16x32_bf16 v[204:207], v[68:71], v[108:111], v[204:207]
  s_add_u32 s31, s31, 2048
  s_add_u32 s30, s30, 229376
  s_waitcnt vmcnt(18) lgkmcnt(0)
  s_barrier
  v_mfma_f32_16x16x32_bf16 v[112:115], v[16:19], v[80:83], v[112:115]
  ds_read_b64_tr_b16 v[48:49], v3 offset:30720
  v_mfma_f32_16x16x32_bf16 v[116:119], v[16:19], v[84:87], v[116:119]
  ds_read_b64_tr_b16 v[50:51], v3 offset:32512
  s_add_u32 m0, s32, 61440
  v_mfma_f32_16x16x32_bf16 v[120:123], v[16:19], v[88:91], v[120:123]
  ds_read_b128 v[96:99], v5 offset:30720
  buffer_load_dwordx4 v6, s[8:11], s30 offen lds
  v_mfma_f32_16x16x32_bf16 v[124:127], v[16:19], v[92:95], v[124:127]
  ds_read_b128 v[100:103], v5 offset:30976
  v_mfma_f32_16x16x32_bf16 v[128:131], v[20:23], v[80:83], v[128:131]
  ds_read_b128 v[104:107], v5 offset:32768
  v_mfma_f32_16x16x32_bf16 v[132:135], v[20:23], v[84:87], v[132:135]
  ds_read_b128 v[108:111], v5 offset:33024
  s_add_u32 m0, s32, 62464
  v_mfma_f32_16x16x32_bf16 v[136:139], v[20:23], v[88:91], v[136:139]
  ds_read_b64_tr_b16 v[52:53], v3 offset:37888
  buffer_load_dwordx4 v7, s[8:11], s30 offen lds
  v_mfma_f32_16x16x32_bf16 v[140:143], v[20:23], v[92:95], v[140:143]
  ds_read_b64_tr_b16 v[54:55], v3 offset:39680
  v_mfma_f32_16x16x32_bf16 v[144:147], v[24:27], v[80:83], v[144:147]
  ds_read_b64_tr_b16 v[56:57], v3 offset:30752
  v_mfma_f32_16x16x32_bf16 v[148:151], v[24:27], v[84:87], v[148:151]
  ds_read_b64_tr_b16 v[58:59], v3 offset:32544
  s_add_u32 m0, s32, 63488
  v_mfma_f32_16x16x32_bf16 v[152:155], v[24:27], v[88:91], v[152:155]
  ds_read_b64_tr_b16 v[60:61], v3 offset:37920
  buffer_load_dwordx4 v8, s[8:11], s30 offen lds
  v_mfma_f32_16x16x32_bf16 v[156:159], v[24:27], v[92:95], v[156:159]
  ds_read_b64_tr_b16 v[62:63], v3 offset:39712
  v_mfma_f32_16x16x32_bf16 v[160:163], v[28:31], v[80:83], v[160:163]
  ds_read_b64_tr_b16 v[64:65], v3 offset:30784
  v_mfma_f32_16x16x32_bf16 v[164:167], v[28:31], v[84:87], v[164:167]
  ds_read_b64_tr_b16 v[66:67], v3 offset:32576
  s_add_u32 m0, s32, 64512
  v_mfma_f32_16x16x32_bf16 v[168:171], v[28:31], v[88:91], v[168:171]
  ds_read_b64_tr_b16 v[68:69], v3 offset:37952
  buffer_load_dwordx4 v9, s[8:11], s30 offen lds
  v_mfma_f32_16x16x32_bf16 v[172:175], v[28:31], v[92:95], v[172:175]
  ds_read_b64_tr_b16 v[70:71], v3 offset:39744
  v_mfma_f32_16x16x32_bf16 v[176:179], v[32:35], v[80:83], v[176:179]
  v_mfma_f32_16x16x32_bf16 v[180:183], v[32:35], v[84:87], v[180:183]
  s_add_u32 m0, s33, 61440
  v_mfma_f32_16x16x32_bf16 v[184:187], v[32:35], v[88:91], v[184:187]
  buffer_load_dwordx4 v10, s[12:15], s31 offen sc1 lds
  v_mfma_f32_16x16x32_bf16 v[188:191], v[32:35], v[92:95], v[188:191]
  v_mfma_f32_16x16x32_bf16 v[192:195], v[36:39], v[80:83], v[192:195]
  v_mfma_f32_16x16x32_bf16 v[196:199], v[36:39], v[84:87], v[196:199]
  v_mfma_f32_16x16x32_bf16 v[200:203], v[36:39], v[88:91], v[200:203]
  v_mfma_f32_16x16x32_bf16 v[204:207], v[36:39], v[92:95], v[204:207]
  s_add_u32 s31, s31, 2048
  s_add_u32 s30, s30, 229376
  s_waitcnt vmcnt(10) lgkmcnt(0)
  s_barrier
  v_mfma_f32_16x16x32_bf16 v[112:115], v[48:51], v[96:99], v[112:115]
  ds_read_b64_tr_b16 v[16:17], v2 offset:0
  v_mfma_f32_16x16x32_bf16 v[116:119], v[48:51], v[100:103], v[116:119]
  ds_read_b64_tr_b16 v[18:19], v2 offset:1792
  s_add_u32 m0, s32, 92160
  v_mfma_f32_16x16x32_bf16 v[120:123], v[48:51], v[104:107], v[120:123]
  ds_read_b128 v[80:83], v4 offset:0
  buffer_load_dwordx4 v6, s[8:11], s30 offen lds
  v_mfma_f32_16x16x32_bf16 v[124:127], v[48:51], v[108:111], v[124:127]
  ds_read_b128 v[84:87], v4 offset:256
  v_mfma_f32_16x16x32_bf16 v[128:131], v[52:55], v[96:99], v[128:131]
  ds_read_b128 v[88:91], v4 offset:2048
  v_add_f32 v242, v242, v243
  v_mfma_f32_16x16x32_bf16 v[132:135], v[52:55], v[100:103], v[132:135]
  ds_read_b128 v[92:95], v4 offset:2304
  s_add_u32 m0, s32, 93184
  v_add_f32 v244, v244, v245
  v_mfma_f32_16x16x32_bf16 v[136:139], v[52:55], v[104:107], v[136:139]
  ds_read_b64_tr_b16 v[20:21], v2 offset:7168
  buffer_load_dwordx4 v7, s[8:11], s30 offen lds
  v_add_f32 v246, v246, v247
  v_mfma_f32_16x16x32_bf16 v[140:143], v[52:55], v[108:111], v[140:143]
  ds_read_b64_tr_b16 v[22:23], v2 offset:8960
  v_add_f32 v248, v248, v249
  v_mfma_f32_16x16x32_bf16 v[144:147], v[56:59], v[96:99], v[144:147]
  ds_read_b64_tr_b16 v[24:25], v2 offset:32
  v_add_f32 v242, v242, v244
  v_mfma_f32_16x16x32_bf16 v[148:151], v[56:59], v[100:103], v[148:151]
  ds_read_b64_tr_b16 v[26:27], v2 offset:1824
  s_add_u32 m0, s32, 94208
  v_add_f32 v246, v246, v248
  v_mfma_f32_16x16x32_bf16 v[152:155], v[56:59], v[104:107], v[152:155]
  ds_read_b64_tr_b16 v[28:29], v2 offset:7200
  buffer_load_dwordx4 v8, s[8:11], s30 offen lds
  v_add_f32 v242, v242, v246
  v_mfma_f32_16x16x32_bf16 v[156:159], v[56:59], v[108:111], v[156:159]
  ds_read_b64_tr_b16 v[30:31], v2 offset:8992
  v_mov_b32 v243, v242
  v_mfma_f32_16x16x32_bf16 v[160:163], v[60:63], v[96:99], v[160:163]
  ds_read_b64_tr_b16 v[32:33], v2 offset:64
  s_nop 1
  v_mfma_f32_16x16x32_bf16 v[164:167], v[60:63], v[100:103], v[164:167]
  ds_read_b64_tr_b16 v[34:35], v2 offset:1856
  s_add_u32 m0, s32, 95232
  v_permlane32_swap_b32 v242, v243
  v_mfma_f32_16x16x32_bf16 v[168:171], v[60:63], v[104:107], v[168:171]
  ds_read_b64_tr_b16 v[36:37], v2 offset:7232
  buffer_load_dwordx4 v9, s[8:11], s30 offen lds
  v_add_f32 v242, v242, v243
  v_mfma_f32_16x16x32_bf16 v[172:175], v[60:63], v[108:111], v[172:175]
  ds_read_b64_tr_b16 v[38:39], v2 offset:9024
  v_mov_b32 v245, 0x3a800000
  v_mfma_f32_16x16x32_bf16 v[176:179], v[64:67], v[96:99], v[176:179]
  v_mov_b32 v247, 0x3727c5ac
  v_mfma_f32_16x16x32_bf16 v[180:183], v[64:67], v[100:103], v[180:183]
  s_add_u32 m0, s33, 92160
  v_fma_f32 v244, v242, v245, v247
  v_mfma_f32_16x16x32_bf16 v[184:187], v[64:67], v[104:107], v[184:187]
  buffer_load_dwordx4 v10, s[12:15], s31 offen sc1 lds
  v_rsq_f32 v246, v244
  v_mfma_f32_16x16x32_bf16 v[188:191], v[64:67], v[108:111], v[188:191]
  v_mov_b32 v245, 0
  v_mfma_f32_16x16x32_bf16 v[192:195], v[68:71], v[96:99], v[192:195]
  v_mul_f32 v243, 0xc0135761, v246
  v_mfma_f32_16x16x32_bf16 v[196:199], v[68:71], v[100:103], v[196:199]
  v_mul_f32 v247, v246, v246
  v_mfma_f32_16x16x32_bf16 v[200:203], v[68:71], v[104:107], v[200:203]
  v_mul_f32 v242, 0x3d372713, v243
  v_mfma_f32_16x16x32_bf16 v[204:207], v[68:71], v[108:111], v[204:207]
  s_add_u32 s31, s31, 2048
  s_add_u32 s30, s30, 229376
  v_mul_f32 v242, v242, v247
  ds_write_b128 v251, v[242:245]
  s_mov_b32 s36, 0
L_p4B0_37:
  s_waitcnt vmcnt(10) lgkmcnt(0)
  s_barrier
  v_mfma_f32_16x16x32_bf16 v[112:115], v[16:19], v[80:83], v[112:115]
  ds_read_b64_tr_b16 v[48:49], v2 offset:30720
  v_mfma_f32_16x16x32_bf16 v[116:119], v[16:19], v[84:87], v[116:119]
  ds_read_b64_tr_b16 v[50:51], v2 offset:32512
  s_add_u32 m0, s32, 0
  v_mfma_f32_16x16x32_bf16 v[120:123], v[16:19], v[88:91], v[120:123]
  ds_read_b128 v[96:99], v4 offset:30720
  buffer_load_dwordx4 v6, s[8:11], s30 offen lds
  v_mfma_f32_16x16x32_bf16 v[124:127], v[16:19], v[92:95], v[124:127]
  ds_read_b128 v[100:103], v4 offset:30976
  v_mfma_f32_16x16x32_bf16 v[128:131], v[20:23], v[80:83], v[128:131]
  ds_read_b128 v[104:107], v4 offset:32768
  v_mfma_f32_16x16x32_bf16 v[132:135], v[20:23], v[84:87], v[132:135]
  ds_read_b128 v[108:111], v4 offset:33024
  s_add_u32 m0, s32, 1024
  v_mfma_f32_16x16x32_bf16 v[136:139], v[20:23], v[88:91], v[136:139]
  ds_read_b64_tr_b16 v[52:53], v2 offset:37888
  buffer_load_dwordx4 v7, s[8:11], s30 offen lds
  v_mfma_f32_16x16x32_bf16 v[140:143], v[20:23], v[92:95], v[140:143]
  ds_read_b64_tr_b16 v[54:55], v2 offset:39680
  v_mfma_f32_16x16x32_bf16 v[144:147], v[24:27], v[80:83], v[144:147]
  ds_read_b64_tr_b16 v[56:57], v2 offset:30752
  v_mfma_f32_16x16x32_bf16 v[148:151], v[24:27], v[84:87], v[148:151]
  ds_read_b64_tr_b16 v[58:59], v2 offset:32544
  s_add_u32 m0, s32, 2048
  v_mfma_f32_16x16x32_bf16 v[152:155], v[24:27], v[88:91], v[152:155]
  ds_read_b64_tr_b16 v[60:61], v2 offset:37920
  buffer_load_dwordx4 v8, s[8:11], s30 offen lds
  v_mfma_f32_16x16x32_bf16 v[156:159], v[24:27], v[92:95], v[156:159]
  ds_read_b64_tr_b16 v[62:63], v2 offset:39712
  v_mfma_f32_16x16x32_bf16 v[160:163], v[28:31], v[80:83], v[160:163]
  ds_read_b64_tr_b16 v[64:65], v2 offset:30784
  v_mfma_f32_16x16x32_bf16 v[164:167], v[28:31], v[84:87], v[164:167]
  ds_read_b64_tr_b16 v[66:67], v2 offset:32576
  s_add_u32 m0, s32, 3072
  v_mfma_f32_16x16x32_bf16 v[168:171], v[28:31], v[88:91], v[168:171]
  ds_read_b64_tr_b16 v[68:69], v2 offset:37952
  buffer_load_dwordx4 v9, s[8:11], s30 offen lds
  v_mfma_f32_16x16x32_bf16 v[172:175], v[28:31], v[92:95], v[172:175]
  ds_read_b64_tr_b16 v[70:71], v2 offset:39744
  v_mfma_f32_16x16x32_bf16 v[176:179], v[32:35], v[80:83], v[176:179]
  v_mfma_f32_16x16x32_bf16 v[180:183], v[32:35], v[84:87], v[180:183]
  s_add_u32 m0, s33, 0
  v_mfma_f32_16x16x32_bf16 v[184:187], v[32:35], v[88:91], v[184:187]
  buffer_load_dwordx4 v10, s[12:15], s31 offen sc1 lds
  v_mfma_f32_16x16x32_bf16 v[188:191], v[32:35], v[92:95], v[188:191]
  v_mfma_f32_16x16x32_bf16 v[192:195], v[36:39], v[80:83], v[192:195]
  v_mfma_f32_16x16x32_bf16 v[196:199], v[36:39], v[84:87], v[196:199]
  v_mfma_f32_16x16x32_bf16 v[200:203], v[36:39], v[88:91], v[200:203]
  v_mfma_f32_16x16x32_bf16 v[204:207], v[36:39], v[92:95], v[204:207]
  s_add_u32 s31, s31, 2048
  s_add_u32 s30, s30, 229376
  s_waitcnt vmcnt(10) lgkmcnt(0)
  s_barrier
  v_mfma_f32_16x16x32_bf16 v[112:115], v[48:51], v[96:99], v[112:115]
  ds_read_b64_tr_b16 v[16:17], v3 offset:0
  v_mfma_f32_16x16x32_bf16 v[116:119], v[48:51], v[100:103], v[116:119]
  ds_read_b64_tr_b16 v[18:19], v3 offset:1792
  s_add_u32 m0, s32, 30720
  v_mfma_f32_16x16x32_bf16 v[120:123], v[48:51], v[104:107], v[120:123]
  ds_read_b128 v[80:83], v5 offset:0
  buffer_load_dwordx4 v6, s[8:11], s30 offen lds
  v_mfma_f32_16x16x32_bf16 v[124:127], v[48:51], v[108:111], v[124:127]
  ds_read_b128 v[84:87], v5 offset:256
  v_mfma_f32_16x16x32_bf16 v[128:131], v[52:55], v[96:99], v[128:131]
  ds_read_b128 v[88:91], v5 offset:2048
  v_mfma_f32_16x16x32_bf16 v[132:135], v[52:55], v[100:103], v[132:135]
  ds_read_b128 v[92:95], v5 offset:2304
  s_add_u32 m0, s32, 31744
  v_mfma_f32_16x16x32_bf16 v[136:139], v[52:55], v[104:107], v[136:139]
  ds_read_b64_tr_b16 v[20:21], v3 offset:7168
  buffer_load_dwordx4 v7, s[8:11], s30 offen lds
  v_mfma_f32_16x16x32_bf16 v[140:143], v[52:55], v[108:111], v[140:143]
  ds_read_b64_tr_b16 v[22:23], v3 offset:8960
  v_mfma_f32_16x16x32_bf16 v[144:147], v[56:59], v[96:99], v[144:147]
  ds_read_b64_tr_b16 v[24:25], v3 offset:32
  v_mfma_f32_16x16x32_bf16 v[148:151], v[56:59], v[100:103], v[148:151]
  ds_read_b64_tr_b16 v[26:27], v3 offset:1824
  s_add_u32 m0, s32, 32768
  v_mfma_f32_16x16x32_bf16 v[152:155], v[56:59], v[104:107], v[152:155]
  ds_read_b64_tr_b16 v[28:29], v3 offset:7200
  buffer_load_dwordx4 v8, s[8:11], s30 offen lds
  v_mfma_f32_16x16x32_bf16 v[156:159], v[56:59], v[108:111], v[156:159]
  ds_read_b64_tr_b16 v[30:31], v3 offset:8992
  v_mfma_f32_16x16x32_bf16 v[160:163], v[60:63], v[96:99], v[160:163]
  ds_read_b64_tr_b16 v[32:33], v3 offset:64
  v_mfma_f32_16x16x32_bf16 v[164:167], v[60:63], v[100:103], v[164:167]
  ds_read_b64_tr_b16 v[34:35], v3 offset:1856
  s_add_u32 m0, s32, 33792
  v_mfma_f32_16x16x32_bf16 v[168:171], v[60:63], v[104:107], v[168:171]
  ds_read_b64_tr_b16 v[36:37], v3 offset:7232
  buffer_load_dwordx4 v9, s[8:11], s30 offen lds
  v_mfma_f32_16x16x32_bf16 v[172:175], v[60:63], v[108:111], v[172:175]
  ds_read_b64_tr_b16 v[38:39], v3 offset:9024
  v_mfma_f32_16x16x32_bf16 v[176:179], v[64:67], v[96:99], v[176:179]
  v_mfma_f32_16x16x32_bf16 v[180:183], v[64:67], v[100:103], v[180:183]
  s_add_u32 m0, s33, 30720
  v_mfma_f32_16x16x32_bf16 v[184:187], v[64:67], v[104:107], v[184:187]
  buffer_load_dwordx4 v10, s[12:15], s31 offen sc1 lds
  v_mfma_f32_16x16x32_bf16 v[188:191], v[64:67], v[108:111], v[188:191]
  v_mfma_f32_16x16x32_bf16 v[192:195], v[68:71], v[96:99], v[192:195]
  v_mfma_f32_16x16x32_bf16 v[196:199], v[68:71], v[100:103], v[196:199]
  v_mfma_f32_16x16x32_bf16 v[200:203], v[68:71], v[104:107], v[200:203]
  v_mfma_f32_16x16x32_bf16 v[204:207], v[68:71], v[108:111], v[204:207]
  s_add_u32 s31, s31, 2048
  s_add_u32 s30, s30, 229376
  s_waitcnt vmcnt(10) lgkmcnt(0)
  s_barrier
  v_mfma_f32_16x16x32_bf16 v[112:115], v[16:19], v[80:83], v[112:115]
  ds_read_b64_tr_b16 v[48:49], v3 offset:30720
  v_mfma_f32_16x16x32_bf16 v[116:119], v[16:19], v[84:87], v[116:119]
  ds_read_b64_tr_b16 v[50:51], v3 offset:32512
  s_add_u32 m0, s32, 61440
  v_mfma_f32_16x16x32_bf16 v[120:123], v[16:19], v[88:91], v[120:123]
  ds_read_b128 v[96:99], v5 offset:30720
  buffer_load_dwordx4 v6, s[8:11], s30 offen lds
  v_mfma_f32_16x16x32_bf16 v[124:127], v[16:19], v[92:95], v[124:127]
  ds_read_b128 v[100:103], v5 offset:30976
  v_mfma_f32_16x16x32_bf16 v[128:131], v[20:23], v[80:83], v[128:131]
  ds_read_b128 v[104:107], v5 offset:32768
  v_mfma_f32_16x16x32_bf16 v[132:135], v[20:23], v[84:87], v[132:135]
  ds_read_b128 v[108:111], v5 offset:33024
  s_add_u32 m0, s32, 62464
  v_mfma_f32_16x16x32_bf16 v[136:139], v[20:23], v[88:91], v[136:139]
  ds_read_b64_tr_b16 v[52:53], v3 offset:37888
  buffer_load_dwordx4 v7, s[8:11], s30 offen lds
  v_mfma_f32_16x16x32_bf16 v[140:143], v[20:23], v[92:95], v[140:143]
  ds_read_b64_tr_b16 v[54:55], v3 offset:39680
  v_mfma_f32_16x16x32_bf16 v[144:147], v[24:27], v[80:83], v[144:147]
  ds_read_b64_tr_b16 v[56:57], v3 offset:30752
  v_mfma_f32_16x16x32_bf16 v[148:151], v[24:27], v[84:87], v[148:151]
  ds_read_b64_tr_b16 v[58:59], v3 offset:32544
  s_add_u32 m0, s32, 63488
  v_mfma_f32_16x16x32_bf16 v[152:155], v[24:27], v[88:91], v[152:155]
  ds_read_b64_tr_b16 v[60:61], v3 offset:37920
  buffer_load_dwordx4 v8, s[8:11], s30 offen lds
  v_mfma_f32_16x16x32_bf16 v[156:159], v[24:27], v[92:95], v[156:159]
  ds_read_b64_tr_b16 v[62:63], v3 offset:39712
  v_mfma_f32_16x16x32_bf16 v[160:163], v[28:31], v[80:83], v[160:163]
  ds_read_b64_tr_b16 v[64:65], v3 offset:30784
  v_mfma_f32_16x16x32_bf16 v[164:167], v[28:31], v[84:87], v[164:167]
  ds_read_b64_tr_b16 v[66:67], v3 offset:32576
  s_add_u32 m0, s32, 64512
  v_mfma_f32_16x16x32_bf16 v[168:171], v[28:31], v[88:91], v[168:171]
  ds_read_b64_tr_b16 v[68:69], v3 offset:37952
  buffer_load_dwordx4 v9, s[8:11], s30 offen lds
  v_mfma_f32_16x16x32_bf16 v[172:175], v[28:31], v[92:95], v[172:175]
  ds_read_b64_tr_b16 v[70:71], v3 offset:39744
  v_mfma_f32_16x16x32_bf16 v[176:179], v[32:35], v[80:83], v[176:179]
  v_mfma_f32_16x16x32_bf16 v[180:183], v[32:35], v[84:87], v[180:183]
  s_add_u32 m0, s33, 61440
  v_mfma_f32_16x16x32_bf16 v[184:187], v[32:35], v[88:91], v[184:187]
  buffer_load_dwordx4 v10, s[12:15], s31 offen sc1 lds
  v_mfma_f32_16x16x32_bf16 v[188:191], v[32:35], v[92:95], v[188:191]
  v_mfma_f32_16x16x32_bf16 v[192:195], v[36:39], v[80:83], v[192:195]
  v_mfma_f32_16x16x32_bf16 v[196:199], v[36:39], v[84:87], v[196:199]
  v_mfma_f32_16x16x32_bf16 v[200:203], v[36:39], v[88:91], v[200:203]
  v_mfma_f32_16x16x32_bf16 v[204:207], v[36:39], v[92:95], v[204:207]
  s_add_u32 s31, s31, 2048
  s_add_u32 s30, s30, 229376
  s_waitcnt vmcnt(10) lgkmcnt(0)
  s_barrier
  v_mfma_f32_16x16x32_bf16 v[112:115], v[48:51], v[96:99], v[112:115]
  ds_read_b64_tr_b16 v[16:17], v2 offset:0
  v_mfma_f32_16x16x32_bf16 v[116:119], v[48:51], v[100:103], v[116:119]
  ds_read_b64_tr_b16 v[18:19], v2 offset:1792
  s_add_u32 m0, s32, 92160
  v_mfma_f32_16x16x32_bf16 v[120:123], v[48:51], v[104:107], v[120:123]
  ds_read_b128 v[80:83], v4 offset:0
  buffer_load_dwordx4 v6, s[8:11], s30 offen lds
  v_mfma_f32_16x16x32_bf16 v[124:127], v[48:51], v[108:111], v[124:127]
  ds_read_b128 v[84:87], v4 offset:256
  v_mfma_f32_16x16x32_bf16 v[128:131], v[52:55], v[96:99], v[128:131]
  ds_read_b128 v[88:91], v4 offset:2048
  v_mfma_f32_16x16x32_bf16 v[132:135], v[52:55], v[100:103], v[132:135]
  ds_read_b128 v[92:95], v4 offset:2304
  s_add_u32 m0, s32, 93184
  v_mfma_f32_16x16x32_bf16 v[136:139], v[52:55], v[104:107], v[136:139]
  ds_read_b64_tr_b16 v[20:21], v2 offset:7168
  buffer_load_dwordx4 v7, s[8:11], s30 offen lds
  v_mfma_f32_16x16x32_bf16 v[140:143], v[52:55], v[108:111], v[140:143]
  ds_read_b64_tr_b16 v[22:23], v2 offset:8960
  v_mfma_f32_16x16x32_bf16 v[144:147], v[56:59], v[96:99], v[144:147]
  ds_read_b64_tr_b16 v[24:25], v2 offset:32
  v_mfma_f32_16x16x32_bf16 v[148:151], v[56:59], v[100:103], v[148:151]
  ds_read_b64_tr_b16 v[26:27], v2 offset:1824
  s_add_u32 m0, s32, 94208
  v_mfma_f32_16x16x32_bf16 v[152:155], v[56:59], v[104:107], v[152:155]
  ds_read_b64_tr_b16 v[28:29], v2 offset:7200
  buffer_load_dwordx4 v8, s[8:11], s30 offen lds
  v_mfma_f32_16x16x32_bf16 v[156:159], v[56:59], v[108:111], v[156:159]
  ds_read_b64_tr_b16 v[30:31], v2 offset:8992
  v_mfma_f32_16x16x32_bf16 v[160:163], v[60:63], v[96:99], v[160:163]
  ds_read_b64_tr_b16 v[32:33], v2 offset:64
  v_mfma_f32_16x16x32_bf16 v[164:167], v[60:63], v[100:103], v[164:167]
  ds_read_b64_tr_b16 v[34:35], v2 offset:1856
  s_add_u32 m0, s32, 95232
  v_mfma_f32_16x16x32_bf16 v[168:171], v[60:63], v[104:107], v[168:171]
  ds_read_b64_tr_b16 v[36:37], v2 offset:7232
  buffer_load_dwordx4 v9, s[8:11], s30 offen lds
  v_mfma_f32_16x16x32_bf16 v[172:175], v[60:63], v[108:111], v[172:175]
  ds_read_b64_tr_b16 v[38:39], v2 offset:9024
  v_mfma_f32_16x16x32_bf16 v[176:179], v[64:67], v[96:99], v[176:179]
  v_mfma_f32_16x16x32_bf16 v[180:183], v[64:67], v[100:103], v[180:183]
  s_add_u32 m0, s33, 92160
  v_mfma_f32_16x16x32_bf16 v[184:187], v[64:67], v[104:107], v[184:187]
  buffer_load_dwordx4 v10, s[12:15], s31 offen sc1 lds
  v_mfma_f32_16x16x32_bf16 v[188:191], v[64:67], v[108:111], v[188:191]
  v_mfma_f32_16x16x32_bf16 v[192:195], v[68:71], v[96:99], v[192:195]
  v_mfma_f32_16x16x32_bf16 v[196:199], v[68:71], v[100:103], v[196:199]
  v_mfma_f32_16x16x32_bf16 v[200:203], v[68:71], v[104:107], v[200:203]
  v_mfma_f32_16x16x32_bf16 v[204:207], v[68:71], v[108:111], v[204:207]
  s_add_u32 s31, s31, 2048
  s_add_u32 s30, s30, 229376
  s_add_u32 s36, s36, 1
  s_cmp_lt_u32 s36, 6
  s_cbranch_scc1 L_p4B0_37
  s_waitcnt vmcnt(10) lgkmcnt(0)
  s_barrier
  v_mfma_f32_16x16x32_bf16 v[112:115], v[16:19], v[80:83], v[112:115]
  ds_read_b64_tr_b16 v[48:49], v2 offset:30720
  v_mfma_f32_16x16x32_bf16 v[116:119], v[16:19], v[84:87], v[116:119]
  ds_read_b64_tr_b16 v[50:51], v2 offset:32512
  s_add_u32 m0, s51, 0
  v_mfma_f32_16x16x32_bf16 v[120:123], v[16:19], v[88:91], v[120:123]
  ds_read_b128 v[96:99], v4 offset:30720
  buffer_load_dwordx4 v240, s[12:15], s50 offen sc1 lds
  v_mfma_f32_16x16x32_bf16 v[124:127], v[16:19], v[92:95], v[124:127]
  ds_read_b128 v[100:103], v4 offset:30976
  v_mfma_f32_16x16x32_bf16 v[128:131], v[20:23], v[80:83], v[128:131]
  ds_read_b128 v[104:107], v4 offset:32768
  v_mfma_f32_16x16x32_bf16 v[132:135], v[20:23], v[84:87], v[132:135]
  ds_read_b128 v[108:111], v4 offset:33024
  v_mfma_f32_16x16x32_bf16 v[136:139], v[20:23], v[88:91], v[136:139]
  ds_read_b64_tr_b16 v[52:53], v2 offset:37888
  v_mfma_f32_16x16x32_bf16 v[140:143], v[20:23], v[92:95], v[140:143]
  ds_read_b64_tr_b16 v[54:55], v2 offset:39680
  v_mfma_f32_16x16x32_bf16 v[144:147], v[24:27], v[80:83], v[144:147]
  ds_read_b64_tr_b16 v[56:57], v2 offset:30752
  v_mfma_f32_16x16x32_bf16 v[148:151], v[24:27], v[84:87], v[148:151]
  ds_read_b64_tr_b16 v[58:59], v2 offset:32544
  v_mfma_f32_16x16x32_bf16 v[152:155], v[24:27], v[88:91], v[152:155]
  ds_read_b64_tr_b16 v[60:61], v2 offset:37920
  v_mfma_f32_16x16x32_bf16 v[156:159], v[24:27], v[92:95], v[156:159]
  ds_read_b64_tr_b16 v[62:63], v2 offset:39712
  s_add_u32 m0, s51, 1024
  v_mfma_f32_16x16x32_bf16 v[160:163], v[28:31], v[80:83], v[160:163]
  ds_read_b64_tr_b16 v[64:65], v2 offset:30784
  buffer_load_dwordx4 v241, s[12:15], s50 offen sc1 lds
  s_add_u32 s50, s50, 8192
  v_mfma_f32_16x16x32_bf16 v[164:167], v[28:31], v[84:87], v[164:167]
  ds_read_b64_tr_b16 v[66:67], v2 offset:32576
  v_mfma_f32_16x16x32_bf16 v[168:171], v[28:31], v[88:91], v[168:171]
  ds_read_b64_tr_b16 v[68:69], v2 offset:37952
  v_mfma_f32_16x16x32_bf16 v[172:175], v[28:31], v[92:95], v[172:175]
  ds_read_b64_tr_b16 v[70:71], v2 offset:39744
  v_mfma_f32_16x16x32_bf16 v[176:179], v[32:35], v[80:83], v[176:179]
  v_mfma_f32_16x16x32_bf16 v[180:183], v[32:35], v[84:87], v[180:183]
  v_mfma_f32_16x16x32_bf16 v[184:187], v[32:35], v[88:91], v[184:187]
  v_mfma_f32_16x16x32_bf16 v[188:191], v[32:35], v[92:95], v[188:191]
  v_mfma_f32_16x16x32_bf16 v[192:195], v[36:39], v[80:83], v[192:195]
  v_mfma_f32_16x16x32_bf16 v[196:199], v[36:39], v[84:87], v[196:199]
  v_mfma_f32_16x16x32_bf16 v[200:203], v[36:39], v[88:91], v[200:203]
  v_mfma_f32_16x16x32_bf16 v[204:207], v[36:39], v[92:95], v[204:207]
  s_waitcnt vmcnt(7) lgkmcnt(0)
  s_barrier
  v_mfma_f32_16x16x32_bf16 v[112:115], v[48:51], v[96:99], v[112:115]
  ds_read_b64_tr_b16 v[16:17], v3 offset:0
  v_mfma_f32_16x16x32_bf16 v[116:119], v[48:51], v[100:103], v[116:119]
  ds_read_b64_tr_b16 v[18:19], v3 offset:1792
  s_add_u32 m0, s51, 16384
  v_mfma_f32_16x16x32_bf16 v[120:123], v[48:51], v[104:107], v[120:123]
  ds_read_b128 v[80:83], v5 offset:0
  buffer_load_dwordx4 v240, s[12:15], s50 offen sc1 lds
  v_mfma_f32_16x16x32_bf16 v[124:127], v[48:51], v[108:111], v[124:127]
  ds_read_b128 v[84:87], v5 offset:256
  v_mfma_f32_16x16x32_bf16 v[128:131], v[52:55], v[96:99], v[128:131]
  ds_read_b128 v[88:91], v5 offset:2048
  v_mfma_f32_16x16x32_bf16 v[132:135], v[52:55], v[100:103], v[132:135]
  ds_read_b128 v[92:95], v5 offset:2304
  v_mfma_f32_16x16x32_bf16 v[136:139], v[52:55], v[104:107], v[136:139]
  ds_read_b64_tr_b16 v[20:21], v3 offset:7168
  s_add_u32 m0, s51, 17408
  v_mfma_f32_16x16x32_bf16 v[140:143], v[52:55], v[108:111], v[140:143]
  ds_read_b64_tr_b16 v[22:23], v3 offset:8960
  buffer_load_dwordx4 v241, s[12:15], s50 offen sc1 lds
  s_add_u32 s50, s50, 8192
  v_mfma_f32_16x16x32_bf16 v[144:147], v[56:59], v[96:99], v[144:147]
  ds_read_b64_tr_b16 v[24:25], v3 offset:32
  v_mfma_f32_16x16x32_bf16 v[148:151], v[56:59], v[100:103], v[148:151]
  ds_read_b64_tr_b16 v[26:27], v3 offset:1824
  v_mfma_f32_16x16x32_bf16 v[152:155], v[56:59], v[104:107], v[152:155]
  ds_read_b64_tr_b16 v[28:29], v3 offset:7200
  v_mfma_f32_16x16x32_bf16 v[156:159], v[56:59], v[108:111], v[156:159]
  ds_read_b64_tr_b16 v[30:31], v3 offset:8992
  s_add_u32 m0, s51, 32768
  v_mfma_f32_16x16x32_bf16 v[160:163], v[60:63], v[96:99], v[160:163]
  ds_read_b64_tr_b16 v[32:33], v3 offset:64
  buffer_load_dwordx4 v240, s[12:15], s50 offen sc1 lds
  v_mfma_f32_16x16x32_bf16 v[164:167], v[60:63], v[100:103], v[164:167]
  ds_read_b64_tr_b16 v[34:35], v3 offset:1856
  v_mfma_f32_16x16x32_bf16 v[168:171], v[60:63], v[104:107], v[168:171]
  ds_read_b64_tr_b16 v[36:37], v3 offset:7232
  v_mfma_f32_16x16x32_bf16 v[172:175], v[60:63], v[108:111], v[172:175]
  ds_read_b64_tr_b16 v[38:39], v3 offset:9024
  v_mfma_f32_16x16x32_bf16 v[176:179], v[64:67], v[96:99], v[176:179]
  s_add_u32 m0, s51, 33792
  v_mfma_f32_16x16x32_bf16 v[180:183], v[64:67], v[100:103], v[180:183]
  buffer_load_dwordx4 v241, s[12:15], s50 offen sc1 lds
  s_add_u32 s50, s50, 8192
  v_mfma_f32_16x16x32_bf16 v[184:187], v[64:67], v[104:107], v[184:187]
  v_mfma_f32_16x16x32_bf16 v[188:191], v[64:67], v[108:111], v[188:191]
  v_mfma_f32_16x16x32_bf16 v[192:195], v[68:71], v[96:99], v[192:195]
  v_mfma_f32_16x16x32_bf16 v[196:199], v[68:71], v[100:103], v[196:199]
  v_mfma_f32_16x16x32_bf16 v[200:203], v[68:71], v[104:107], v[200:203]
  v_mfma_f32_16x16x32_bf16 v[204:207], v[68:71], v[108:111], v[204:207]
  s_waitcnt vmcnt(6) lgkmcnt(0)
  s_barrier
  v_mfma_f32_16x16x32_bf16 v[112:115], v[16:19], v[80:83], v[112:115]
  ds_read_b64_tr_b16 v[48:49], v3 offset:30720
  v_mfma_f32_16x16x32_bf16 v[116:119], v[16:19], v[84:87], v[116:119]
  ds_read_b64_tr_b16 v[50:51], v3 offset:32512
  v_mfma_f32_16x16x32_bf16 v[120:123], v[16:19], v[88:91], v[120:123]
  ds_read_b128 v[96:99], v5 offset:30720
  v_mfma_f32_16x16x32_bf16 v[124:127], v[16:19], v[92:95], v[124:127]
  ds_read_b128 v[100:103], v5 offset:30976
  v_mfma_f32_16x16x32_bf16 v[128:131], v[20:23], v[80:83], v[128:131]
  ds_read_b128 v[104:107], v5 offset:32768
  v_mfma_f32_16x16x32_bf16 v[132:135], v[20:23], v[84:87], v[132:135]
  ds_read_b128 v[108:111], v5 offset:33024
  v_mfma_f32_16x16x32_bf16 v[136:139], v[20:23], v[88:91], v[136:139]
  ds_read_b64_tr_b16 v[52:53], v3 offset:37888
  v_mfma_f32_16x16x32_bf16 v[140:143], v[20:23], v[92:95], v[140:143]
  ds_read_b64_tr_b16 v[54:55], v3 offset:39680
  v_mfma_f32_16x16x32_bf16 v[144:147], v[24:27], v[80:83], v[144:147]
  ds_read_b64_tr_b16 v[56:57], v3 offset:30752
  v_mfma_f32_16x16x32_bf16 v[148:151], v[24:27], v[84:87], v[148:151]
  ds_read_b64_tr_b16 v[58:59], v3 offset:32544
  v_mfma_f32_16x16x32_bf16 v[152:155], v[24:27], v[88:91], v[152:155]
  ds_read_b64_tr_b16 v[60:61], v3 offset:37920
  v_mfma_f32_16x16x32_bf16 v[156:159], v[24:27], v[92:95], v[156:159]
  ds_read_b64_tr_b16 v[62:63], v3 offset:39712
  v_mfma_f32_16x16x32_bf16 v[160:163], v[28:31], v[80:83], v[160:163]
  ds_read_b64_tr_b16 v[64:65], v3 offset:30784
  v_mfma_f32_16x16x32_bf16 v[164:167], v[28:31], v[84:87], v[164:167]
  ds_read_b64_tr_b16 v[66:67], v3 offset:32576
  v_mfma_f32_16x16x32_bf16 v[168:171], v[28:31], v[88:91], v[168:171]
  ds_read_b64_tr_b16 v[68:69], v3 offset:37952
  v_mfma_f32_16x16x32_bf16 v[172:175], v[28:31], v[92:95], v[172:175]
  ds_read_b64_tr_b16 v[70:71], v3 offset:39744
  v_mfma_f32_16x16x32_bf16 v[176:179], v[32:35], v[80:83], v[176:179]
  v_mfma_f32_16x16x32_bf16 v[180:183], v[32:35], v[84:87], v[180:183]
  v_mfma_f32_16x16x32_bf16 v[184:187], v[32:35], v[88:91], v[184:187]
  v_mfma_f32_16x16x32_bf16 v[188:191], v[32:35], v[92:95], v[188:191]
  v_mfma_f32_16x16x32_bf16 v[192:195], v[36:39], v[80:83], v[192:195]
  v_mfma_f32_16x16x32_bf16 v[196:199], v[36:39], v[84:87], v[196:199]
  v_mfma_f32_16x16x32_bf16 v[200:203], v[36:39], v[88:91], v[200:203]
  v_mfma_f32_16x16x32_bf16 v[204:207], v[36:39], v[92:95], v[204:207]
  s_waitcnt lgkmcnt(0)
  v_mfma_f32_16x16x32_bf16 v[112:115], v[48:51], v[96:99], v[112:115]
  v_mfma_f32_16x16x32_bf16 v[116:119], v[48:51], v[100:103], v[116:119]
  v_mfma_f32_16x16x32_bf16 v[120:123], v[48:51], v[104:107], v[120:123]
  v_mfma_f32_16x16x32_bf16 v[124:127], v[48:51], v[108:111], v[124:127]
  v_mfma_f32_16x16x32_bf16 v[128:131], v[52:55], v[96:99], v[128:131]
  v_mfma_f32_16x16x32_bf16 v[132:135], v[52:55], v[100:103], v[132:135]
  v_mfma_f32_16x16x32_bf16 v[136:139], v[52:55], v[104:107], v[136:139]
  v_mfma_f32_16x16x32_bf16 v[140:143], v[52:55], v[108:111], v[140:143]
  v_mfma_f32_16x16x32_bf16 v[144:147], v[56:59], v[96:99], v[144:147]
  v_mfma_f32_16x16x32_bf16 v[148:151], v[56:59], v[100:103], v[148:151]
  v_mfma_f32_16x16x32_bf16 v[152:155], v[56:59], v[104:107], v[152:155]
  v_mfma_f32_16x16x32_bf16 v[156:159], v[56:59], v[108:111], v[156:159]
  v_mfma_f32_16x16x32_bf16 v[160:163], v[60:63], v[96:99], v[160:163]
  v_mfma_f32_16x16x32_bf16 v[164:167], v[60:63], v[100:103], v[164:167]
  v_mfma_f32_16x16x32_bf16 v[168:171], v[60:63], v[104:107], v[168:171]
  v_mfma_f32_16x16x32_bf16 v[172:175], v[60:63], v[108:111], v[172:175]
  v_mfma_f32_16x16x32_bf16 v[176:179], v[64:67], v[96:99], v[176:179]
  v_mfma_f32_16x16x32_bf16 v[180:183], v[64:67], v[100:103], v[180:183]
  v_mfma_f32_16x16x32_bf16 v[184:187], v[64:67], v[104:107], v[184:187]
  v_mfma_f32_16x16x32_bf16 v[188:191], v[64:67], v[108:111], v[188:191]
  v_mfma_f32_16x16x32_bf16 v[192:195], v[68:71], v[96:99], v[192:195]
  v_mfma_f32_16x16x32_bf16 v[196:199], v[68:71], v[100:103], v[196:199]
  v_mfma_f32_16x16x32_bf16 v[200:203], v[68:71], v[104:107], v[200:203]
  v_mfma_f32_16x16x32_bf16 v[204:207], v[68:71], v[108:111], v[204:207]
  v_and_b32 v12, 15, v1
  v_lshlrev_b32 v12, 4, v12
  s_lshl_b32 s27, s25, 10
  s_add_u32 s27, s27, 122880
  v_add_u32 v12, s27, v12
  ds_read_b128 v[16:19], v12 offset:0
  ds_read_b128 v[20:23], v12 offset:256
  ds_read_b128 v[24:27], v12 offset:512
  ds_read_b128 v[28:31], v12 offset:768
  s_waitcnt vmcnt(0) lgkmcnt(0)
  s_waitcnt vmcnt(0)
  s_barrier
  v_pk_mul_f32 v[32:33], v[112:113], v[112:113]
  v_pk_mul_f32 v[34:35], v[114:115], v[114:115]
  v_pk_mul_f32 v[36:37], v[116:117], v[116:117]
  v_pk_mul_f32 v[38:39], v[118:119], v[118:119]
  v_pk_fma_f32 v[32:33], v[32:33], v[16:17], v[16:17] op_sel:[0,0,1] op_sel_hi:[1,0,1]
  v_pk_fma_f32 v[34:35], v[34:35], v[16:17], v[16:17] op_sel:[0,0,1] op_sel_hi:[1,0,1]
  v_pk_fma_f32 v[36:37], v[36:37], v[20:21], v[20:21] op_sel:[0,0,1] op_sel_hi:[1,0,1]
  v_pk_fma_f32 v[38:39], v[38:39], v[20:21], v[20:21] op_sel:[0,0,1] op_sel_hi:[1,0,1]
  v_pk_mul_f32 v[32:33], v[32:33], v[112:113]
  v_pk_mul_f32 v[34:35], v[34:35], v[114:115]
  v_pk_mul_f32 v[36:37], v[36:37], v[116:117]
  v_pk_mul_f32 v[38:39], v[38:39], v[118:119]
  v_exp_f32 v32, v32
  v_exp_f32 v33, v33
  v_pk_mul_f32 v[128:129], v[128:129], v[112:113]
  v_exp_f32 v34, v34
  v_exp_f32 v35, v35
  v_pk_mul_f32 v[130:131], v[130:131], v[114:115]
  v_exp_f32 v36, v36
  v_exp_f32 v37, v37
  v_pk_mul_f32 v[132:133], v[132:133], v[116:117]
  v_exp_f32 v38, v38
  v_exp_f32 v39, v39
  v_pk_mul_f32 v[134:135], v[134:135], v[118:119]
  v_pk_fma_f32 v[32:33], v[32:33], v[18:19], v[18:19] op_sel:[0,0,0] op_sel_hi:[1,0,0]
  v_pk_fma_f32 v[34:35], v[34:35], v[18:19], v[18:19] op_sel:[0,0,0] op_sel_hi:[1,0,0]
  v_pk_fma_f32 v[36:37], v[36:37], v[22:23], v[22:23] op_sel:[0,0,0] op_sel_hi:[1,0,0]
  v_pk_fma_f32 v[38:39], v[38:39], v[22:23], v[22:23] op_sel:[0,0,0] op_sel_hi:[1,0,0]
  v_rcp_f32 v32, v32
  v_rcp_f32 v33, v33
  v_rcp_f32 v34, v34
  v_rcp_f32 v35, v35
  v_rcp_f32 v36, v36
  v_rcp_f32 v37, v37
  v_rcp_f32 v38, v38
  v_rcp_f32 v39, v39
  v_pk_mul_f32 v[128:129], v[128:129], v[32:33]
  v_pk_mul_f32 v[130:131], v[130:131], v[34:35]
  v_pk_mul_f32 v[132:133], v[132:133], v[36:37]
  v_pk_mul_f32 v[134:135], v[134:135], v[38:39]
  v_cvt_pk_bf16_f32 v48, v128, v129
  v_cvt_pk_bf16_f32 v49, v130, v131
  v_cvt_pk_bf16_f32 v50, v132, v133
  v_cvt_pk_bf16_f32 v51, v134, v135
  s_nop 0
  v_permlane16_swap_b32 v48, v50
  v_permlane16_swap_b32 v49, v51
  buffer_store_dwordx4 v[48:51], v11, s[12:15], s34 offen offset:0 sc1
  v_pk_mul_f32 v[40:41], v[120:121], v[120:121]
  v_pk_mul_f32 v[42:43], v[122:123], v[122:123]
  v_pk_mul_f32 v[44:45], v[124:125], v[124:125]
  v_pk_mul_f32 v[46:47], v[126:127], v[126:127]
  v_pk_fma_f32 v[40:41], v[40:41], v[24:25], v[24:25] op_sel:[0,0,1] op_sel_hi:[1,0,1]
  v_pk_fma_f32 v[42:43], v[42:43], v[24:25], v[24:25] op_sel:[0,0,1] op_sel_hi:[1,0,1]
  v_pk_fma_f32 v[44:45], v[44:45], v[28:29], v[28:29] op_sel:[0,0,1] op_sel_hi:[1,0,1]
  v_pk_fma_f32 v[46:47], v[46:47], v[28:29], v[28:29] op_sel:[0,0,1] op_sel_hi:[1,0,1]
  v_pk_mul_f32 v[40:41], v[40:41], v[120:121]
  v_pk_mul_f32 v[42:43], v[42:43], v[122:123]
  v_pk_mul_f32 v[44:45], v[44:45], v[124:125]
  v_pk_mul_f32 v[46:47], v[46:47], v[126:127]
  v_exp_f32 v40, v40
  v_exp_f32 v41, v41
  v_pk_mul_f32 v[136:137], v[136:137], v[120:121]
  v_exp_f32 v42, v42
  v_exp_f32 v43, v43
  v_pk_mul_f32 v[138:139], v[138:139], v[122:123]
  v_exp_f32 v44, v44
  v_exp_f32 v45, v45
  v_pk_mul_f32 v[140:141], v[140:141], v[124:125]
  v_exp_f32 v46, v46
  v_exp_f32 v47, v47
  v_pk_mul_f32 v[142:143], v[142:143], v[126:127]
  v_pk_fma_f32 v[40:41], v[40:41], v[26:27], v[26:27] op_sel:[0,0,0] op_sel_hi:[1,0,0]
  v_pk_fma_f32 v[42:43], v[42:43], v[26:27], v[26:27] op_sel:[0,0,0] op_sel_hi:[1,0,0]
  v_pk_fma_f32 v[44:45], v[44:45], v[30:31], v[30:31] op_sel:[0,0,0] op_sel_hi:[1,0,0]
  v_pk_fma_f32 v[46:47], v[46:47], v[30:31], v[30:31] op_sel:[0,0,0] op_sel_hi:[1,0,0]
  v_rcp_f32 v40, v40
  v_rcp_f32 v41, v41
  v_rcp_f32 v42, v42
  v_rcp_f32 v43, v43
  v_rcp_f32 v44, v44
  v_rcp_f32 v45, v45
  v_rcp_f32 v46, v46
  v_rcp_f32 v47, v47
  v_pk_mul_f32 v[136:137], v[136:137], v[40:41]
  v_pk_mul_f32 v[138:139], v[138:139], v[42:43]
  v_pk_mul_f32 v[140:141], v[140:141], v[44:45]
  v_pk_mul_f32 v[142:143], v[142:143], v[46:47]
  v_cvt_pk_bf16_f32 v52, v136, v137
  v_cvt_pk_bf16_f32 v53, v138, v139
  v_cvt_pk_bf16_f32 v54, v140, v141
  v_cvt_pk_bf16_f32 v55, v142, v143
  s_nop 0
  v_permlane16_swap_b32 v52, v54
  v_permlane16_swap_b32 v53, v55
  buffer_store_dwordx4 v[52:55], v11, s[12:15], s35 offen offset:0 sc1
  v_pk_mul_f32 v[32:33], v[144:145], v[144:145]
  v_pk_mul_f32 v[34:35], v[146:147], v[146:147]
  v_pk_mul_f32 v[36:37], v[148:149], v[148:149]
  v_pk_mul_f32 v[38:39], v[150:151], v[150:151]
  v_pk_fma_f32 v[32:33], v[32:33], v[16:17], v[16:17] op_sel:[0,0,1] op_sel_hi:[1,0,1]
  v_pk_fma_f32 v[34:35], v[34:35], v[16:17], v[16:17] op_sel:[0,0,1] op_sel_hi:[1,0,1]
  v_pk_fma_f32 v[36:37], v[36:37], v[20:21], v[20:21] op_sel:[0,0,1] op_sel_hi:[1,0,1]
  v_pk_fma_f32 v[38:39], v[38:39], v[20:21], v[20:21] op_sel:[0,0,1] op_sel_hi:[1,0,1]
  v_pk_mul_f32 v[32:33], v[32:33], v[144:145]
  v_pk_mul_f32 v[34:35], v[34:35], v[146:147]
  v_pk_mul_f32 v[36:37], v[36:37], v[148:149]
  v_pk_mul_f32 v[38:39], v[38:39], v[150:151]
  v_exp_f32 v32, v32
  v_exp_f32 v33, v33
  v_pk_mul_f32 v[160:161], v[160:161], v[144:145]
  v_exp_f32 v34, v34
  v_exp_f32 v35, v35
  v_pk_mul_f32 v[162:163], v[162:163], v[146:147]
  v_exp_f32 v36, v36
  v_exp_f32 v37, v37
  v_pk_mul_f32 v[164:165], v[164:165], v[148:149]
  v_exp_f32 v38, v38
  v_exp_f32 v39, v39
  v_pk_mul_f32 v[166:167], v[166:167], v[150:151]
  v_pk_fma_f32 v[32:33], v[32:33], v[18:19], v[18:19] op_sel:[0,0,0] op_sel_hi:[1,0,0]
  v_pk_fma_f32 v[34:35], v[34:35], v[18:19], v[18:19] op_sel:[0,0,0] op_sel_hi:[1,0,0]
  v_pk_fma_f32 v[36:37], v[36:37], v[22:23], v[22:23] op_sel:[0,0,0] op_sel_hi:[1,0,0]
  v_pk_fma_f32 v[38:39], v[38:39], v[22:23], v[22:23] op_sel:[0,0,0] op_sel_hi:[1,0,0]
  v_rcp_f32 v32, v32
  v_rcp_f32 v33, v33
  v_rcp_f32 v34, v34
  v_rcp_f32 v35, v35
  v_rcp_f32 v36, v36
  v_rcp_f32 v37, v37
  v_rcp_f32 v38, v38
  v_rcp_f32 v39, v39
  v_pk_mul_f32 v[160:161], v[160:161], v[32:33]
  v_pk_mul_f32 v[162:163], v[162:163], v[34:35]
  v_pk_mul_f32 v[164:165], v[164:165], v[36:37]
  v_pk_mul_f32 v[166:167], v[166:167], v[38:39]
  v_cvt_pk_bf16_f32 v56, v160, v161
  v_cvt_pk_bf16_f32 v57, v162, v163
  v_cvt_pk_bf16_f32 v58, v164, v165
  v_cvt_pk_bf16_f32 v59, v166, v167
  s_nop 0
  v_permlane16_swap_b32 v56, v58
  v_permlane16_swap_b32 v57, v59
  buffer_store_dwordx4 v[56:59], v11, s[12:15], s34 offen offset:1024 sc1
  v_pk_mul_f32 v[40:41], v[152:153], v[152:153]
  v_pk_mul_f32 v[42:43], v[154:155], v[154:155]
  v_pk_mul_f32 v[44:45], v[156:157], v[156:157]
  v_pk_mul_f32 v[46:47], v[158:159], v[158:159]
  v_pk_fma_f32 v[40:41], v[40:41], v[24:25], v[24:25] op_sel:[0,0,1] op_sel_hi:[1,0,1]
  v_pk_fma_f32 v[42:43], v[42:43], v[24:25], v[24:25] op_sel:[0,0,1] op_sel_hi:[1,0,1]
  v_pk_fma_f32 v[44:45], v[44:45], v[28:29], v[28:29] op_sel:[0,0,1] op_sel_hi:[1,0,1]
  v_pk_fma_f32 v[46:47], v[46:47], v[28:29], v[28:29] op_sel:[0,0,1] op_sel_hi:[1,0,1]
  v_pk_mul_f32 v[40:41], v[40:41], v[152:153]
  v_pk_mul_f32 v[42:43], v[42:43], v[154:155]
  v_pk_mul_f32 v[44:45], v[44:45], v[156:157]
  v_pk_mul_f32 v[46:47], v[46:47], v[158:159]
  v_exp_f32 v40, v40
  v_exp_f32 v41, v41
  v_pk_mul_f32 v[168:169], v[168:169], v[152:153]
  v_exp_f32 v42, v42
  v_exp_f32 v43, v43
  v_pk_mul_f32 v[170:171], v[170:171], v[154:155]
  v_exp_f32 v44, v44
  v_exp_f32 v45, v45
  v_pk_mul_f32 v[172:173], v[172:173], v[156:157]
  v_exp_f32 v46, v46
  v_exp_f32 v47, v47
  v_pk_mul_f32 v[174:175], v[174:175], v[158:159]
  v_pk_fma_f32 v[40:41], v[40:41], v[26:27], v[26:27] op_sel:[0,0,0] op_sel_hi:[1,0,0]
  v_pk_fma_f32 v[42:43], v[42:43], v[26:27], v[26:27] op_sel:[0,0,0] op_sel_hi:[1,0,0]
  v_pk_fma_f32 v[44:45], v[44:45], v[30:31], v[30:31] op_sel:[0,0,0] op_sel_hi:[1,0,0]
  v_pk_fma_f32 v[46:47], v[46:47], v[30:31], v[30:31] op_sel:[0,0,0] op_sel_hi:[1,0,0]
  v_rcp_f32 v40, v40
  v_rcp_f32 v41, v41
  v_rcp_f32 v42, v42
  v_rcp_f32 v43, v43
  v_rcp_f32 v44, v44
  v_rcp_f32 v45, v45
  v_rcp_f32 v46, v46
  v_rcp_f32 v47, v47
  v_pk_mul_f32 v[168:169], v[168:169], v[40:41]
  v_pk_mul_f32 v[170:171], v[170:171], v[42:43]
  v_pk_mul_f32 v[172:173], v[172:173], v[44:45]
  v_pk_mul_f32 v[174:175], v[174:175], v[46:47]
  v_cvt_pk_bf16_f32 v60, v168, v169
  v_cvt_pk_bf16_f32 v61, v170, v171
  v_cvt_pk_bf16_f32 v62, v172, v173
  v_cvt_pk_bf16_f32 v63, v174, v175
  s_nop 0
  v_permlane16_swap_b32 v60, v62
  v_permlane16_swap_b32 v61, v63
  buffer_store_dwordx4 v[60:63], v11, s[12:15], s35 offen offset:1024 sc1
  v_pk_mul_f32 v[32:33], v[176:177], v[176:177]
  v_pk_mul_f32 v[34:35], v[178:179], v[178:179]
  v_pk_mul_f32 v[36:37], v[180:181], v[180:181]
  v_pk_mul_f32 v[38:39], v[182:183], v[182:183]
  v_pk_fma_f32 v[32:33], v[32:33], v[16:17], v[16:17] op_sel:[0,0,1] op_sel_hi:[1,0,1]
  v_pk_fma_f32 v[34:35], v[34:35], v[16:17], v[16:17] op_sel:[0,0,1] op_sel_hi:[1,0,1]
  v_pk_fma_f32 v[36:37], v[36:37], v[20:21], v[20:21] op_sel:[0,0,1] op_sel_hi:[1,0,1]
  v_pk_fma_f32 v[38:39], v[38:39], v[20:21], v[20:21] op_sel:[0,0,1] op_sel_hi:[1,0,1]
  v_pk_mul_f32 v[32:33], v[32:33], v[176:177]
  v_pk_mul_f32 v[34:35], v[34:35], v[178:179]
  v_pk_mul_f32 v[36:37], v[36:37], v[180:181]
  v_pk_mul_f32 v[38:39], v[38:39], v[182:183]
  v_exp_f32 v32, v32
  v_exp_f32 v33, v33
  v_pk_mul_f32 v[192:193], v[192:193], v[176:177]
  v_exp_f32 v34, v34
  v_exp_f32 v35, v35
  v_pk_mul_f32 v[194:195], v[194:195], v[178:179]
  v_exp_f32 v36, v36
  v_exp_f32 v37, v37
  v_pk_mul_f32 v[196:197], v[196:197], v[180:181]
  v_exp_f32 v38, v38
  v_exp_f32 v39, v39
  v_pk_mul_f32 v[198:199], v[198:199], v[182:183]
  v_pk_fma_f32 v[32:33], v[32:33], v[18:19], v[18:19] op_sel:[0,0,0] op_sel_hi:[1,0,0]
  v_pk_fma_f32 v[34:35], v[34:35], v[18:19], v[18:19] op_sel:[0,0,0] op_sel_hi:[1,0,0]
  v_pk_fma_f32 v[36:37], v[36:37], v[22:23], v[22:23] op_sel:[0,0,0] op_sel_hi:[1,0,0]
  v_pk_fma_f32 v[38:39], v[38:39], v[22:23], v[22:23] op_sel:[0,0,0] op_sel_hi:[1,0,0]
  v_rcp_f32 v32, v32
  v_rcp_f32 v33, v33
  v_rcp_f32 v34, v34
  v_rcp_f32 v35, v35
  v_rcp_f32 v36, v36
  v_rcp_f32 v37, v37
  v_rcp_f32 v38, v38
  v_rcp_f32 v39, v39
  v_pk_mul_f32 v[192:193], v[192:193], v[32:33]
  v_pk_mul_f32 v[194:195], v[194:195], v[34:35]
  v_pk_mul_f32 v[196:197], v[196:197], v[36:37]
  v_pk_mul_f32 v[198:199], v[198:199], v[38:39]
  v_cvt_pk_bf16_f32 v48, v192, v193
  v_cvt_pk_bf16_f32 v49, v194, v195
  v_cvt_pk_bf16_f32 v50, v196, v197
  v_cvt_pk_bf16_f32 v51, v198, v199
  s_nop 0
  v_permlane16_swap_b32 v48, v50
  v_permlane16_swap_b32 v49, v51
  buffer_store_dwordx4 v[48:51], v11, s[12:15], s34 offen offset:2048 sc1
  v_pk_mul_f32 v[40:41], v[184:185], v[184:185]
  v_pk_mul_f32 v[42:43], v[186:187], v[186:187]
  v_pk_mul_f32 v[44:45], v[188:189], v[188:189]
  v_pk_mul_f32 v[46:47], v[190:191], v[190:191]
  v_pk_fma_f32 v[40:41], v[40:41], v[24:25], v[24:25] op_sel:[0,0,1] op_sel_hi:[1,0,1]
  v_pk_fma_f32 v[42:43], v[42:43], v[24:25], v[24:25] op_sel:[0,0,1] op_sel_hi:[1,0,1]
  v_pk_fma_f32 v[44:45], v[44:45], v[28:29], v[28:29] op_sel:[0,0,1] op_sel_hi:[1,0,1]
  v_pk_fma_f32 v[46:47], v[46:47], v[28:29], v[28:29] op_sel:[0,0,1] op_sel_hi:[1,0,1]
  v_pk_mul_f32 v[40:41], v[40:41], v[184:185]
  v_pk_mul_f32 v[42:43], v[42:43], v[186:187]
  v_pk_mul_f32 v[44:45], v[44:45], v[188:189]
  v_pk_mul_f32 v[46:47], v[46:47], v[190:191]
  v_exp_f32 v40, v40
  v_exp_f32 v41, v41
  v_pk_mul_f32 v[200:201], v[200:201], v[184:185]
  v_exp_f32 v42, v42
  v_exp_f32 v43, v43
  v_pk_mul_f32 v[202:203], v[202:203], v[186:187]
  v_exp_f32 v44, v44
  v_exp_f32 v45, v45
  v_pk_mul_f32 v[204:205], v[204:205], v[188:189]
  v_exp_f32 v46, v46
  v_exp_f32 v47, v47
  v_pk_mul_f32 v[206:207], v[206:207], v[190:191]
  v_pk_fma_f32 v[40:41], v[40:41], v[26:27], v[26:27] op_sel:[0,0,0] op_sel_hi:[1,0,0]
  v_pk_fma_f32 v[42:43], v[42:43], v[26:27], v[26:27] op_sel:[0,0,0] op_sel_hi:[1,0,0]
  v_pk_fma_f32 v[44:45], v[44:45], v[30:31], v[30:31] op_sel:[0,0,0] op_sel_hi:[1,0,0]
  v_pk_fma_f32 v[46:47], v[46:47], v[30:31], v[30:31] op_sel:[0,0,0] op_sel_hi:[1,0,0]
  v_rcp_f32 v40, v40
  v_rcp_f32 v41, v41
  v_rcp_f32 v42, v42
  v_rcp_f32 v43, v43
  v_rcp_f32 v44, v44
  v_rcp_f32 v45, v45
  v_rcp_f32 v46, v46
  v_rcp_f32 v47, v47
  v_pk_mul_f32 v[200:201], v[200:201], v[40:41]
  v_pk_mul_f32 v[202:203], v[202:203], v[42:43]
  v_pk_mul_f32 v[204:205], v[204:205], v[44:45]
  v_pk_mul_f32 v[206:207], v[206:207], v[46:47]
  v_cvt_pk_bf16_f32 v52, v200, v201
  v_cvt_pk_bf16_f32 v53, v202, v203
  v_cvt_pk_bf16_f32 v54, v204, v205
  v_cvt_pk_bf16_f32 v55, v206, v207
  s_nop 0
  v_permlane16_swap_b32 v52, v54
  v_permlane16_swap_b32 v53, v55
  buffer_store_dwordx4 v[52:55], v11, s[12:15], s35 offen offset:2048 sc1
  s_branch L_p4join_33
L_p4B1_35:
  s_add_u32 m0, s33, 0
  s_nop 0
  buffer_load_dwordx4 v10, s[12:15], s31 offen sc1 lds
  s_add_u32 s31, s31, 2048
  s_add_u32 m0, s33, 30720
  s_nop 0
  buffer_load_dwordx4 v10, s[12:15], s31 offen sc1 lds
  s_add_u32 s31, s31, 2048
  s_add_u32 m0, s33, 61440
  s_nop 0
  buffer_load_dwordx4 v10, s[12:15], s31 offen sc1 lds
  s_add_u32 s31, s31, 2048
  s_add_u32 m0, s33, 92160
  s_nop 0
  buffer_load_dwordx4 v10, s[12:15], s31 offen sc1 lds
  s_add_u32 s31, s31, 2048
  s_mov_b32 s28, s37
  buffer_load_dword v242, v250, s[12:15], s28 offen sc1
  s_add_u32 s28, s28, 8192
  buffer_load_dword v243, v250, s[12:15], s28 offen sc1
  s_add_u32 s28, s28, 8192
  buffer_load_dword v244, v250, s[12:15], s28 offen sc1
  s_add_u32 s28, s28, 8192
  buffer_load_dword v245, v250, s[12:15], s28 offen sc1
  s_add_u32 s28, s28, 8192
  buffer_load_dword v246, v250, s[12:15], s28 offen sc1
  s_add_u32 s28, s28, 8192
  buffer_load_dword v247, v250, s[12:15], s28 offen sc1
  s_add_u32 s28, s28, 8192
  buffer_load_dword v248, v250, s[12:15], s28 offen sc1
  s_add_u32 s28, s28, 8192
  buffer_load_dword v249, v250, s[12:15], s28 offen sc1
  s_waitcnt vmcnt(11)
  s_barrier
  ds_read_b64_tr_b16 v[16:17], v2 offset:0
  ds_read_b64_tr_b16 v[18:19], v2 offset:1792
  ds_read_b128 v[80:83], v4 offset:0
  ds_read_b128 v[84:87], v4 offset:256
  ds_read_b128 v[88:91], v4 offset:2048
  ds_read_b128 v[92:95], v4 offset:2304
  ds_read_b64_tr_b16 v[20:21], v2 offset:7168
  ds_read_b64_tr_b16 v[22:23], v2 offset:8960
  ds_read_b64_tr_b16 v[24:25], v2 offset:32
  ds_read_b64_tr_b16 v[26:27], v2 offset:1824
  ds_read_b64_tr_b16 v[28:29], v2 offset:7200
  ds_read_b64_tr_b16 v[30:31], v2 offset:8992
  ds_read_b64_tr_b16 v[32:33], v2 offset:64
  ds_read_b64_tr_b16 v[34:35], v2 offset:1856
  ds_read_b64_tr_b16 v[36:37], v2 offset:7232
  ds_read_b64_tr_b16 v[38:39], v2 offset:9024
  s_waitcnt vmcnt(10) lgkmcnt(0)
  s_barrier
  v_mfma_f32_16x16x32_bf16 v[112:115], v[16:19], v[80:83], v[112:115]
  ds_read_b64_tr_b16 v[48:49], v2 offset:30720
  v_mfma_f32_16x16x32_bf16 v[116:119], v[16:19], v[84:87], v[116:119]
  ds_read_b64_tr_b16 v[50:51], v2 offset:32512
  s_add_u32 m0, s32, 0
  v_mfma_f32_16x16x32_bf16 v[120:123], v[16:19], v[88:91], v[120:123]
  ds_read_b128 v[96:99], v4 offset:30720
  buffer_load_dwordx4 v6, s[8:11], s30 offen lds
  v_mfma_f32_16x16x32_bf16 v[124:127], v[16:19], v[92:95], v[124:127]
  ds_read_b128 v[100:103], v4 offset:30976
  v_mfma_f32_16x16x32_bf16 v[128:131], v[20:23], v[80:83], v[128:131]
  ds_read_b128 v[104:107], v4 offset:32768
  v_mfma_f32_16x16x32_bf16 v[132:135], v[20:23], v[84:87], v[132:135]
  ds_read_b128 v[108:111], v4 offset:33024
  v_mfma_f32_16x16x32_bf16 v[136:139], v[20:23], v[88:91], v[136:139]
  ds_read_b64_tr_b16 v[52:53], v2 offset:37888
  s_add_u32 m0, s32, 1024
  v_mfma_f32_16x16x32_bf16 v[140:143], v[20:23], v[92:95], v[140:143]
  ds_read_b64_tr_b16 v[54:55], v2 offset:39680
  buffer_load_dwordx4 v7, s[8:11], s30 offen lds
  v_mfma_f32_16x16x32_bf16 v[144:147], v[24:27], v[80:83], v[144:147]
  ds_read_b64_tr_b16 v[56:57], v2 offset:30752
  v_mfma_f32_16x16x32_bf16 v[148:151], v[24:27], v[84:87], v[148:151]
  ds_read_b64_tr_b16 v[58:59], v2 offset:32544
  v_mfma_f32_16x16x32_bf16 v[152:155], v[24:27], v[88:91], v[152:155]
  ds_read_b64_tr_b16 v[60:61], v2 offset:37920
  v_mfma_f32_16x16x32_bf16 v[156:159], v[24:27], v[92:95], v[156:159]
  ds_read_b64_tr_b16 v[62:63], v2 offset:39712
  s_add_u32 m0, s32, 2048
  v_mfma_f32_16x16x32_bf16 v[160:163], v[28:31], v[80:83], v[160:163]
  ds_read_b64_tr_b16 v[64:65], v2 offset:30784
  buffer_load_dwordx4 v8, s[8:11], s30 offen lds
  v_mfma_f32_16x16x32_bf16 v[164:167], v[28:31], v[84:87], v[164:167]
  ds_read_b64_tr_b16 v[66:67], v2 offset:32576
  v_mfma_f32_16x16x32_bf16 v[168:171], v[28:31], v[88:91], v[168:171]
  ds_read_b64_tr_b16 v[68:69], v2 offset:37952
  v_mfma_f32_16x16x32_bf16 v[172:175], v[28:31], v[92:95], v[172:175]
  ds_read_b64_tr_b16 v[70:71], v2 offset:39744
  v_mfma_f32_16x16x32_bf16 v[176:179], v[32:35], v[80:83], v[176:179]
  s_add_u32 m0, s33, 0
  v_mfma_f32_16x16x32_bf16 v[180:183], v[32:35], v[84:87], v[180:183]
  buffer_load_dwordx4 v10, s[12:15], s31 offen sc1 lds
  v_mfma_f32_16x16x32_bf16 v[184:187], v[32:35], v[88:91], v[184:187]
  v_mfma_f32_16x16x32_bf16 v[188:191], v[32:35], v[92:95], v[188:191]
  v_mfma_f32_16x16x32_bf16 v[192:195], v[36:39], v[80:83], v[192:195]
  v_mfma_f32_16x16x32_bf16 v[196:199], v[36:39], v[84:87], v[196:199]
  v_mfma_f32_16x16x32_bf16 v[200:203], v[36:39], v[88:91], v[200:203]
  v_mfma_f32_16x16x32_bf16 v[204:207], v[36:39], v[92:95], v[204:207]
  s_add_u32 s31, s31, 2048
  s_add_u32 s30, s30, 229376
  s_waitcnt vmcnt(13) lgkmcnt(0)
  s_barrier
  v_mfma_f32_16x16x32_bf16 v[112:115], v[48:51], v[96:99], v[112:115]
  ds_read_b64_tr_b16 v[16:17], v3 offset:0
  v_mfma_f32_16x16x32_bf16 v[116:119], v[48:51], v[100:103], v[116:119]
  ds_read_b64_tr_b16 v[18:19], v3 offset:1792
  s_add_u32 m0, s32, 30720
  v_mfma_f32_16x16x32_bf16 v[120:123], v[48:51], v[104:107], v[120:123]
  ds_read_b128 v[80:83], v5 offset:0
  buffer_load_dwordx4 v6, s[8:11], s30 offen lds
  v_mfma_f32_16x16x32_bf16 v[124:127], v[48:51], v[108:111], v[124:127]
  ds_read_b128 v[84:87], v5 offset:256
  v_mfma_f32_16x16x32_bf16 v[128:131], v[52:55], v[96:99], v[128:131]
  ds_read_b128 v[88:91], v5 offset:2048
  v_mfma_f32_16x16x32_bf16 v[132:135], v[52:55], v[100:103], v[132:135]
  ds_read_b128 v[92:95], v5 offset:2304
  v_mfma_f32_16x16x32_bf16 v[136:139], v[52:55], v[104:107], v[136:139]
  ds_read_b64_tr_b16 v[20:21], v3 offset:7168
  s_add_u32 m0, s32, 31744
  v_mfma_f32_16x16x32_bf16 v[140:143], v[52:55], v[108:111], v[140:143]
  ds_read_b64_tr_b16 v[22:23], v3 offset:8960
  buffer_load_dwordx4 v7, s[8:11], s30 offen lds
  v_mfma_f32_16x16x32_bf16 v[144:147], v[56:59], v[96:99], v[144:147]
  ds_read_b64_tr_b16 v[24:25], v3 offset:32
  v_mfma_f32_16x16x32_bf16 v[148:151], v[56:59], v[100:103], v[148:151]
  ds_read_b64_tr_b16 v[26:27], v3 offset:1824
  v_mfma_f32_16x16x32_bf16 v[152:155], v[56:59], v[104:107], v[152:155]
  ds_read_b64_tr_b16 v[28:29], v3 offset:7200
  v_mfma_f32_16x16x32_bf16 v[156:159], v[56:59], v[108:111], v[156:159]
  ds_read_b64_tr_b16 v[30:31], v3 offset:8992
  s_add_u32 m0, s32, 32768
  v_mfma_f32_16x16x32_bf16 v[160:163], v[60:63], v[96:99], v[160:163]
  ds_read_b64_tr_b16 v[32:33], v3 offset:64
  buffer_load_dwordx4 v8, s[8:11], s30 offen lds
  v_mfma_f32_16x16x32_bf16 v[164:167], v[60:63], v[100:103], v[164:167]
  ds_read_b64_tr_b16 v[34:35], v3 offset:1856
  v_mfma_f32_16x16x32_bf16 v[168:171], v[60:63], v[104:107], v[168:171]
  ds_read_b64_tr_b16 v[36:37], v3 offset:7232
  v_mfma_f32_16x16x32_bf16 v[172:175], v[60:63], v[108:111], v[172:175]
  ds_read_b64_tr_b16 v[38:39], v3 offset:9024
  v_mfma_f32_16x16x32_bf16 v[176:179], v[64:67], v[96:99], v[176:179]
  s_add_u32 m0, s33, 30720
  v_mfma_f32_16x16x32_bf16 v[180:183], v[64:67], v[100:103], v[180:183]
  buffer_load_dwordx4 v10, s[12:15], s31 offen sc1 lds
  v_mfma_f32_16x16x32_bf16 v[184:187], v[64:67], v[104:107], v[184:187]
  v_mfma_f32_16x16x32_bf16 v[188:191], v[64:67], v[108:111], v[188:191]
  v_mfma_f32_16x16x32_bf16 v[192:195], v[68:71], v[96:99], v[192:195]
  v_mfma_f32_16x16x32_bf16 v[196:199], v[68:71], v[100:103], v[196:199]
  v_mfma_f32_16x16x32_bf16 v[200:203], v[68:71], v[104:107], v[200:203]
  v_mfma_f32_16x16x32_bf16 v[204:207], v[68:71], v[108:111], v[204:207]
  s_add_u32 s31, s31, 2048
  s_add_u32 s30, s30, 229376
  s_waitcnt vmcnt(16) lgkmcnt(0)
  s_barrier
  v_mfma_f32_16x16x32_bf16 v[112:115], v[16:19], v[80:83], v[112:115]
  ds_read_b64_tr_b16 v[48:49], v3 offset:30720
  v_mfma_f32_16x16x32_bf16 v[116:119], v[16:19], v[84:87], v[116:119]
  ds_read_b64_tr_b16 v[50:51], v3 offset:32512
  s_add_u32 m0, s32, 61440
  v_mfma_f32_16x16x32_bf16 v[120:123], v[16:19], v[88:91], v[120:123]
  ds_read_b128 v[96:99], v5 offset:30720
  buffer_load_dwordx4 v6, s[8:11], s30 offen lds
  v_mfma_f32_16x16x32_bf16 v[124:127], v[16:19], v[92:95], v[124:127]
  ds_read_b128 v[100:103], v5 offset:30976
  v_mfma_f32_16x16x32_bf16 v[128:131], v[20:23], v[80:83], v[128:131]
  ds_read_b128 v[104:107], v5 offset:32768
  v_mfma_f32_16x16x32_bf16 v[132:135], v[20:23], v[84:87], v[132:135]
  ds_read_b128 v[108:111], v5 offset:33024
  v_mfma_f32_16x16x32_bf16 v[136:139], v[20:23], v[88:91], v[136:139]
  ds_read_b64_tr_b16 v[52:53], v3 offset:37888
  s_add_u32 m0, s32, 62464
  v_mfma_f32_16x16x32_bf16 v[140:143], v[20:23], v[92:95], v[140:143]
  ds_read_b64_tr_b16 v[54:55], v3 offset:39680
  buffer_load_dwordx4 v7, s[8:11], s30 offen lds
  v_mfma_f32_16x16x32_bf16 v[144:147], v[24:27], v[80:83], v[144:147]
  ds_read_b64_tr_b16 v[56:57], v3 offset:30752
  v_mfma_f32_16x16x32_bf16 v[148:151], v[24:27], v[84:87], v[148:151]
  ds_read_b64_tr_b16 v[58:59], v3 offset:32544
  v_mfma_f32_16x16x32_bf16 v[152:155], v[24:27], v[88:91], v[152:155]
  ds_read_b64_tr_b16 v[60:61], v3 offset:37920
  v_mfma_f32_16x16x32_bf16 v[156:159], v[24:27], v[92:95], v[156:159]
  ds_read_b64_tr_b16 v[62:63], v3 offset:39712
  s_add_u32 m0, s32, 63488
  v_mfma_f32_16x16x32_bf16 v[160:163], v[28:31], v[80:83], v[160:163]
  ds_read_b64_tr_b16 v[64:65], v3 offset:30784
  buffer_load_dwordx4 v8, s[8:11], s30 offen lds
  v_mfma_f32_16x16x32_bf16 v[164:167], v[28:31], v[84:87], v[164:167]
  ds_read_b64_tr_b16 v[66:67], v3 offset:32576
  v_mfma_f32_16x16x32_bf16 v[168:171], v[28:31], v[88:91], v[168:171]
  ds_read_b64_tr_b16 v[68:69], v3 offset:37952
  v_mfma_f32_16x16x32_bf16 v[172:175], v[28:31], v[92:95], v[172:175]
  ds_read_b64_tr_b16 v[70:71], v3 offset:39744
  v_mfma_f32_16x16x32_bf16 v[176:179], v[32:35], v[80:83], v[176:179]
  s_add_u32 m0, s33, 61440
  v_mfma_f32_16x16x32_bf16 v[180:183], v[32:35], v[84:87], v[180:183]
  buffer_load_dwordx4 v10, s[12:15], s31 offen sc1 lds
  v_mfma_f32_16x16x32_bf16 v[184:187], v[32:35], v[88:91], v[184:187]
  v_mfma_f32_16x16x32_bf16 v[188:191], v[32:35], v[92:95], v[188:191]
  v_mfma_f32_16x16x32_bf16 v[192:195], v[36:39], v[80:83], v[192:195]
  v_mfma_f32_16x16x32_bf16 v[196:199], v[36:39], v[84:87], v[196:199]
  v_mfma_f32_16x16x32_bf16 v[200:203], v[36:39], v[88:91], v[200:203]
  v_mfma_f32_16x16x32_bf16 v[204:207], v[36:39], v[92:95], v[204:207]
  s_add_u32 s31, s31, 2048
  s_add_u32 s30, s30, 229376
  s_waitcnt vmcnt(8) lgkmcnt(0)
  s_barrier
  v_mfma_f32_16x16x32_bf16 v[112:115], v[48:51], v[96:99], v[112:115]
  ds_read_b64_tr_b16 v[16:17], v2 offset:0
  v_mfma_f32_16x16x32_bf16 v[116:119], v[48:51], v[100:103], v[116:119]
  ds_read_b64_tr_b16 v[18:19], v2 offset:1792
  s_add_u32 m0, s32, 92160
  v_mfma_f32_16x16x32_bf16 v[120:123], v[48:51], v[104:107], v[120:123]
  ds_read_b128 v[80:83], v4 offset:0
  buffer_load_dwordx4 v6, s[8:11], s30 offen lds
  v_mfma_f32_16x16x32_bf16 v[124:127], v[48:51], v[108:111], v[124:127]
  ds_read_b128 v[84:87], v4 offset:256
  v_mfma_f32_16x16x32_bf16 v[128:131], v[52:55], v[96:99], v[128:131]
  ds_read_b128 v[88:91], v4 offset:2048
  v_add_f32 v242, v242, v243
  v_mfma_f32_16x16x32_bf16 v[132:135], v[52:55], v[100:103], v[132:135]
  ds_read_b128 v[92:95], v4 offset:2304
  v_add_f32 v244, v244, v245
  v_mfma_f32_16x16x32_bf16 v[136:139], v[52:55], v[104:107], v[136:139]
  ds_read_b64_tr_b16 v[20:21], v2 offset:7168
  s_add_u32 m0, s32, 93184
  v_add_f32 v246, v246, v247
  v_mfma_f32_16x16x32_bf16 v[140:143], v[52:55], v[108:111], v[140:143]
  ds_read_b64_tr_b16 v[22:23], v2 offset:8960
  buffer_load_dwordx4 v7, s[8:11], s30 offen lds
  v_add_f32 v248, v248, v249
  v_mfma_f32_16x16x32_bf16 v[144:147], v[56:59], v[96:99], v[144:147]
  ds_read_b64_tr_b16 v[24:25], v2 offset:32
  v_add_f32 v242, v242, v244
  v_mfma_f32_16x16x32_bf16 v[148:151], v[56:59], v[100:103], v[148:151]
  ds_read_b64_tr_b16 v[26:27], v2 offset:1824
  v_add_f32 v246, v246, v248
  v_mfma_f32_16x16x32_bf16 v[152:155], v[56:59], v[104:107], v[152:155]
  ds_read_b64_tr_b16 v[28:29], v2 offset:7200
  v_add_f32 v242, v242, v246
  v_mfma_f32_16x16x32_bf16 v[156:159], v[56:59], v[108:111], v[156:159]
  ds_read_b64_tr_b16 v[30:31], v2 offset:8992
  s_add_u32 m0, s32, 94208
  v_mov_b32 v243, v242
  v_mfma_f32_16x16x32_bf16 v[160:163], v[60:63], v[96:99], v[160:163]
  ds_read_b64_tr_b16 v[32:33], v2 offset:64
  buffer_load_dwordx4 v8, s[8:11], s30 offen lds
  s_nop 1
  v_mfma_f32_16x16x32_bf16 v[164:167], v[60:63], v[100:103], v[164:167]
  ds_read_b64_tr_b16 v[34:35], v2 offset:1856
  v_permlane32_swap_b32 v242, v243
  v_mfma_f32_16x16x32_bf16 v[168:171], v[60:63], v[104:107], v[168:171]
  ds_read_b64_tr_b16 v[36:37], v2 offset:7232
  v_add_f32 v242, v242, v243
  v_mfma_f32_16x16x32_bf16 v[172:175], v[60:63], v[108:111], v[172:175]
  ds_read_b64_tr_b16 v[38:39], v2 offset:9024
  v_mov_b32 v245, 0x3a800000
  v_mfma_f32_16x16x32_bf16 v[176:179], v[64:67], v[96:99], v[176:179]
  s_add_u32 m0, s33, 92160
  v_mov_b32 v247, 0x3727c5ac
  v_mfma_f32_16x16x32_bf16 v[180:183], v[64:67], v[100:103], v[180:183]
  buffer_load_dwordx4 v10, s[12:15], s31 offen sc1 lds
  v_fma_f32 v244, v242, v245, v247
  v_mfma_f32_16x16x32_bf16 v[184:187], v[64:67], v[104:107], v[184:187]
  v_rsq_f32 v246, v244
  v_mfma_f32_16x16x32_bf16 v[188:191], v[64:67], v[108:111], v[188:191]
  v_mov_b32 v245, 0
  v_mfma_f32_16x16x32_bf16 v[192:195], v[68:71], v[96:99], v[192:195]
  v_mul_f32 v243, 0xc0135761, v246
  v_mfma_f32_16x16x32_bf16 v[196:199], v[68:71], v[100:103], v[196:199]
  v_mul_f32 v247, v246, v246
  v_mfma_f32_16x16x32_bf16 v[200:203], v[68:71], v[104:107], v[200:203]
  v_mul_f32 v242, 0x3d372713, v243
  v_mfma_f32_16x16x32_bf16 v[204:207], v[68:71], v[108:111], v[204:207]
  s_add_u32 s31, s31, 2048
  s_add_u32 s30, s30, 229376
  v_mul_f32 v242, v242, v247
  ds_write_b128 v251, v[242:245]
  s_mov_b32 s36, 0
L_p4B1_38:
  s_waitcnt vmcnt(8) lgkmcnt(0)
  s_barrier
  v_mfma_f32_16x16x32_bf16 v[112:115], v[16:19], v[80:83], v[112:115]
  ds_read_b64_tr_b16 v[48:49], v2 offset:30720
  v_mfma_f32_16x16x32_bf16 v[116:119], v[16:19], v[84:87], v[116:119]
  ds_read_b64_tr_b16 v[50:51], v2 offset:32512
  s_add_u32 m0, s32, 0
  v_mfma_f32_16x16x32_bf16 v[120:123], v[16:19], v[88:91], v[120:123]
  ds_read_b128 v[96:99], v4 offset:30720
  buffer_load_dwordx4 v6, s[8:11], s30 offen lds
  v_mfma_f32_16x16x32_bf16 v[124:127], v[16:19], v[92:95], v[124:127]
  ds_read_b128 v[100:103], v4 offset:30976
  v_mfma_f32_16x16x32_bf16 v[128:131], v[20:23], v[80:83], v[128:131]
  ds_read_b128 v[104:107], v4 offset:32768
  v_mfma_f32_16x16x32_bf16 v[132:135], v[20:23], v[84:87], v[132:135]
  ds_read_b128 v[108:111], v4 offset:33024
  v_mfma_f32_16x16x32_bf16 v[136:139], v[20:23], v[88:91], v[136:139]
  ds_read_b64_tr_b16 v[52:53], v2 offset:37888
  s_add_u32 m0, s32, 1024
  v_mfma_f32_16x16x32_bf16 v[140:143], v[20:23], v[92:95], v[140:143]
  ds_read_b64_tr_b16 v[54:55], v2 offset:39680
  buffer_load_dwordx4 v7, s[8:11], s30 offen lds
  v_mfma_f32_16x16x32_bf16 v[144:147], v[24:27], v[80:83], v[144:147]
  ds_read_b64_tr_b16 v[56:57], v2 offset:30752
  v_mfma_f32_16x16x32_bf16 v[148:151], v[24:27], v[84:87], v[148:151]
  ds_read_b64_tr_b16 v[58:59], v2 offset:32544
  v_mfma_f32_16x16x32_bf16 v[152:155], v[24:27], v[88:91], v[152:155]
  ds_read_b64_tr_b16 v[60:61], v2 offset:37920
  v_mfma_f32_16x16x32_bf16 v[156:159], v[24:27], v[92:95], v[156:159]
  ds_read_b64_tr_b16 v[62:63], v2 offset:39712
  s_add_u32 m0, s32, 2048
  v_mfma_f32_16x16x32_bf16 v[160:163], v[28:31], v[80:83], v[160:163]
  ds_read_b64_tr_b16 v[64:65], v2 offset:30784
  buffer_load_dwordx4 v8, s[8:11], s30 offen lds
  v_mfma_f32_16x16x32_bf16 v[164:167], v[28:31], v[84:87], v[164:167]
  ds_read_b64_tr_b16 v[66:67], v2 offset:32576
  v_mfma_f32_16x16x32_bf16 v[168:171], v[28:31], v[88:91], v[168:171]
  ds_read_b64_tr_b16 v[68:69], v2 offset:37952
  v_mfma_f32_16x16x32_bf16 v[172:175], v[28:31], v[92:95], v[172:175]
  ds_read_b64_tr_b16 v[70:71], v2 offset:39744
  v_mfma_f32_16x16x32_bf16 v[176:179], v[32:35], v[80:83], v[176:179]
  s_add_u32 m0, s33, 0
  v_mfma_f32_16x16x32_bf16 v[180:183], v[32:35], v[84:87], v[180:183]
  buffer_load_dwordx4 v10, s[12:15], s31 offen sc1 lds
  v_mfma_f32_16x16x32_bf16 v[184:187], v[32:35], v[88:91], v[184:187]
  v_mfma_f32_16x16x32_bf16 v[188:191], v[32:35], v[92:95], v[188:191]
  v_mfma_f32_16x16x32_bf16 v[192:195], v[36:39], v[80:83], v[192:195]
  v_mfma_f32_16x16x32_bf16 v[196:199], v[36:39], v[84:87], v[196:199]
  v_mfma_f32_16x16x32_bf16 v[200:203], v[36:39], v[88:91], v[200:203]
  v_mfma_f32_16x16x32_bf16 v[204:207], v[36:39], v[92:95], v[204:207]
  s_add_u32 s31, s31, 2048
  s_add_u32 s30, s30, 229376
  s_waitcnt vmcnt(8) lgkmcnt(0)
  s_barrier
  v_mfma_f32_16x16x32_bf16 v[112:115], v[48:51], v[96:99], v[112:115]
  ds_read_b64_tr_b16 v[16:17], v3 offset:0
  v_mfma_f32_16x16x32_bf16 v[116:119], v[48:51], v[100:103], v[116:119]
  ds_read_b64_tr_b16 v[18:19], v3 offset:1792
  s_add_u32 m0, s32, 30720
  v_mfma_f32_16x16x32_bf16 v[120:123], v[48:51], v[104:107], v[120:123]
  ds_read_b128 v[80:83], v5 offset:0
  buffer_load_dwordx4 v6, s[8:11], s30 offen lds
  v_mfma_f32_16x16x32_bf16 v[124:127], v[48:51], v[108:111], v[124:127]
  ds_read_b128 v[84:87], v5 offset:256
  v_mfma_f32_16x16x32_bf16 v[128:131], v[52:55], v[96:99], v[128:131]
  ds_read_b128 v[88:91], v5 offset:2048
  v_mfma_f32_16x16x32_bf16 v[132:135], v[52:55], v[100:103], v[132:135]
  ds_read_b128 v[92:95], v5 offset:2304
  v_mfma_f32_16x16x32_bf16 v[136:139], v[52:55], v[104:107], v[136:139]
  ds_read_b64_tr_b16 v[20:21], v3 offset:7168
  s_add_u32 m0, s32, 31744
  v_mfma_f32_16x16x32_bf16 v[140:143], v[52:55], v[108:111], v[140:143]
  ds_read_b64_tr_b16 v[22:23], v3 offset:8960
  buffer_load_dwordx4 v7, s[8:11], s30 offen lds
  v_mfma_f32_16x16x32_bf16 v[144:147], v[56:59], v[96:99], v[144:147]
  ds_read_b64_tr_b16 v[24:25], v3 offset:32
  v_mfma_f32_16x16x32_bf16 v[148:151], v[56:59], v[100:103], v[148:151]
  ds_read_b64_tr_b16 v[26:27], v3 offset:1824
  v_mfma_f32_16x16x32_bf16 v[152:155], v[56:59], v[104:107], v[152:155]
  ds_read_b64_tr_b16 v[28:29], v3 offset:7200
  v_mfma_f32_16x16x32_bf16 v[156:159], v[56:59], v[108:111], v[156:159]
  ds_read_b64_tr_b16 v[30:31], v3 offset:8992
  s_add_u32 m0, s32, 32768
  v_mfma_f32_16x16x32_bf16 v[160:163], v[60:63], v[96:99], v[160:163]
  ds_read_b64_tr_b16 v[32:33], v3 offset:64
  buffer_load_dwordx4 v8, s[8:11], s30 offen lds
  v_mfma_f32_16x16x32_bf16 v[164:167], v[60:63], v[100:103], v[164:167]
  ds_read_b64_tr_b16 v[34:35], v3 offset:1856
  v_mfma_f32_16x16x32_bf16 v[168:171], v[60:63], v[104:107], v[168:171]
  ds_read_b64_tr_b16 v[36:37], v3 offset:7232
  v_mfma_f32_16x16x32_bf16 v[172:175], v[60:63], v[108:111], v[172:175]
  ds_read_b64_tr_b16 v[38:39], v3 offset:9024
  v_mfma_f32_16x16x32_bf16 v[176:179], v[64:67], v[96:99], v[176:179]
  s_add_u32 m0, s33, 30720
  v_mfma_f32_16x16x32_bf16 v[180:183], v[64:67], v[100:103], v[180:183]
  buffer_load_dwordx4 v10, s[12:15], s31 offen sc1 lds
  v_mfma_f32_16x16x32_bf16 v[184:187], v[64:67], v[104:107], v[184:187]
  v_mfma_f32_16x16x32_bf16 v[188:191], v[64:67], v[108:111], v[188:191]
  v_mfma_f32_16x16x32_bf16 v[192:195], v[68:71], v[96:99], v[192:195]
  v_mfma_f32_16x16x32_bf16 v[196:199], v[68:71], v[100:103], v[196:199]
  v_mfma_f32_16x16x32_bf16 v[200:203], v[68:71], v[104:107], v[200:203]
  v_mfma_f32_16x16x32_bf16 v[204:207], v[68:71], v[108:111], v[204:207]
  s_add_u32 s31, s31, 2048
  s_add_u32 s30, s30, 229376
  s_waitcnt vmcnt(8) lgkmcnt(0)
  s_barrier
  v_mfma_f32_16x16x32_bf16 v[112:115], v[16:19], v[80:83], v[112:115]
  ds_read_b64_tr_b16 v[48:49], v3 offset:30720
  v_mfma_f32_16x16x32_bf16 v[116:119], v[16:19], v[84:87], v[116:119]
  ds_read_b64_tr_b16 v[50:51], v3 offset:32512
  s_add_u32 m0, s32, 61440
  v_mfma_f32_16x16x32_bf16 v[120:123], v[16:19], v[88:91], v[120:123]
  ds_read_b128 v[96:99], v5 offset:30720
  buffer_load_dwordx4 v6, s[8:11], s30 offen lds
  v_mfma_f32_16x16x32_bf16 v[124:127], v[16:19], v[92:95], v[124:127]
  ds_read_b128 v[100:103], v5 offset:30976
  v_mfma_f32_16x16x32_bf16 v[128:131], v[20:23], v[80:83], v[128:131]
  ds_read_b128 v[104:107], v5 offset:32768
  v_mfma_f32_16x16x32_bf16 v[132:135], v[20:23], v[84:87], v[132:135]
  ds_read_b128 v[108:111], v5 offset:33024
  v_mfma_f32_16x16x32_bf16 v[136:139], v[20:23], v[88:91], v[136:139]
  ds_read_b64_tr_b16 v[52:53], v3 offset:37888
  s_add_u32 m0, s32, 62464
  v_mfma_f32_16x16x32_bf16 v[140:143], v[20:23], v[92:95], v[140:143]
  ds_read_b64_tr_b16 v[54:55], v3 offset:39680
  buffer_load_dwordx4 v7, s[8:11], s30 offen lds
  v_mfma_f32_16x16x32_bf16 v[144:147], v[24:27], v[80:83], v[144:147]
  ds_read_b64_tr_b16 v[56:57], v3 offset:30752
  v_mfma_f32_16x16x32_bf16 v[148:151], v[24:27], v[84:87], v[148:151]
  ds_read_b64_tr_b16 v[58:59], v3 offset:32544
  v_mfma_f32_16x16x32_bf16 v[152:155], v[24:27], v[88:91], v[152:155]
  ds_read_b64_tr_b16 v[60:61], v3 offset:37920
  v_mfma_f32_16x16x32_bf16 v[156:159], v[24:27], v[92:95], v[156:159]
  ds_read_b64_tr_b16 v[62:63], v3 offset:39712
  s_add_u32 m0, s32, 63488
  v_mfma_f32_16x16x32_bf16 v[160:163], v[28:31], v[80:83], v[160:163]
  ds_read_b64_tr_b16 v[64:65], v3 offset:30784
  buffer_load_dwordx4 v8, s[8:11], s30 offen lds
  v_mfma_f32_16x16x32_bf16 v[164:167], v[28:31], v[84:87], v[164:167]
  ds_read_b64_tr_b16 v[66:67], v3 offset:32576
  v_mfma_f32_16x16x32_bf16 v[168:171], v[28:31], v[88:91], v[168:171]
  ds_read_b64_tr_b16 v[68:69], v3 offset:37952
  v_mfma_f32_16x16x32_bf16 v[172:175], v[28:31], v[92:95], v[172:175]
  ds_read_b64_tr_b16 v[70:71], v3 offset:39744
  v_mfma_f32_16x16x32_bf16 v[176:179], v[32:35], v[80:83], v[176:179]
  s_add_u32 m0, s33, 61440
  v_mfma_f32_16x16x32_bf16 v[180:183], v[32:35], v[84:87], v[180:183]
  buffer_load_dwordx4 v10, s[12:15], s31 offen sc1 lds
  v_mfma_f32_16x16x32_bf16 v[184:187], v[32:35], v[88:91], v[184:187]
  v_mfma_f32_16x16x32_bf16 v[188:191], v[32:35], v[92:95], v[188:191]
  v_mfma_f32_16x16x32_bf16 v[192:195], v[36:39], v[80:83], v[192:195]
  v_mfma_f32_16x16x32_bf16 v[196:199], v[36:39], v[84:87], v[196:199]
  v_mfma_f32_16x16x32_bf16 v[200:203], v[36:39], v[88:91], v[200:203]
  v_mfma_f32_16x16x32_bf16 v[204:207], v[36:39], v[92:95], v[204:207]
  s_add_u32 s31, s31, 2048
  s_add_u32 s30, s30, 229376
  s_waitcnt vmcnt(8) lgkmcnt(0)
  s_barrier
  v_mfma_f32_16x16x32_bf16 v[112:115], v[48:51], v[96:99], v[112:115]
  ds_read_b64_tr_b16 v[16:17], v2 offset:0
  v_mfma_f32_16x16x32_bf16 v[116:119], v[48:51], v[100:103], v[116:119]
  ds_read_b64_tr_b16 v[18:19], v2 offset:1792
  s_add_u32 m0, s32, 92160
  v_mfma_f32_16x16x32_bf16 v[120:123], v[48:51], v[104:107], v[120:123]
  ds_read_b128 v[80:83], v4 offset:0
  buffer_load_dwordx4 v6, s[8:11], s30 offen lds
  v_mfma_f32_16x16x32_bf16 v[124:127], v[48:51], v[108:111], v[124:127]
  ds_read_b128 v[84:87], v4 offset:256
  v_mfma_f32_16x16x32_bf16 v[128:131], v[52:55], v[96:99], v[128:131]
  ds_read_b128 v[88:91], v4 offset:2048
  v_mfma_f32_16x16x32_bf16 v[132:135], v[52:55], v[100:103], v[132:135]
  ds_read_b128 v[92:95], v4 offset:2304
  v_mfma_f32_16x16x32_bf16 v[136:139], v[52:55], v[104:107], v[136:139]
  ds_read_b64_tr_b16 v[20:21], v2 offset:7168
  s_add_u32 m0, s32, 93184
  v_mfma_f32_16x16x32_bf16 v[140:143], v[52:55], v[108:111], v[140:143]
  ds_read_b64_tr_b16 v[22:23], v2 offset:8960
  buffer_load_dwordx4 v7, s[8:11], s30 offen lds
  v_mfma_f32_16x16x32_bf16 v[144:147], v[56:59], v[96:99], v[144:147]
  ds_read_b64_tr_b16 v[24:25], v2 offset:32
  v_mfma_f32_16x16x32_bf16 v[148:151], v[56:59], v[100:103], v[148:151]
  ds_read_b64_tr_b16 v[26:27], v2 offset:1824
  v_mfma_f32_16x16x32_bf16 v[152:155], v[56:59], v[104:107], v[152:155]
  ds_read_b64_tr_b16 v[28:29], v2 offset:7200
  v_mfma_f32_16x16x32_bf16 v[156:159], v[56:59], v[108:111], v[156:159]
  ds_read_b64_tr_b16 v[30:31], v2 offset:8992
  s_add_u32 m0, s32, 94208
  v_mfma_f32_16x16x32_bf16 v[160:163], v[60:63], v[96:99], v[160:163]
  ds_read_b64_tr_b16 v[32:33], v2 offset:64
  buffer_load_dwordx4 v8, s[8:11], s30 offen lds
  v_mfma_f32_16x16x32_bf16 v[164:167], v[60:63], v[100:103], v[164:167]
  ds_read_b64_tr_b16 v[34:35], v2 offset:1856
  v_mfma_f32_16x16x32_bf16 v[168:171], v[60:63], v[104:107], v[168:171]
  ds_read_b64_tr_b16 v[36:37], v2 offset:7232
  v_mfma_f32_16x16x32_bf16 v[172:175], v[60:63], v[108:111], v[172:175]
  ds_read_b64_tr_b16 v[38:39], v2 offset:9024
  v_mfma_f32_16x16x32_bf16 v[176:179], v[64:67], v[96:99], v[176:179]
  s_add_u32 m0, s33, 92160
  v_mfma_f32_16x16x32_bf16 v[180:183], v[64:67], v[100:103], v[180:183]
  buffer_load_dwordx4 v10, s[12:15], s31 offen sc1 lds
  v_mfma_f32_16x16x32_bf16 v[184:187], v[64:67], v[104:107], v[184:187]
  v_mfma_f32_16x16x32_bf16 v[188:191], v[64:67], v[108:111], v[188:191]
  v_mfma_f32_16x16x32_bf16 v[192:195], v[68:71], v[96:99], v[192:195]
  v_mfma_f32_16x16x32_bf16 v[196:199], v[68:71], v[100:103], v[196:199]
  v_mfma_f32_16x16x32_bf16 v[200:203], v[68:71], v[104:107], v[200:203]
  v_mfma_f32_16x16x32_bf16 v[204:207], v[68:71], v[108:111], v[204:207]
  s_add_u32 s31, s31, 2048
  s_add_u32 s30, s30, 229376
  s_add_u32 s36, s36, 1
  s_cmp_lt_u32 s36, 6
  s_cbranch_scc1 L_p4B1_38
  s_waitcnt vmcnt(8) lgkmcnt(0)
  s_barrier
  v_mfma_f32_16x16x32_bf16 v[112:115], v[16:19], v[80:83], v[112:115]
  ds_read_b64_tr_b16 v[48:49], v2 offset:30720
  v_mfma_f32_16x16x32_bf16 v[116:119], v[16:19], v[84:87], v[116:119]
  ds_read_b64_tr_b16 v[50:51], v2 offset:32512
  s_add_u32 m0, s51, 0
  v_mfma_f32_16x16x32_bf16 v[120:123], v[16:19], v[88:91], v[120:123]
  ds_read_b128 v[96:99], v4 offset:30720
  buffer_load_dwordx4 v240, s[12:15], s50 offen sc1 lds
  v_mfma_f32_16x16x32_bf16 v[124:127], v[16:19], v[92:95], v[124:127]
  ds_read_b128 v[100:103], v4 offset:30976
  v_mfma_f32_16x16x32_bf16 v[128:131], v[20:23], v[80:83], v[128:131]
  ds_read_b128 v[104:107], v4 offset:32768
  v_mfma_f32_16x16x32_bf16 v[132:135], v[20:23], v[84:87], v[132:135]
  ds_read_b128 v[108:111], v4 offset:33024
  v_mfma_f32_16x16x32_bf16 v[136:139], v[20:23], v[88:91], v[136:139]
  ds_read_b64_tr_b16 v[52:53], v2 offset:37888
  v_mfma_f32_16x16x32_bf16 v[140:143], v[20:23], v[92:95], v[140:143]
  ds_read_b64_tr_b16 v[54:55], v2 offset:39680
  v_mfma_f32_16x16x32_bf16 v[144:147], v[24:27], v[80:83], v[144:147]
  ds_read_b64_tr_b16 v[56:57], v2 offset:30752
  v_mfma_f32_16x16x32_bf16 v[148:151], v[24:27], v[84:87], v[148:151]
  ds_read_b64_tr_b16 v[58:59], v2 offset:32544
  v_mfma_f32_16x16x32_bf16 v[152:155], v[24:27], v[88:91], v[152:155]
  ds_read_b64_tr_b16 v[60:61], v2 offset:37920
  v_mfma_f32_16x16x32_bf16 v[156:159], v[24:27], v[92:95], v[156:159]
  ds_read_b64_tr_b16 v[62:63], v2 offset:39712
  s_add_u32 m0, s51, 1024
  v_mfma_f32_16x16x32_bf16 v[160:163], v[28:31], v[80:83], v[160:163]
  ds_read_b64_tr_b16 v[64:65], v2 offset:30784
  buffer_load_dwordx4 v241, s[12:15], s50 offen sc1 lds
  s_add_u32 s50, s50, 8192
  v_mfma_f32_16x16x32_bf16 v[164:167], v[28:31], v[84:87], v[164:167]
  ds_read_b64_tr_b16 v[66:67], v2 offset:32576
  v_mfma_f32_16x16x32_bf16 v[168:171], v[28:31], v[88:91], v[168:171]
  ds_read_b64_tr_b16 v[68:69], v2 offset:37952
  v_mfma_f32_16x16x32_bf16 v[172:175], v[28:31], v[92:95], v[172:175]
  ds_read_b64_tr_b16 v[70:71], v2 offset:39744
  v_mfma_f32_16x16x32_bf16 v[176:179], v[32:35], v[80:83], v[176:179]
  v_mfma_f32_16x16x32_bf16 v[180:183], v[32:35], v[84:87], v[180:183]
  v_mfma_f32_16x16x32_bf16 v[184:187], v[32:35], v[88:91], v[184:187]
  v_mfma_f32_16x16x32_bf16 v[188:191], v[32:35], v[92:95], v[188:191]
  v_mfma_f32_16x16x32_bf16 v[192:195], v[36:39], v[80:83], v[192:195]
  v_mfma_f32_16x16x32_bf16 v[196:199], v[36:39], v[84:87], v[196:199]
  v_mfma_f32_16x16x32_bf16 v[200:203], v[36:39], v[88:91], v[200:203]
  v_mfma_f32_16x16x32_bf16 v[204:207], v[36:39], v[92:95], v[204:207]
  s_waitcnt vmcnt(6) lgkmcnt(0)
  s_barrier
  v_mfma_f32_16x16x32_bf16 v[112:115], v[48:51], v[96:99], v[112:115]
  ds_read_b64_tr_b16 v[16:17], v3 offset:0
  v_mfma_f32_16x16x32_bf16 v[116:119], v[48:51], v[100:103], v[116:119]
  ds_read_b64_tr_b16 v[18:19], v3 offset:1792
  s_add_u32 m0, s51, 16384
  v_mfma_f32_16x16x32_bf16 v[120:123], v[48:51], v[104:107], v[120:123]
  ds_read_b128 v[80:83], v5 offset:0
  buffer_load_dwordx4 v240, s[12:15], s50 offen sc1 lds
  v_mfma_f32_16x16x32_bf16 v[124:127], v[48:51], v[108:111], v[124:127]
  ds_read_b128 v[84:87], v5 offset:256
  v_mfma_f32_16x16x32_bf16 v[128:131], v[52:55], v[96:99], v[128:131]
  ds_read_b128 v[88:91], v5 offset:2048
  v_mfma_f32_16x16x32_bf16 v[132:135], v[52:55], v[100:103], v[132:135]
  ds_read_b128 v[92:95], v5 offset:2304
  v_mfma_f32_16x16x32_bf16 v[136:139], v[52:55], v[104:107], v[136:139]
  ds_read_b64_tr_b16 v[20:21], v3 offset:7168
  s_add_u32 m0, s51, 17408
  v_mfma_f32_16x16x32_bf16 v[140:143], v[52:55], v[108:111], v[140:143]
  ds_read_b64_tr_b16 v[22:23], v3 offset:8960
  buffer_load_dwordx4 v241, s[12:15], s50 offen sc1 lds
  s_add_u32 s50, s50, 8192
  v_mfma_f32_16x16x32_bf16 v[144:147], v[56:59], v[96:99], v[144:147]
  ds_read_b64_tr_b16 v[24:25], v3 offset:32
  v_mfma_f32_16x16x32_bf16 v[148:151], v[56:59], v[100:103], v[148:151]
  ds_read_b64_tr_b16 v[26:27], v3 offset:1824
  v_mfma_f32_16x16x32_bf16 v[152:155], v[56:59], v[104:107], v[152:155]
  ds_read_b64_tr_b16 v[28:29], v3 offset:7200
  v_mfma_f32_16x16x32_bf16 v[156:159], v[56:59], v[108:111], v[156:159]
  ds_read_b64_tr_b16 v[30:31], v3 offset:8992
  s_add_u32 m0, s51, 32768
  v_mfma_f32_16x16x32_bf16 v[160:163], v[60:63], v[96:99], v[160:163]
  ds_read_b64_tr_b16 v[32:33], v3 offset:64
  buffer_load_dwordx4 v240, s[12:15], s50 offen sc1 lds
  v_mfma_f32_16x16x32_bf16 v[164:167], v[60:63], v[100:103], v[164:167]
  ds_read_b64_tr_b16 v[34:35], v3 offset:1856
  v_mfma_f32_16x16x32_bf16 v[168:171], v[60:63], v[104:107], v[168:171]
  ds_read_b64_tr_b16 v[36:37], v3 offset:7232
  v_mfma_f32_16x16x32_bf16 v[172:175], v[60:63], v[108:111], v[172:175]
  ds_read_b64_tr_b16 v[38:39], v3 offset:9024
  v_mfma_f32_16x16x32_bf16 v[176:179], v[64:67], v[96:99], v[176:179]
  s_add_u32 m0, s51, 33792
  v_mfma_f32_16x16x32_bf16 v[180:183], v[64:67], v[100:103], v[180:183]
  buffer_load_dwordx4 v241, s[12:15], s50 offen sc1 lds
  s_add_u32 s50, s50, 8192
  v_mfma_f32_16x16x32_bf16 v[184:187], v[64:67], v[104:107], v[184:187]
  v_mfma_f32_16x16x32_bf16 v[188:191], v[64:67], v[108:111], v[188:191]
  v_mfma_f32_16x16x32_bf16 v[192:195], v[68:71], v[96:99], v[192:195]
  v_mfma_f32_16x16x32_bf16 v[196:199], v[68:71], v[100:103], v[196:199]
  v_mfma_f32_16x16x32_bf16 v[200:203], v[68:71], v[104:107], v[200:203]
  v_mfma_f32_16x16x32_bf16 v[204:207], v[68:71], v[108:111], v[204:207]
  s_waitcnt vmcnt(6) lgkmcnt(0)
  s_barrier
  v_mfma_f32_16x16x32_bf16 v[112:115], v[16:19], v[80:83], v[112:115]
  ds_read_b64_tr_b16 v[48:49], v3 offset:30720
  v_mfma_f32_16x16x32_bf16 v[116:119], v[16:19], v[84:87], v[116:119]
  ds_read_b64_tr_b16 v[50:51], v3 offset:32512
  v_mfma_f32_16x16x32_bf16 v[120:123], v[16:19], v[88:91], v[120:123]
  ds_read_b128 v[96:99], v5 offset:30720
  v_mfma_f32_16x16x32_bf16 v[124:127], v[16:19], v[92:95], v[124:127]
  ds_read_b128 v[100:103], v5 offset:30976
  v_mfma_f32_16x16x32_bf16 v[128:131], v[20:23], v[80:83], v[128:131]
  ds_read_b128 v[104:107], v5 offset:32768
  v_mfma_f32_16x16x32_bf16 v[132:135], v[20:23], v[84:87], v[132:135]
  ds_read_b128 v[108:111], v5 offset:33024
  v_mfma_f32_16x16x32_bf16 v[136:139], v[20:23], v[88:91], v[136:139]
  ds_read_b64_tr_b16 v[52:53], v3 offset:37888
  v_mfma_f32_16x16x32_bf16 v[140:143], v[20:23], v[92:95], v[140:143]
  ds_read_b64_tr_b16 v[54:55], v3 offset:39680
  v_mfma_f32_16x16x32_bf16 v[144:147], v[24:27], v[80:83], v[144:147]
  ds_read_b64_tr_b16 v[56:57], v3 offset:30752
  v_mfma_f32_16x16x32_bf16 v[148:151], v[24:27], v[84:87], v[148:151]
  ds_read_b64_tr_b16 v[58:59], v3 offset:32544
  v_mfma_f32_16x16x32_bf16 v[152:155], v[24:27], v[88:91], v[152:155]
  ds_read_b64_tr_b16 v[60:61], v3 offset:37920
  v_mfma_f32_16x16x32_bf16 v[156:159], v[24:27], v[92:95], v[156:159]
  ds_read_b64_tr_b16 v[62:63], v3 offset:39712
  v_mfma_f32_16x16x32_bf16 v[160:163], v[28:31], v[80:83], v[160:163]
  ds_read_b64_tr_b16 v[64:65], v3 offset:30784
  v_mfma_f32_16x16x32_bf16 v[164:167], v[28:31], v[84:87], v[164:167]
  ds_read_b64_tr_b16 v[66:67], v3 offset:32576
  v_mfma_f32_16x16x32_bf16 v[168:171], v[28:31], v[88:91], v[168:171]
  ds_read_b64_tr_b16 v[68:69], v3 offset:37952
  v_mfma_f32_16x16x32_bf16 v[172:175], v[28:31], v[92:95], v[172:175]
  ds_read_b64_tr_b16 v[70:71], v3 offset:39744
  v_mfma_f32_16x16x32_bf16 v[176:179], v[32:35], v[80:83], v[176:179]
  v_mfma_f32_16x16x32_bf16 v[180:183], v[32:35], v[84:87], v[180:183]
  v_mfma_f32_16x16x32_bf16 v[184:187], v[32:35], v[88:91], v[184:187]
  v_mfma_f32_16x16x32_bf16 v[188:191], v[32:35], v[92:95], v[188:191]
  v_mfma_f32_16x16x32_bf16 v[192:195], v[36:39], v[80:83], v[192:195]
  v_mfma_f32_16x16x32_bf16 v[196:199], v[36:39], v[84:87], v[196:199]
  v_mfma_f32_16x16x32_bf16 v[200:203], v[36:39], v[88:91], v[200:203]
  v_mfma_f32_16x16x32_bf16 v[204:207], v[36:39], v[92:95], v[204:207]
  s_waitcnt lgkmcnt(0)
  v_mfma_f32_16x16x32_bf16 v[112:115], v[48:51], v[96:99], v[112:115]
  v_mfma_f32_16x16x32_bf16 v[116:119], v[48:51], v[100:103], v[116:119]
  v_mfma_f32_16x16x32_bf16 v[120:123], v[48:51], v[104:107], v[120:123]
  v_mfma_f32_16x16x32_bf16 v[124:127], v[48:51], v[108:111], v[124:127]
  v_mfma_f32_16x16x32_bf16 v[128:131], v[52:55], v[96:99], v[128:131]
  v_mfma_f32_16x16x32_bf16 v[132:135], v[52:55], v[100:103], v[132:135]
  v_mfma_f32_16x16x32_bf16 v[136:139], v[52:55], v[104:107], v[136:139]
  v_mfma_f32_16x16x32_bf16 v[140:143], v[52:55], v[108:111], v[140:143]
  v_mfma_f32_16x16x32_bf16 v[144:147], v[56:59], v[96:99], v[144:147]
  v_mfma_f32_16x16x32_bf16 v[148:151], v[56:59], v[100:103], v[148:151]
  v_mfma_f32_16x16x32_bf16 v[152:155], v[56:59], v[104:107], v[152:155]
  v_mfma_f32_16x16x32_bf16 v[156:159], v[56:59], v[108:111], v[156:159]
  v_mfma_f32_16x16x32_bf16 v[160:163], v[60:63], v[96:99], v[160:163]
  v_mfma_f32_16x16x32_bf16 v[164:167], v[60:63], v[100:103], v[164:167]
  v_mfma_f32_16x16x32_bf16 v[168:171], v[60:63], v[104:107], v[168:171]
  v_mfma_f32_16x16x32_bf16 v[172:175], v[60:63], v[108:111], v[172:175]
  v_mfma_f32_16x16x32_bf16 v[176:179], v[64:67], v[96:99], v[176:179]
  v_mfma_f32_16x16x32_bf16 v[180:183], v[64:67], v[100:103], v[180:183]
  v_mfma_f32_16x16x32_bf16 v[184:187], v[64:67], v[104:107], v[184:187]
  v_mfma_f32_16x16x32_bf16 v[188:191], v[64:67], v[108:111], v[188:191]
  v_mfma_f32_16x16x32_bf16 v[192:195], v[68:71], v[96:99], v[192:195]
  v_mfma_f32_16x16x32_bf16 v[196:199], v[68:71], v[100:103], v[196:199]
  v_mfma_f32_16x16x32_bf16 v[200:203], v[68:71], v[104:107], v[200:203]
  v_mfma_f32_16x16x32_bf16 v[204:207], v[68:71], v[108:111], v[204:207]
  v_and_b32 v12, 15, v1
  v_lshlrev_b32 v12, 4, v12
  s_lshl_b32 s27, s25, 10
  s_add_u32 s27, s27, 122880
  v_add_u32 v12, s27, v12
  ds_read_b128 v[16:19], v12 offset:0
  ds_read_b128 v[20:23], v12 offset:256
  ds_read_b128 v[24:27], v12 offset:512
  ds_read_b128 v[28:31], v12 offset:768
  s_waitcnt vmcnt(0) lgkmcnt(0)
  s_waitcnt vmcnt(0)
  s_barrier
  v_pk_mul_f32 v[32:33], v[112:113], v[112:113]
  v_pk_mul_f32 v[34:35], v[114:115], v[114:115]
  v_pk_mul_f32 v[36:37], v[116:117], v[116:117]
  v_pk_mul_f32 v[38:39], v[118:119], v[118:119]
  v_pk_fma_f32 v[32:33], v[32:33], v[16:17], v[16:17] op_sel:[0,0,1] op_sel_hi:[1,0,1]
  v_pk_fma_f32 v[34:35], v[34:35], v[16:17], v[16:17] op_sel:[0,0,1] op_sel_hi:[1,0,1]
  v_pk_fma_f32 v[36:37], v[36:37], v[20:21], v[20:21] op_sel:[0,0,1] op_sel_hi:[1,0,1]
  v_pk_fma_f32 v[38:39], v[38:39], v[20:21], v[20:21] op_sel:[0,0,1] op_sel_hi:[1,0,1]
  v_pk_mul_f32 v[32:33], v[32:33], v[112:113]
  v_pk_mul_f32 v[34:35], v[34:35], v[114:115]
  v_pk_mul_f32 v[36:37], v[36:37], v[116:117]
  v_pk_mul_f32 v[38:39], v[38:39], v[118:119]
  v_exp_f32 v32, v32
  v_exp_f32 v33, v33
  v_pk_mul_f32 v[128:129], v[128:129], v[112:113]
  v_exp_f32 v34, v34
  v_exp_f32 v35, v35
  v_pk_mul_f32 v[130:131], v[130:131], v[114:115]
  v_exp_f32 v36, v36
  v_exp_f32 v37, v37
  v_pk_mul_f32 v[132:133], v[132:133], v[116:117]
  v_exp_f32 v38, v38
  v_exp_f32 v39, v39
  v_pk_mul_f32 v[134:135], v[134:135], v[118:119]
  v_pk_fma_f32 v[32:33], v[32:33], v[18:19], v[18:19] op_sel:[0,0,0] op_sel_hi:[1,0,0]
  v_pk_fma_f32 v[34:35], v[34:35], v[18:19], v[18:19] op_sel:[0,0,0] op_sel_hi:[1,0,0]
  v_pk_fma_f32 v[36:37], v[36:37], v[22:23], v[22:23] op_sel:[0,0,0] op_sel_hi:[1,0,0]
  v_pk_fma_f32 v[38:39], v[38:39], v[22:23], v[22:23] op_sel:[0,0,0] op_sel_hi:[1,0,0]
  v_rcp_f32 v32, v32
  v_rcp_f32 v33, v33
  v_rcp_f32 v34, v34
  v_rcp_f32 v35, v35
  v_rcp_f32 v36, v36
  v_rcp_f32 v37, v37
  v_rcp_f32 v38, v38
  v_rcp_f32 v39, v39
  v_pk_mul_f32 v[128:129], v[128:129], v[32:33]
  v_pk_mul_f32 v[130:131], v[130:131], v[34:35]
  v_pk_mul_f32 v[132:133], v[132:133], v[36:37]
  v_pk_mul_f32 v[134:135], v[134:135], v[38:39]
  v_cvt_pk_bf16_f32 v48, v128, v129
  v_cvt_pk_bf16_f32 v49, v130, v131
  v_cvt_pk_bf16_f32 v50, v132, v133
  v_cvt_pk_bf16_f32 v51, v134, v135
  s_nop 0
  v_permlane16_swap_b32 v48, v50
  v_permlane16_swap_b32 v49, v51
  buffer_store_dwordx4 v[48:51], v11, s[12:15], s34 offen offset:0 sc1
  v_pk_mul_f32 v[40:41], v[120:121], v[120:121]
  v_pk_mul_f32 v[42:43], v[122:123], v[122:123]
  v_pk_mul_f32 v[44:45], v[124:125], v[124:125]
  v_pk_mul_f32 v[46:47], v[126:127], v[126:127]
  v_pk_fma_f32 v[40:41], v[40:41], v[24:25], v[24:25] op_sel:[0,0,1] op_sel_hi:[1,0,1]
  v_pk_fma_f32 v[42:43], v[42:43], v[24:25], v[24:25] op_sel:[0,0,1] op_sel_hi:[1,0,1]
  v_pk_fma_f32 v[44:45], v[44:45], v[28:29], v[28:29] op_sel:[0,0,1] op_sel_hi:[1,0,1]
  v_pk_fma_f32 v[46:47], v[46:47], v[28:29], v[28:29] op_sel:[0,0,1] op_sel_hi:[1,0,1]
  v_pk_mul_f32 v[40:41], v[40:41], v[120:121]
  v_pk_mul_f32 v[42:43], v[42:43], v[122:123]
  v_pk_mul_f32 v[44:45], v[44:45], v[124:125]
  v_pk_mul_f32 v[46:47], v[46:47], v[126:127]
  v_exp_f32 v40, v40
  v_exp_f32 v41, v41
  v_pk_mul_f32 v[136:137], v[136:137], v[120:121]
  v_exp_f32 v42, v42
  v_exp_f32 v43, v43
  v_pk_mul_f32 v[138:139], v[138:139], v[122:123]
  v_exp_f32 v44, v44
  v_exp_f32 v45, v45
  v_pk_mul_f32 v[140:141], v[140:141], v[124:125]
  v_exp_f32 v46, v46
  v_exp_f32 v47, v47
  v_pk_mul_f32 v[142:143], v[142:143], v[126:127]
  v_pk_fma_f32 v[40:41], v[40:41], v[26:27], v[26:27] op_sel:[0,0,0] op_sel_hi:[1,0,0]
  v_pk_fma_f32 v[42:43], v[42:43], v[26:27], v[26:27] op_sel:[0,0,0] op_sel_hi:[1,0,0]
  v_pk_fma_f32 v[44:45], v[44:45], v[30:31], v[30:31] op_sel:[0,0,0] op_sel_hi:[1,0,0]
  v_pk_fma_f32 v[46:47], v[46:47], v[30:31], v[30:31] op_sel:[0,0,0] op_sel_hi:[1,0,0]
  v_rcp_f32 v40, v40
  v_rcp_f32 v41, v41
  v_rcp_f32 v42, v42
  v_rcp_f32 v43, v43
  v_rcp_f32 v44, v44
  v_rcp_f32 v45, v45
  v_rcp_f32 v46, v46
  v_rcp_f32 v47, v47
  v_pk_mul_f32 v[136:137], v[136:137], v[40:41]
  v_pk_mul_f32 v[138:139], v[138:139], v[42:43]
  v_pk_mul_f32 v[140:141], v[140:141], v[44:45]
  v_pk_mul_f32 v[142:143], v[142:143], v[46:47]
  v_cvt_pk_bf16_f32 v52, v136, v137
  v_cvt_pk_bf16_f32 v53, v138, v139
  v_cvt_pk_bf16_f32 v54, v140, v141
  v_cvt_pk_bf16_f32 v55, v142, v143
  s_nop 0
  v_permlane16_swap_b32 v52, v54
  v_permlane16_swap_b32 v53, v55
  buffer_store_dwordx4 v[52:55], v11, s[12:15], s35 offen offset:0 sc1
  v_pk_mul_f32 v[32:33], v[144:145], v[144:145]
  v_pk_mul_f32 v[34:35], v[146:147], v[146:147]
  v_pk_mul_f32 v[36:37], v[148:149], v[148:149]
  v_pk_mul_f32 v[38:39], v[150:151], v[150:151]
  v_pk_fma_f32 v[32:33], v[32:33], v[16:17], v[16:17] op_sel:[0,0,1] op_sel_hi:[1,0,1]
  v_pk_fma_f32 v[34:35], v[34:35], v[16:17], v[16:17] op_sel:[0,0,1] op_sel_hi:[1,0,1]
  v_pk_fma_f32 v[36:37], v[36:37], v[20:21], v[20:21] op_sel:[0,0,1] op_sel_hi:[1,0,1]
  v_pk_fma_f32 v[38:39], v[38:39], v[20:21], v[20:21] op_sel:[0,0,1] op_sel_hi:[1,0,1]
  v_pk_mul_f32 v[32:33], v[32:33], v[144:145]
  v_pk_mul_f32 v[34:35], v[34:35], v[146:147]
  v_pk_mul_f32 v[36:37], v[36:37], v[148:149]
  v_pk_mul_f32 v[38:39], v[38:39], v[150:151]
  v_exp_f32 v32, v32
  v_exp_f32 v33, v33
  v_pk_mul_f32 v[160:161], v[160:161], v[144:145]
  v_exp_f32 v34, v34
  v_exp_f32 v35, v35
  v_pk_mul_f32 v[162:163], v[162:163], v[146:147]
  v_exp_f32 v36, v36
  v_exp_f32 v37, v37
  v_pk_mul_f32 v[164:165], v[164:165], v[148:149]
  v_exp_f32 v38, v38
  v_exp_f32 v39, v39
  v_pk_mul_f32 v[166:167], v[166:167], v[150:151]
  v_pk_fma_f32 v[32:33], v[32:33], v[18:19], v[18:19] op_sel:[0,0,0] op_sel_hi:[1,0,0]
  v_pk_fma_f32 v[34:35], v[34:35], v[18:19], v[18:19] op_sel:[0,0,0] op_sel_hi:[1,0,0]
  v_pk_fma_f32 v[36:37], v[36:37], v[22:23], v[22:23] op_sel:[0,0,0] op_sel_hi:[1,0,0]
  v_pk_fma_f32 v[38:39], v[38:39], v[22:23], v[22:23] op_sel:[0,0,0] op_sel_hi:[1,0,0]
  v_rcp_f32 v32, v32
  v_rcp_f32 v33, v33
  v_rcp_f32 v34, v34
  v_rcp_f32 v35, v35
  v_rcp_f32 v36, v36
  v_rcp_f32 v37, v37
  v_rcp_f32 v38, v38
  v_rcp_f32 v39, v39
  v_pk_mul_f32 v[160:161], v[160:161], v[32:33]
  v_pk_mul_f32 v[162:163], v[162:163], v[34:35]
  v_pk_mul_f32 v[164:165], v[164:165], v[36:37]
  v_pk_mul_f32 v[166:167], v[166:167], v[38:39]
  v_cvt_pk_bf16_f32 v56, v160, v161
  v_cvt_pk_bf16_f32 v57, v162, v163
  v_cvt_pk_bf16_f32 v58, v164, v165
  v_cvt_pk_bf16_f32 v59, v166, v167
  s_nop 0
  v_permlane16_swap_b32 v56, v58
  v_permlane16_swap_b32 v57, v59
  buffer_store_dwordx4 v[56:59], v11, s[12:15], s34 offen offset:1024 sc1
  v_pk_mul_f32 v[40:41], v[152:153], v[152:153]
  v_pk_mul_f32 v[42:43], v[154:155], v[154:155]
  v_pk_mul_f32 v[44:45], v[156:157], v[156:157]
  v_pk_mul_f32 v[46:47], v[158:159], v[158:159]
  v_pk_fma_f32 v[40:41], v[40:41], v[24:25], v[24:25] op_sel:[0,0,1] op_sel_hi:[1,0,1]
  v_pk_fma_f32 v[42:43], v[42:43], v[24:25], v[24:25] op_sel:[0,0,1] op_sel_hi:[1,0,1]
  v_pk_fma_f32 v[44:45], v[44:45], v[28:29], v[28:29] op_sel:[0,0,1] op_sel_hi:[1,0,1]
  v_pk_fma_f32 v[46:47], v[46:47], v[28:29], v[28:29] op_sel:[0,0,1] op_sel_hi:[1,0,1]
  v_pk_mul_f32 v[40:41], v[40:41], v[152:153]
  v_pk_mul_f32 v[42:43], v[42:43], v[154:155]
  v_pk_mul_f32 v[44:45], v[44:45], v[156:157]
  v_pk_mul_f32 v[46:47], v[46:47], v[158:159]
  v_exp_f32 v40, v40
  v_exp_f32 v41, v41
  v_pk_mul_f32 v[168:169], v[168:169], v[152:153]
  v_exp_f32 v42, v42
  v_exp_f32 v43, v43
  v_pk_mul_f32 v[170:171], v[170:171], v[154:155]
  v_exp_f32 v44, v44
  v_exp_f32 v45, v45
  v_pk_mul_f32 v[172:173], v[172:173], v[156:157]
  v_exp_f32 v46, v46
  v_exp_f32 v47, v47
  v_pk_mul_f32 v[174:175], v[174:175], v[158:159]
  v_pk_fma_f32 v[40:41], v[40:41], v[26:27], v[26:27] op_sel:[0,0,0] op_sel_hi:[1,0,0]
  v_pk_fma_f32 v[42:43], v[42:43], v[26:27], v[26:27] op_sel:[0,0,0] op_sel_hi:[1,0,0]
  v_pk_fma_f32 v[44:45], v[44:45], v[30:31], v[30:31] op_sel:[0,0,0] op_sel_hi:[1,0,0]
  v_pk_fma_f32 v[46:47], v[46:47], v[30:31], v[30:31] op_sel:[0,0,0] op_sel_hi:[1,0,0]
  v_rcp_f32 v40, v40
  v_rcp_f32 v41, v41
  v_rcp_f32 v42, v42
  v_rcp_f32 v43, v43
  v_rcp_f32 v44, v44
  v_rcp_f32 v45, v45
  v_rcp_f32 v46, v46
  v_rcp_f32 v47, v47
  v_pk_mul_f32 v[168:169], v[168:169], v[40:41]
  v_pk_mul_f32 v[170:171], v[170:171], v[42:43]
  v_pk_mul_f32 v[172:173], v[172:173], v[44:45]
  v_pk_mul_f32 v[174:175], v[174:175], v[46:47]
  v_cvt_pk_bf16_f32 v60, v168, v169
  v_cvt_pk_bf16_f32 v61, v170, v171
  v_cvt_pk_bf16_f32 v62, v172, v173
  v_cvt_pk_bf16_f32 v63, v174, v175
  s_nop 0
  v_permlane16_swap_b32 v60, v62
  v_permlane16_swap_b32 v61, v63
  buffer_store_dwordx4 v[60:63], v11, s[12:15], s35 offen offset:1024 sc1
  v_pk_mul_f32 v[32:33], v[176:177], v[176:177]
  v_pk_mul_f32 v[34:35], v[178:179], v[178:179]
  v_pk_mul_f32 v[36:37], v[180:181], v[180:181]
  v_pk_mul_f32 v[38:39], v[182:183], v[182:183]
  v_pk_fma_f32 v[32:33], v[32:33], v[16:17], v[16:17] op_sel:[0,0,1] op_sel_hi:[1,0,1]
  v_pk_fma_f32 v[34:35], v[34:35], v[16:17], v[16:17] op_sel:[0,0,1] op_sel_hi:[1,0,1]
  v_pk_fma_f32 v[36:37], v[36:37], v[20:21], v[20:21] op_sel:[0,0,1] op_sel_hi:[1,0,1]
  v_pk_fma_f32 v[38:39], v[38:39], v[20:21], v[20:21] op_sel:[0,0,1] op_sel_hi:[1,0,1]
  v_pk_mul_f32 v[32:33], v[32:33], v[176:177]
  v_pk_mul_f32 v[34:35], v[34:35], v[178:179]
  v_pk_mul_f32 v[36:37], v[36:37], v[180:181]
  v_pk_mul_f32 v[38:39], v[38:39], v[182:183]
  v_exp_f32 v32, v32
  v_exp_f32 v33, v33
  v_pk_mul_f32 v[192:193], v[192:193], v[176:177]
  v_exp_f32 v34, v34
  v_exp_f32 v35, v35
  v_pk_mul_f32 v[194:195], v[194:195], v[178:179]
  v_exp_f32 v36, v36
  v_exp_f32 v37, v37
  v_pk_mul_f32 v[196:197], v[196:197], v[180:181]
  v_exp_f32 v38, v38
  v_exp_f32 v39, v39
  v_pk_mul_f32 v[198:199], v[198:199], v[182:183]
  v_pk_fma_f32 v[32:33], v[32:33], v[18:19], v[18:19] op_sel:[0,0,0] op_sel_hi:[1,0,0]
  v_pk_fma_f32 v[34:35], v[34:35], v[18:19], v[18:19] op_sel:[0,0,0] op_sel_hi:[1,0,0]
  v_pk_fma_f32 v[36:37], v[36:37], v[22:23], v[22:23] op_sel:[0,0,0] op_sel_hi:[1,0,0]
  v_pk_fma_f32 v[38:39], v[38:39], v[22:23], v[22:23] op_sel:[0,0,0] op_sel_hi:[1,0,0]
  v_rcp_f32 v32, v32
  v_rcp_f32 v33, v33
  v_rcp_f32 v34, v34
  v_rcp_f32 v35, v35
  v_rcp_f32 v36, v36
  v_rcp_f32 v37, v37
  v_rcp_f32 v38, v38
  v_rcp_f32 v39, v39
  v_pk_mul_f32 v[192:193], v[192:193], v[32:33]
  v_pk_mul_f32 v[194:195], v[194:195], v[34:35]
  v_pk_mul_f32 v[196:197], v[196:197], v[36:37]
  v_pk_mul_f32 v[198:199], v[198:199], v[38:39]
  v_cvt_pk_bf16_f32 v48, v192, v193
  v_cvt_pk_bf16_f32 v49, v194, v195
  v_cvt_pk_bf16_f32 v50, v196, v197
  v_cvt_pk_bf16_f32 v51, v198, v199
  s_nop 0
  v_permlane16_swap_b32 v48, v50
  v_permlane16_swap_b32 v49, v51
  buffer_store_dwordx4 v[48:51], v11, s[12:15], s34 offen offset:2048 sc1
  v_pk_mul_f32 v[40:41], v[184:185], v[184:185]
  v_pk_mul_f32 v[42:43], v[186:187], v[186:187]
  v_pk_mul_f32 v[44:45], v[188:189], v[188:189]
  v_pk_mul_f32 v[46:47], v[190:191], v[190:191]
  v_pk_fma_f32 v[40:41], v[40:41], v[24:25], v[24:25] op_sel:[0,0,1] op_sel_hi:[1,0,1]
  v_pk_fma_f32 v[42:43], v[42:43], v[24:25], v[24:25] op_sel:[0,0,1] op_sel_hi:[1,0,1]
  v_pk_fma_f32 v[44:45], v[44:45], v[28:29], v[28:29] op_sel:[0,0,1] op_sel_hi:[1,0,1]
  v_pk_fma_f32 v[46:47], v[46:47], v[28:29], v[28:29] op_sel:[0,0,1] op_sel_hi:[1,0,1]
  v_pk_mul_f32 v[40:41], v[40:41], v[184:185]
  v_pk_mul_f32 v[42:43], v[42:43], v[186:187]
  v_pk_mul_f32 v[44:45], v[44:45], v[188:189]
  v_pk_mul_f32 v[46:47], v[46:47], v[190:191]
  v_exp_f32 v40, v40
  v_exp_f32 v41, v41
  v_pk_mul_f32 v[200:201], v[200:201], v[184:185]
  v_exp_f32 v42, v42
  v_exp_f32 v43, v43
  v_pk_mul_f32 v[202:203], v[202:203], v[186:187]
  v_exp_f32 v44, v44
  v_exp_f32 v45, v45
  v_pk_mul_f32 v[204:205], v[204:205], v[188:189]
  v_exp_f32 v46, v46
  v_exp_f32 v47, v47
  v_pk_mul_f32 v[206:207], v[206:207], v[190:191]
  v_pk_fma_f32 v[40:41], v[40:41], v[26:27], v[26:27] op_sel:[0,0,0] op_sel_hi:[1,0,0]
  v_pk_fma_f32 v[42:43], v[42:43], v[26:27], v[26:27] op_sel:[0,0,0] op_sel_hi:[1,0,0]
  v_pk_fma_f32 v[44:45], v[44:45], v[30:31], v[30:31] op_sel:[0,0,0] op_sel_hi:[1,0,0]
  v_pk_fma_f32 v[46:47], v[46:47], v[30:31], v[30:31] op_sel:[0,0,0] op_sel_hi:[1,0,0]
  v_rcp_f32 v40, v40
  v_rcp_f32 v41, v41
  v_rcp_f32 v42, v42
  v_rcp_f32 v43, v43
  v_rcp_f32 v44, v44
  v_rcp_f32 v45, v45
  v_rcp_f32 v46, v46
  v_rcp_f32 v47, v47
  v_pk_mul_f32 v[200:201], v[200:201], v[40:41]
  v_pk_mul_f32 v[202:203], v[202:203], v[42:43]
  v_pk_mul_f32 v[204:205], v[204:205], v[44:45]
  v_pk_mul_f32 v[206:207], v[206:207], v[46:47]
  v_cvt_pk_bf16_f32 v52, v200, v201
  v_cvt_pk_bf16_f32 v53, v202, v203
  v_cvt_pk_bf16_f32 v54, v204, v205
  v_cvt_pk_bf16_f32 v55, v206, v207
  s_nop 0
  v_permlane16_swap_b32 v52, v54
  v_permlane16_swap_b32 v53, v55
  buffer_store_dwordx4 v[52:55], v11, s[12:15], s35 offen offset:2048 sc1
L_p4join_33:
  s_lshl_b32 s27, s23, 7
  s_add_u32 s27, s27, 41684992
  s_waitcnt vmcnt(0)
  s_barrier
  s_cmp_lg_u32 s20, 0
  s_cbranch_scc1 L_nosig_39
  s_mov_b64 exec, 1
  v_mov_b32 v12, 1
  v_mov_b32 v13, 0
  buffer_atomic_add v12, v13, s[12:15], s27 offen sc1
  s_mov_b64 exec, -1
L_nosig_39:
  s_and_b32 s21, s2, 7
  s_lshr_b32 s22, s2, 3
  s_and_b32 s23, s21, 3
  s_lshl_b32 s23, s23, 2
  s_and_b32 s25, s22, 3
  s_add_u32 s23, s23, s25
  s_lshr_b32 s24, s21, 2
  s_lshl_b32 s24, s24, 3
  s_lshr_b32 s25, s22, 2
  s_add_u32 s24, s24, s25
  s_and_b32 s25, s20, 3
  s_lshr_b32 s26, s20, 2
  s_lshl_b32 s31, s23, 2
  s_add_u32 s31, s31, s25
  s_mul_i32 s31, s31, 229376
  s_lshl_b32 s28, s26, 11
  s_add_u32 s31, s31, s28
  s_add_u32 s31, s31, 25165824
  s_and_b32 s28, s24, 1
  s_mul_i32 s28, s28, 114688
  s_add_u32 s31, s31, s28
  v_lshrrev_b32 v12, 4, v1
  v_and_b32 v13, 15, v1
  v_lshlrev_b32 v14, 4, v13
  v_lshl_add_u32 v14, v12, 9, v14
  s_lshl_b32 s28, s26, 8
  v_add_u32 v6, s28, v14
  v_xor_b32 v7, 256, v6
  s_lshl_b32 s33, s23, 2
  s_add_u32 s33, s33, s25
  s_lshl_b32 s33, s33, 1
  s_add_u32 s33, s33, s26
  s_lshl_b32 s33, s33, 15
  s_lshl_b32 s28, s24, 7
  s_add_u32 s33, s33, s28
  s_add_u32 s34, s33, 16384
  s_lshl_b32 s28, s20, 11
  s_add_u32 s28, s28, 147456
  v_lshl_add_u32 v9, v1, 4, s28
  v_lshlrev_b32 v201, 4, v1
  s_lshl_b32 s38, s23, 4
  s_add_u32 s38, s38, s24
  s_xor_b32 s39, s38, 1
  s_lshl_b32 s28, s20, 11
  s_add_u32 s28, s28, 58720256
  s_lshl_b32 s40, s39, 10
  s_add_u32 s40, s40, 62914560
  v_mov_b32 v203, 0
  buffer_load_dword v202, v203, s[12:15], s40 offen sc1
  s_lshl_b32 s38, s38, 14
  s_add_u32 s38, s38, s28
  s_lshl_b32 s39, s39, 14
  s_add_u32 s39, s39, s28
  v_bfe_u32 v13, v1, 2, 2
  v_lshrrev_b32 v14, 1, v12
  v_and_b32 v15, 1, v12
  v_lshlrev_b32 v14, 4, v14
  v_lshl_add_u32 v14, v15, 2, v14
  v_add_u32 v14, v14, v13
  v_lshlrev_b32 v14, 7, v14
  v_lshrrev_b32 v13, 1, v13
  v_lshl_add_u32 v13, v15, 1, v13
  v_and_b32 v15, 3, v1
  v_lshl_add_u32 v14, v15, 3, v14
  s_lshl_b32 s28, s26, 12
  v_add_u32 v14, s28, v14
  v_xor_b32 v15, 0, v13
  v_lshl_add_u32 v2, v15, 5, v14
  v_xor_b32 v15, 1, v13
  v_lshl_add_u32 v3, v15, 5, v14
  v_xor_b32 v15, 2, v13
  v_lshl_add_u32 v4, v15, 5, v14
  v_xor_b32 v15, 3, v13
  v_lshl_add_u32 v5, v15, 5, v14
  v_add_u32 v204, 65536, v2
  v_add_u32 v205, 65536, v3
  v_add_u32 v206, 65536, v4
  v_add_u32 v207, 65536, v5
  s_mov_b32 s16, s78
  s_mov_b32 s17, s79
  s_mov_b32 s18, 0x400000
  s_mov_b32 s19, 0x20000
  v_and_b32 v12, 15, v1
  v_lshrrev_b32 v13, 4, v1
  v_and_b32 v14, 1, v13
  v_lshlrev_b32 v14, 1, v14
  v_lshrrev_b32 v13, 1, v13
  v_add_u32 v13, v13, v14
  v_xor_b32 v13, v13, v12
  v_and_b32 v13, 7, v13
  v_lshlrev_b32 v13, 4, v13
  s_lshl_b32 s28, s20, 13
  s_xor_b32 s28, s28, 32768
  s_add_u32 s28, s28, 81920
  v_lshl_add_u32 v13, v12, 7, v13
  v_add_u32 v8, s28, v13
  v_xor_b32 v10, 64, v8
  v_lshrrev_b32 v12, 3, v1
  v_and_b32 v13, 7, v1
  v_lshlrev_b32 v11, 11, v12
  v_lshl_add_u32 v11, v13, 4, v11
  v_xor_b32 v13, v13, v12
  v_lshlrev_b32 v13, 4, v13
  v_lshl_add_u32 v13, v12, 7, v13
  v_add_u32 v200, s28, v13
  s_lshl_b32 s27, s20, 13
  s_add_u32 s27, s27, 81920
  v_add_u32 v13, s27, v201
  v_add_u32 v14, s28, v201
  v_mov_b32 v15, 0xffff0000
  v_and_b32 v12, 15, v1
  v_lshrrev_b32 v208, 5, v1
  v_lshrrev_b32 v209, 1, v12
  v_xor_b32 v208, v208, v209
  v_lshlrev_b32 v208, 4, v208
  v_lshl_add_u32 v208, v12, 7, v208
  v_bfe_u32 v209, v1, 4, 1
  v_lshl_add_u32 v208, v209, 3, v208
  v_add_u32 v216, s28, v208
  v_xor_b32 v217, 32, v216
  v_xor_b32 v218, 64, v216
  v_xor_b32 v219, 96, v216
  v_and_b32 v208, 7, v1
  v_lshrrev_b32 v209, 4, v1
  v_xor_b32 v208, v208, v209
  v_lshlrev_b32 v208, 4, v208
  v_lshrrev_b32 v209, 3, v1
  v_lshl_add_u32 v208, v209, 7, v208
  v_add_u32 v200, s28, v208
  v_xor_b32 v220, 64, v200
  ds_read_b128 v[16:19], v9 offset:0
  ds_read_b128 v[20:23], v9 offset:1024
  v_mov_b32 v56, 0
  v_mov_b32 v57, 0
  v_mov_b32 v58, 0
  v_mov_b32 v59, 0
  v_mov_b32 v60, 0
  v_mov_b32 v61, 0
  v_mov_b32 v62, 0
  v_mov_b32 v63, 0
  v_mov_b32 v64, 0
  v_mov_b32 v65, 0
  v_mov_b32 v66, 0
  v_mov_b32 v67, 0
  v_mov_b32 v68, 0
  v_mov_b32 v69, 0
  v_mov_b32 v70, 0
  v_mov_b32 v71, 0
  v_mov_b32 v72, 0
  v_mov_b32 v73, 0
  v_mov_b32 v74, 0
  v_mov_b32 v75, 0
  v_mov_b32 v76, 0
  v_mov_b32 v77, 0
  v_mov_b32 v78, 0
  v_mov_b32 v79, 0
  v_mov_b32 v80, 0
  v_mov_b32 v81, 0
  v_mov_b32 v82, 0
  v_mov_b32 v83, 0
  v_mov_b32 v84, 0
  v_mov_b32 v85, 0
  v_mov_b32 v86, 0
  v_mov_b32 v87, 0
  v_mov_b32 v104, 0
  v_mov_b32 v105, 0
  v_mov_b32 v106, 0
  v_mov_b32 v107, 0
  v_mov_b32 v108, 0
  v_mov_b32 v109, 0
  v_mov_b32 v110, 0
  v_mov_b32 v111, 0
  v_mov_b32 v112, 0
  v_mov_b32 v113, 0
  v_mov_b32 v114, 0
  v_mov_b32 v115, 0
  v_mov_b32 v116, 0
  v_mov_b32 v117, 0
  v_mov_b32 v118, 0
  v_mov_b32 v119, 0
  s_waitcnt lgkmcnt(0)
  v_lshlrev_b32 v88, 16, v16
  v_and_b32 v89, v15, v16
  v_lshlrev_b32 v90, 16, v17
  v_and_b32 v91, v15, v17
  v_lshlrev_b32 v92, 16, v18
  v_and_b32 v93, v15, v18
  v_lshlrev_b32 v94, 16, v19
  v_and_b32 v95, v15, v19
  v_lshlrev_b32 v96, 16, v20
  v_and_b32 v97, v15, v20
  v_lshlrev_b32 v98, 16, v21
  v_and_b32 v99, v15, v21
  v_lshlrev_b32 v100, 16, v22
  v_and_b32 v101, v15, v22
  v_lshlrev_b32 v102, 16, v23
  v_and_b32 v103, v15, v23
  v_permlane16_swap_b32 v88, v92
  v_permlane16_swap_b32 v89, v93
  v_permlane16_swap_b32 v90, v94
  v_permlane16_swap_b32 v91, v95
  v_permlane16_swap_b32 v96, v100
  v_permlane16_swap_b32 v97, v101
  v_permlane16_swap_b32 v98, v102
  v_permlane16_swap_b32 v99, v103
  s_add_u32 m0, s51, 49152
  s_nop 0
  buffer_load_dwordx4 v240, s[12:15], s50 offen sc1 lds
  s_add_u32 m0, s51, 50176
  s_nop 0
  buffer_load_dwordx4 v241, s[12:15], s50 offen sc1 lds
  s_add_u32 s50, s50, 8192
  s_add_u32 m0, s51, 65536
  s_nop 0
  buffer_load_dwordx4 v240, s[12:15], s50 offen sc1 lds
  s_add_u32 m0, s51, 66560
  s_nop 0
  buffer_load_dwordx4 v241, s[12:15], s50 offen sc1 lds
  s_add_u32 s50, s50, 8192
  s_lshr_b32 s27, s23, 1
  s_lshl_b32 s27, s27, 7
  s_add_u32 s27, s27, 41684992
  s_cmp_lg_u32 s20, 0
  s_cbranch_scc1 L_wdone_40
  v_mov_b32 v17, 0
  s_mov_b32 s28, 0
L_wspin_41:
  buffer_load_dword v16, v17, s[12:15], s27 offen sc1
  s_add_u32 s28, s28, 1
  s_waitcnt vmcnt(0)
  v_readfirstlane_b32 s29, v16
  s_cmp_eq_u32 s29, 32
  s_cbranch_scc1 L_wdone_40
  s_cmp_gt_u32 s28, 262144
  s_cbranch_scc1 L_wdone_40
  s_sleep 1
  s_branch L_wspin_41
L_wdone_40:
  s_barrier
  buffer_load_dwordx4 v[120:123], v6, s[12:15], s31 offen sc1
  buffer_load_dwordx4 v[124:127], v7, s[12:15], s31 offen sc1
  s_add_u32 s31, s31, 4096
  buffer_load_dwordx4 v[128:131], v6, s[12:15], s31 offen sc1
  buffer_load_dwordx4 v[132:135], v7, s[12:15], s31 offen sc1
  s_add_u32 s31, s31, 4096
  buffer_load_dwordx4 v[136:139], v6, s[12:15], s31 offen sc1
  buffer_load_dwordx4 v[140:143], v7, s[12:15], s31 offen sc1
  s_add_u32 s31, s31, 4096
  buffer_load_dwordx4 v[144:147], v6, s[12:15], s31 offen sc1
  buffer_load_dwordx4 v[148:151], v7, s[12:15], s31 offen sc1
  s_add_u32 s31, s31, 4096
  ds_read_b64_tr_b16 v[24:25], v2 offset:0
  ds_read_b64_tr_b16 v[26:27], v2 offset:1024
  ds_read_b64_tr_b16 v[28:29], v3 offset:0
  ds_read_b64_tr_b16 v[30:31], v3 offset:1024
  ds_read_b64_tr_b16 v[32:33], v4 offset:0
  ds_read_b64_tr_b16 v[34:35], v4 offset:1024
  ds_read_b64_tr_b16 v[36:37], v5 offset:0
  ds_read_b64_tr_b16 v[38:39], v5 offset:1024
  s_waitcnt vmcnt(6) lgkmcnt(0)
  v_mfma_f32_16x16x32_bf16 v[56:59], v[24:27], v[120:123], v[56:59]
  ds_read_b64_tr_b16 v[40:41], v2 offset:8192
  v_mfma_f32_16x16x32_bf16 v[72:75], v[24:27], v[124:127], v[72:75]
  ds_read_b64_tr_b16 v[42:43], v2 offset:9216
  v_mfma_f32_16x16x32_bf16 v[60:63], v[28:31], v[120:123], v[60:63]
  ds_read_b64_tr_b16 v[44:45], v3 offset:8192
  buffer_load_dwordx4 v[152:155], v6, s[12:15], s31 offen sc1
  v_mfma_f32_16x16x32_bf16 v[76:79], v[28:31], v[124:127], v[76:79]
  ds_read_b64_tr_b16 v[46:47], v3 offset:9216
  v_mfma_f32_16x16x32_bf16 v[64:67], v[32:35], v[120:123], v[64:67]
  ds_read_b64_tr_b16 v[48:49], v4 offset:8192
  v_mfma_f32_16x16x32_bf16 v[80:83], v[32:35], v[124:127], v[80:83]
  ds_read_b64_tr_b16 v[50:51], v4 offset:9216
  buffer_load_dwordx4 v[156:159], v7, s[12:15], s31 offen sc1
  s_add_u32 s31, s31, 4096
  v_mfma_f32_16x16x32_bf16 v[68:71], v[36:39], v[120:123], v[68:71]
  ds_read_b64_tr_b16 v[52:53], v5 offset:8192
  v_mfma_f32_16x16x32_bf16 v[84:87], v[36:39], v[124:127], v[84:87]
  ds_read_b64_tr_b16 v[54:55], v5 offset:9216
  s_waitcnt lgkmcnt(0)
  s_barrier
  v_mfma_f32_16x16x32_bf16 v[88:91], v[40:43], v[120:123], v[88:91]
  ds_read_b64_tr_b16 v[24:25], v2 offset:16384
  s_add_u32 m0, s51, 0
  v_mfma_f32_16x16x32_bf16 v[104:107], v[40:43], v[124:127], v[104:107]
  ds_read_b64_tr_b16 v[26:27], v2 offset:17408
  buffer_load_dwordx4 v240, s[12:15], s50 offen sc1 lds
  v_mfma_f32_16x16x32_bf16 v[92:95], v[44:47], v[120:123], v[92:95]
  ds_read_b64_tr_b16 v[28:29], v3 offset:16384
  s_add_u32 m0, s51, 1024
  v_mfma_f32_16x16x32_bf16 v[108:111], v[44:47], v[124:127], v[108:111]
  ds_read_b64_tr_b16 v[30:31], v3 offset:17408
  buffer_load_dwordx4 v241, s[12:15], s50 offen sc1 lds
  v_mfma_f32_16x16x32_bf16 v[96:99], v[48:51], v[120:123], v[96:99]
  ds_read_b64_tr_b16 v[32:33], v4 offset:16384
  s_add_u32 s50, s50, 8192
  v_mfma_f32_16x16x32_bf16 v[112:115], v[48:51], v[124:127], v[112:115]
  ds_read_b64_tr_b16 v[34:35], v4 offset:17408
  v_mfma_f32_16x16x32_bf16 v[100:103], v[52:55], v[120:123], v[100:103]
  ds_read_b64_tr_b16 v[36:37], v5 offset:16384
  v_mfma_f32_16x16x32_bf16 v[116:119], v[52:55], v[124:127], v[116:119]
  ds_read_b64_tr_b16 v[38:39], v5 offset:17408
  s_waitcnt vmcnt(8) lgkmcnt(0)
  v_mfma_f32_16x16x32_bf16 v[56:59], v[24:27], v[128:131], v[56:59]
  ds_read_b64_tr_b16 v[40:41], v2 offset:24576
  v_mfma_f32_16x16x32_bf16 v[72:75], v[24:27], v[132:135], v[72:75]
  ds_read_b64_tr_b16 v[42:43], v2 offset:25600
  v_mfma_f32_16x16x32_bf16 v[60:63], v[28:31], v[128:131], v[60:63]
  ds_read_b64_tr_b16 v[44:45], v3 offset:24576
  buffer_load_dwordx4 v[120:123], v6, s[12:15], s31 offen sc1
  v_mfma_f32_16x16x32_bf16 v[76:79], v[28:31], v[132:135], v[76:79]
  ds_read_b64_tr_b16 v[46:47], v3 offset:25600
  v_mfma_f32_16x16x32_bf16 v[64:67], v[32:35], v[128:131], v[64:67]
  ds_read_b64_tr_b16 v[48:49], v4 offset:24576
  v_mfma_f32_16x16x32_bf16 v[80:83], v[32:35], v[132:135], v[80:83]
  ds_read_b64_tr_b16 v[50:51], v4 offset:25600
  buffer_load_dwordx4 v[124:127], v7, s[12:15], s31 offen sc1
  s_add_u32 s31, s31, 4096
  v_mfma_f32_16x16x32_bf16 v[68:71], v[36:39], v[128:131], v[68:71]
  ds_read_b64_tr_b16 v[52:53], v5 offset:24576
  v_mfma_f32_16x16x32_bf16 v[84:87], v[36:39], v[132:135], v[84:87]
  ds_read_b64_tr_b16 v[54:55], v5 offset:25600
  s_waitcnt lgkmcnt(0)
  s_barrier
  v_mfma_f32_16x16x32_bf16 v[88:91], v[40:43], v[128:131], v[88:91]
  ds_read_b64_tr_b16 v[24:25], v2 offset:32768
  s_add_u32 m0, s51, 16384
  v_mfma_f32_16x16x32_bf16 v[104:107], v[40:43], v[132:135], v[104:107]
  ds_read_b64_tr_b16 v[26:27], v2 offset:33792
  buffer_load_dwordx4 v240, s[12:15], s50 offen sc1 lds
  v_mfma_f32_16x16x32_bf16 v[92:95], v[44:47], v[128:131], v[92:95]
  ds_read_b64_tr_b16 v[28:29], v3 offset:32768
  s_add_u32 m0, s51, 17408
  v_mfma_f32_16x16x32_bf16 v[108:111], v[44:47], v[132:135], v[108:111]
  ds_read_b64_tr_b16 v[30:31], v3 offset:33792
  buffer_load_dwordx4 v241, s[12:15], s50 offen sc1 lds
  v_mfma_f32_16x16x32_bf16 v[96:99], v[48:51], v[128:131], v[96:99]
  ds_read_b64_tr_b16 v[32:33], v4 offset:32768
  s_add_u32 s50, s50, 8192
  v_mfma_f32_16x16x32_bf16 v[112:115], v[48:51], v[132:135], v[112:115]
  ds_read_b64_tr_b16 v[34:35], v4 offset:33792
  v_mfma_f32_16x16x32_bf16 v[100:103], v[52:55], v[128:131], v[100:103]
  ds_read_b64_tr_b16 v[36:37], v5 offset:32768
  v_mfma_f32_16x16x32_bf16 v[116:119], v[52:55], v[132:135], v[116:119]
  ds_read_b64_tr_b16 v[38:39], v5 offset:33792
  s_waitcnt vmcnt(10) lgkmcnt(0)
  v_mfma_f32_16x16x32_bf16 v[56:59], v[24:27], v[136:139], v[56:59]
  ds_read_b64_tr_b16 v[40:41], v2 offset:40960
  v_mfma_f32_16x16x32_bf16 v[72:75], v[24:27], v[140:143], v[72:75]
  ds_read_b64_tr_b16 v[42:43], v2 offset:41984
  v_mfma_f32_16x16x32_bf16 v[60:63], v[28:31], v[136:139], v[60:63]
  ds_read_b64_tr_b16 v[44:45], v3 offset:40960
  buffer_load_dwordx4 v[128:131], v6, s[12:15], s31 offen sc1
  v_mfma_f32_16x16x32_bf16 v[76:79], v[28:31], v[140:143], v[76:79]
  ds_read_b64_tr_b16 v[46:47], v3 offset:41984
  v_mfma_f32_16x16x32_bf16 v[64:67], v[32:35], v[136:139], v[64:67]
  ds_read_b64_tr_b16 v[48:49], v4 offset:40960
  v_mfma_f32_16x16x32_bf16 v[80:83], v[32:35], v[140:143], v[80:83]
  ds_read_b64_tr_b16 v[50:51], v4 offset:41984
  buffer_load_dwordx4 v[132:135], v7, s[12:15], s31 offen sc1
  s_add_u32 s31, s31, 4096
  v_mfma_f32_16x16x32_bf16 v[68:71], v[36:39], v[136:139], v[68:71]
  ds_read_b64_tr_b16 v[52:53], v5 offset:40960
  v_mfma_f32_16x16x32_bf16 v[84:87], v[36:39], v[140:143], v[84:87]
  ds_read_b64_tr_b16 v[54:55], v5 offset:41984
  s_waitcnt vmcnt(20) lgkmcnt(0)
  s_barrier
  v_mfma_f32_16x16x32_bf16 v[88:91], v[40:43], v[136:139], v[88:91]
  ds_read_b64_tr_b16 v[24:25], v2 offset:49152
  s_add_u32 m0, s51, 32768
  v_mfma_f32_16x16x32_bf16 v[104:107], v[40:43], v[140:143], v[104:107]
  ds_read_b64_tr_b16 v[26:27], v2 offset:50176
  buffer_load_dwordx4 v240, s[12:15], s50 offen sc1 lds
  v_mfma_f32_16x16x32_bf16 v[92:95], v[44:47], v[136:139], v[92:95]
  ds_read_b64_tr_b16 v[28:29], v3 offset:49152
  s_add_u32 m0, s51, 33792
  v_mfma_f32_16x16x32_bf16 v[108:111], v[44:47], v[140:143], v[108:111]
  ds_read_b64_tr_b16 v[30:31], v3 offset:50176
  buffer_load_dwordx4 v241, s[12:15], s50 offen sc1 lds
  v_mfma_f32_16x16x32_bf16 v[96:99], v[48:51], v[136:139], v[96:99]
  ds_read_b64_tr_b16 v[32:33], v4 offset:49152
  s_add_u32 s50, s50, 8192
  v_mfma_f32_16x16x32_bf16 v[112:115], v[48:51], v[140:143], v[112:115]
  ds_read_b64_tr_b16 v[34:35], v4 offset:50176
  v_mfma_f32_16x16x32_bf16 v[100:103], v[52:55], v[136:139], v[100:103]
  ds_read_b64_tr_b16 v[36:37], v5 offset:49152
  v_mfma_f32_16x16x32_bf16 v[116:119], v[52:55], v[140:143], v[116:119]
  ds_read_b64_tr_b16 v[38:39], v5 offset:50176
  s_waitcnt vmcnt(12) lgkmcnt(0)
  v_mfma_f32_16x16x32_bf16 v[56:59], v[24:27], v[144:147], v[56:59]
  ds_read_b64_tr_b16 v[40:41], v2 offset:57344
  v_mfma_f32_16x16x32_bf16 v[72:75], v[24:27], v[148:151], v[72:75]
  ds_read_b64_tr_b16 v[42:43], v2 offset:58368
  v_mfma_f32_16x16x32_bf16 v[60:63], v[28:31], v[144:147], v[60:63]
  ds_read_b64_tr_b16 v[44:45], v3 offset:57344
  buffer_load_dwordx4 v[136:139], v6, s[12:15], s31 offen sc1
  v_mfma_f32_16x16x32_bf16 v[76:79], v[28:31], v[148:151], v[76:79]
  ds_read_b64_tr_b16 v[46:47], v3 offset:58368
  v_mfma_f32_16x16x32_bf16 v[64:67], v[32:35], v[144:147], v[64:67]
  ds_read_b64_tr_b16 v[48:49], v4 offset:57344
  v_mfma_f32_16x16x32_bf16 v[80:83], v[32:35], v[148:151], v[80:83]
  ds_read_b64_tr_b16 v[50:51], v4 offset:58368
  buffer_load_dwordx4 v[140:143], v7, s[12:15], s31 offen sc1
  s_add_u32 s31, s31, 4096
  v_mfma_f32_16x16x32_bf16 v[68:71], v[36:39], v[144:147], v[68:71]
  ds_read_b64_tr_b16 v[52:53], v5 offset:57344
  v_mfma_f32_16x16x32_bf16 v[84:87], v[36:39], v[148:151], v[84:87]
  ds_read_b64_tr_b16 v[54:55], v5 offset:58368
  s_waitcnt vmcnt(22) lgkmcnt(0)
  s_barrier
  v_mfma_f32_16x16x32_bf16 v[88:91], v[40:43], v[144:147], v[88:91]
  ds_read_b64_tr_b16 v[24:25], v204 offset:0
  s_add_u32 m0, s51, 49152
  v_mfma_f32_16x16x32_bf16 v[104:107], v[40:43], v[148:151], v[104:107]
  ds_read_b64_tr_b16 v[26:27], v204 offset:1024
  buffer_load_dwordx4 v240, s[12:15], s50 offen sc1 lds
  v_mfma_f32_16x16x32_bf16 v[92:95], v[44:47], v[144:147], v[92:95]
  ds_read_b64_tr_b16 v[28:29], v205 offset:0
  s_add_u32 m0, s51, 50176
  v_mfma_f32_16x16x32_bf16 v[108:111], v[44:47], v[148:151], v[108:111]
  ds_read_b64_tr_b16 v[30:31], v205 offset:1024
  buffer_load_dwordx4 v241, s[12:15], s50 offen sc1 lds
  v_mfma_f32_16x16x32_bf16 v[96:99], v[48:51], v[144:147], v[96:99]
  ds_read_b64_tr_b16 v[32:33], v206 offset:0
  s_add_u32 s50, s50, 8192
  v_mfma_f32_16x16x32_bf16 v[112:115], v[48:51], v[148:151], v[112:115]
  ds_read_b64_tr_b16 v[34:35], v206 offset:1024
  v_mfma_f32_16x16x32_bf16 v[100:103], v[52:55], v[144:147], v[100:103]
  ds_read_b64_tr_b16 v[36:37], v207 offset:0
  v_mfma_f32_16x16x32_bf16 v[116:119], v[52:55], v[148:151], v[116:119]
  ds_read_b64_tr_b16 v[38:39], v207 offset:1024
  s_waitcnt vmcnt(14) lgkmcnt(0)
  v_mfma_f32_16x16x32_bf16 v[56:59], v[24:27], v[152:155], v[56:59]
  ds_read_b64_tr_b16 v[40:41], v204 offset:8192
  v_mfma_f32_16x16x32_bf16 v[72:75], v[24:27], v[156:159], v[72:75]
  ds_read_b64_tr_b16 v[42:43], v204 offset:9216
  v_mfma_f32_16x16x32_bf16 v[60:63], v[28:31], v[152:155], v[60:63]
  ds_read_b64_tr_b16 v[44:45], v205 offset:8192
  buffer_load_dwordx4 v[144:147], v6, s[12:15], s31 offen sc1
  v_mfma_f32_16x16x32_bf16 v[76:79], v[28:31], v[156:159], v[76:79]
  ds_read_b64_tr_b16 v[46:47], v205 offset:9216
  v_mfma_f32_16x16x32_bf16 v[64:67], v[32:35], v[152:155], v[64:67]
  ds_read_b64_tr_b16 v[48:49], v206 offset:8192
  v_mfma_f32_16x16x32_bf16 v[80:83], v[32:35], v[156:159], v[80:83]
  ds_read_b64_tr_b16 v[50:51], v206 offset:9216
  buffer_load_dwordx4 v[148:151], v7, s[12:15], s31 offen sc1
  s_add_u32 s31, s31, 4096
  v_mfma_f32_16x16x32_bf16 v[68:71], v[36:39], v[152:155], v[68:71]
  ds_read_b64_tr_b16 v[52:53], v207 offset:8192
  v_mfma_f32_16x16x32_bf16 v[84:87], v[36:39], v[156:159], v[84:87]
  ds_read_b64_tr_b16 v[54:55], v207 offset:9216
  s_waitcnt vmcnt(14) lgkmcnt(0)
  s_barrier
  v_mfma_f32_16x16x32_bf16 v[88:91], v[40:43], v[152:155], v[88:91]
  ds_read_b64_tr_b16 v[24:25], v2 offset:0
  s_add_u32 m0, s51, 65536
  v_mfma_f32_16x16x32_bf16 v[104:107], v[40:43], v[156:159], v[104:107]
  ds_read_b64_tr_b16 v[26:27], v2 offset:1024
  buffer_load_dwordx4 v240, s[12:15], s50 offen sc1 lds
  v_mfma_f32_16x16x32_bf16 v[92:95], v[44:47], v[152:155], v[92:95]
  ds_read_b64_tr_b16 v[28:29], v3 offset:0
  s_add_u32 m0, s51, 66560
  v_mfma_f32_16x16x32_bf16 v[108:111], v[44:47], v[156:159], v[108:111]
  ds_read_b64_tr_b16 v[30:31], v3 offset:1024
  buffer_load_dwordx4 v241, s[12:15], s50 offen sc1 lds
  v_mfma_f32_16x16x32_bf16 v[96:99], v[48:51], v[152:155], v[96:99]
  ds_read_b64_tr_b16 v[32:33], v4 offset:0
  s_add_u32 s50, s50, 8192
  v_mfma_f32_16x16x32_bf16 v[112:115], v[48:51], v[156:159], v[112:115]
  ds_read_b64_tr_b16 v[34:35], v4 offset:1024
  v_mfma_f32_16x16x32_bf16 v[100:103], v[52:55], v[152:155], v[100:103]
  ds_read_b64_tr_b16 v[36:37], v5 offset:0
  v_mfma_f32_16x16x32_bf16 v[116:119], v[52:55], v[156:159], v[116:119]
  ds_read_b64_tr_b16 v[38:39], v5 offset:1024
  s_mov_b32 s36, 0
L_p5loop_46:
  s_waitcnt vmcnt(14) lgkmcnt(0)
  v_mfma_f32_16x16x32_bf16 v[56:59], v[24:27], v[120:123], v[56:59]
  ds_read_b64_tr_b16 v[40:41], v2 offset:8192
  v_mfma_f32_16x16x32_bf16 v[72:75], v[24:27], v[124:127], v[72:75]
  ds_read_b64_tr_b16 v[42:43], v2 offset:9216
  v_mfma_f32_16x16x32_bf16 v[60:63], v[28:31], v[120:123], v[60:63]
  ds_read_b64_tr_b16 v[44:45], v3 offset:8192
  buffer_load_dwordx4 v[152:155], v6, s[12:15], s31 offen sc1
  v_mfma_f32_16x16x32_bf16 v[76:79], v[28:31], v[124:127], v[76:79]
  ds_read_b64_tr_b16 v[46:47], v3 offset:9216
  v_mfma_f32_16x16x32_bf16 v[64:67], v[32:35], v[120:123], v[64:67]
  ds_read_b64_tr_b16 v[48:49], v4 offset:8192
  v_mfma_f32_16x16x32_bf16 v[80:83], v[32:35], v[124:127], v[80:83]
  ds_read_b64_tr_b16 v[50:51], v4 offset:9216
  buffer_load_dwordx4 v[156:159], v7, s[12:15], s31 offen sc1
  s_add_u32 s31, s31, 4096
  v_mfma_f32_16x16x32_bf16 v[68:71], v[36:39], v[120:123], v[68:71]
  ds_read_b64_tr_b16 v[52:53], v5 offset:8192
  v_mfma_f32_16x16x32_bf16 v[84:87], v[36:39], v[124:127], v[84:87]
  ds_read_b64_tr_b16 v[54:55], v5 offset:9216
  s_waitcnt vmcnt(14) lgkmcnt(0)
  s_barrier
  v_mfma_f32_16x16x32_bf16 v[88:91], v[40:43], v[120:123], v[88:91]
  ds_read_b64_tr_b16 v[24:25], v2 offset:16384
  s_add_u32 m0, s51, 0
  v_mfma_f32_16x16x32_bf16 v[104:107], v[40:43], v[124:127], v[104:107]
  ds_read_b64_tr_b16 v[26:27], v2 offset:17408
  buffer_load_dwordx4 v240, s[12:15], s50 offen sc1 lds
  v_mfma_f32_16x16x32_bf16 v[92:95], v[44:47], v[120:123], v[92:95]
  ds_read_b64_tr_b16 v[28:29], v3 offset:16384
  s_add_u32 m0, s51, 1024
  v_mfma_f32_16x16x32_bf16 v[108:111], v[44:47], v[124:127], v[108:111]
  ds_read_b64_tr_b16 v[30:31], v3 offset:17408
  buffer_load_dwordx4 v241, s[12:15], s50 offen sc1 lds
  v_mfma_f32_16x16x32_bf16 v[96:99], v[48:51], v[120:123], v[96:99]
  ds_read_b64_tr_b16 v[32:33], v4 offset:16384
  s_add_u32 s50, s50, 8192
  v_mfma_f32_16x16x32_bf16 v[112:115], v[48:51], v[124:127], v[112:115]
  ds_read_b64_tr_b16 v[34:35], v4 offset:17408
  v_mfma_f32_16x16x32_bf16 v[100:103], v[52:55], v[120:123], v[100:103]
  ds_read_b64_tr_b16 v[36:37], v5 offset:16384
  v_mfma_f32_16x16x32_bf16 v[116:119], v[52:55], v[124:127], v[116:119]
  ds_read_b64_tr_b16 v[38:39], v5 offset:17408
  s_waitcnt vmcnt(14) lgkmcnt(0)
  v_mfma_f32_16x16x32_bf16 v[56:59], v[24:27], v[128:131], v[56:59]
  ds_read_b64_tr_b16 v[40:41], v2 offset:24576
  v_mfma_f32_16x16x32_bf16 v[72:75], v[24:27], v[132:135], v[72:75]
  ds_read_b64_tr_b16 v[42:43], v2 offset:25600
  v_mfma_f32_16x16x32_bf16 v[60:63], v[28:31], v[128:131], v[60:63]
  ds_read_b64_tr_b16 v[44:45], v3 offset:24576
  buffer_load_dwordx4 v[120:123], v6, s[12:15], s31 offen sc1
  v_mfma_f32_16x16x32_bf16 v[76:79], v[28:31], v[132:135], v[76:79]
  ds_read_b64_tr_b16 v[46:47], v3 offset:25600
  v_mfma_f32_16x16x32_bf16 v[64:67], v[32:35], v[128:131], v[64:67]
  ds_read_b64_tr_b16 v[48:49], v4 offset:24576
  v_mfma_f32_16x16x32_bf16 v[80:83], v[32:35], v[132:135], v[80:83]
  ds_read_b64_tr_b16 v[50:51], v4 offset:25600
  buffer_load_dwordx4 v[124:127], v7, s[12:15], s31 offen sc1
  s_add_u32 s31, s31, 4096
  v_mfma_f32_16x16x32_bf16 v[68:71], v[36:39], v[128:131], v[68:71]
  ds_read_b64_tr_b16 v[52:53], v5 offset:24576
  v_mfma_f32_16x16x32_bf16 v[84:87], v[36:39], v[132:135], v[84:87]
  ds_read_b64_tr_b16 v[54:55], v5 offset:25600
  s_waitcnt vmcnt(14) lgkmcnt(0)
  s_barrier
  v_mfma_f32_16x16x32_bf16 v[88:91], v[40:43], v[128:131], v[88:91]
  ds_read_b64_tr_b16 v[24:25], v2 offset:32768
  s_add_u32 m0, s51, 16384
  v_mfma_f32_16x16x32_bf16 v[104:107], v[40:43], v[132:135], v[104:107]
  ds_read_b64_tr_b16 v[26:27], v2 offset:33792
  buffer_load_dwordx4 v240, s[12:15], s50 offen sc1 lds
  v_mfma_f32_16x16x32_bf16 v[92:95], v[44:47], v[128:131], v[92:95]
  ds_read_b64_tr_b16 v[28:29], v3 offset:32768
  s_add_u32 m0, s51, 17408
  v_mfma_f32_16x16x32_bf16 v[108:111], v[44:47], v[132:135], v[108:111]
  ds_read_b64_tr_b16 v[30:31], v3 offset:33792
  buffer_load_dwordx4 v241, s[12:15], s50 offen sc1 lds
  v_mfma_f32_16x16x32_bf16 v[96:99], v[48:51], v[128:131], v[96:99]
  ds_read_b64_tr_b16 v[32:33], v4 offset:32768
  s_add_u32 s50, s50, 8192
  v_mfma_f32_16x16x32_bf16 v[112:115], v[48:51], v[132:135], v[112:115]
  ds_read_b64_tr_b16 v[34:35], v4 offset:33792
  v_mfma_f32_16x16x32_bf16 v[100:103], v[52:55], v[128:131], v[100:103]
  ds_read_b64_tr_b16 v[36:37], v5 offset:32768
  v_mfma_f32_16x16x32_bf16 v[116:119], v[52:55], v[132:135], v[116:119]
  ds_read_b64_tr_b16 v[38:39], v5 offset:33792
  s_waitcnt vmcnt(14) lgkmcnt(0)
  v_mfma_f32_16x16x32_bf16 v[56:59], v[24:27], v[136:139], v[56:59]
  ds_read_b64_tr_b16 v[40:41], v2 offset:40960
  v_mfma_f32_16x16x32_bf16 v[72:75], v[24:27], v[140:143], v[72:75]
  ds_read_b64_tr_b16 v[42:43], v2 offset:41984
  v_mfma_f32_16x16x32_bf16 v[60:63], v[28:31], v[136:139], v[60:63]
  ds_read_b64_tr_b16 v[44:45], v3 offset:40960
  buffer_load_dwordx4 v[128:131], v6, s[12:15], s31 offen sc1
  v_mfma_f32_16x16x32_bf16 v[76:79], v[28:31], v[140:143], v[76:79]
  ds_read_b64_tr_b16 v[46:47], v3 offset:41984
  v_mfma_f32_16x16x32_bf16 v[64:67], v[32:35], v[136:139], v[64:67]
  ds_read_b64_tr_b16 v[48:49], v4 offset:40960
  v_mfma_f32_16x16x32_bf16 v[80:83], v[32:35], v[140:143], v[80:83]
  ds_read_b64_tr_b16 v[50:51], v4 offset:41984
  buffer_load_dwordx4 v[132:135], v7, s[12:15], s31 offen sc1
  s_add_u32 s31, s31, 4096
  v_mfma_f32_16x16x32_bf16 v[68:71], v[36:39], v[136:139], v[68:71]
  ds_read_b64_tr_b16 v[52:53], v5 offset:40960
  v_mfma_f32_16x16x32_bf16 v[84:87], v[36:39], v[140:143], v[84:87]
  ds_read_b64_tr_b16 v[54:55], v5 offset:41984
  s_waitcnt vmcnt(14) lgkmcnt(0)
  s_barrier
  v_mfma_f32_16x16x32_bf16 v[88:91], v[40:43], v[136:139], v[88:91]
  ds_read_b64_tr_b16 v[24:25], v2 offset:49152
  s_add_u32 m0, s51, 32768
  v_mfma_f32_16x16x32_bf16 v[104:107], v[40:43], v[140:143], v[104:107]
  ds_read_b64_tr_b16 v[26:27], v2 offset:50176
  buffer_load_dwordx4 v240, s[12:15], s50 offen sc1 lds
  v_mfma_f32_16x16x32_bf16 v[92:95], v[44:47], v[136:139], v[92:95]
  ds_read_b64_tr_b16 v[28:29], v3 offset:49152
  s_add_u32 m0, s51, 33792
  v_mfma_f32_16x16x32_bf16 v[108:111], v[44:47], v[140:143], v[108:111]
  ds_read_b64_tr_b16 v[30:31], v3 offset:50176
  buffer_load_dwordx4 v241, s[12:15], s50 offen sc1 lds
  v_mfma_f32_16x16x32_bf16 v[96:99], v[48:51], v[136:139], v[96:99]
  ds_read_b64_tr_b16 v[32:33], v4 offset:49152
  s_add_u32 s50, s50, 8192
  v_mfma_f32_16x16x32_bf16 v[112:115], v[48:51], v[140:143], v[112:115]
  ds_read_b64_tr_b16 v[34:35], v4 offset:50176
  v_mfma_f32_16x16x32_bf16 v[100:103], v[52:55], v[136:139], v[100:103]
  ds_read_b64_tr_b16 v[36:37], v5 offset:49152
  v_mfma_f32_16x16x32_bf16 v[116:119], v[52:55], v[140:143], v[116:119]
  ds_read_b64_tr_b16 v[38:39], v5 offset:50176
  s_waitcnt vmcnt(14) lgkmcnt(0)
  v_mfma_f32_16x16x32_bf16 v[56:59], v[24:27], v[144:147], v[56:59]
  ds_read_b64_tr_b16 v[40:41], v2 offset:57344
  v_mfma_f32_16x16x32_bf16 v[72:75], v[24:27], v[148:151], v[72:75]
  ds_read_b64_tr_b16 v[42:43], v2 offset:58368
  v_mfma_f32_16x16x32_bf16 v[60:63], v[28:31], v[144:147], v[60:63]
  ds_read_b64_tr_b16 v[44:45], v3 offset:57344
  buffer_load_dwordx4 v[136:139], v6, s[12:15], s31 offen sc1
  v_mfma_f32_16x16x32_bf16 v[76:79], v[28:31], v[148:151], v[76:79]
  ds_read_b64_tr_b16 v[46:47], v3 offset:58368
  v_mfma_f32_16x16x32_bf16 v[64:67], v[32:35], v[144:147], v[64:67]
  ds_read_b64_tr_b16 v[48:49], v4 offset:57344
  v_mfma_f32_16x16x32_bf16 v[80:83], v[32:35], v[148:151], v[80:83]
  ds_read_b64_tr_b16 v[50:51], v4 offset:58368
  buffer_load_dwordx4 v[140:143], v7, s[12:15], s31 offen sc1
  s_add_u32 s31, s31, 4096
  v_mfma_f32_16x16x32_bf16 v[68:71], v[36:39], v[144:147], v[68:71]
  ds_read_b64_tr_b16 v[52:53], v5 offset:57344
  v_mfma_f32_16x16x32_bf16 v[84:87], v[36:39], v[148:151], v[84:87]
  ds_read_b64_tr_b16 v[54:55], v5 offset:58368
  s_waitcnt vmcnt(14) lgkmcnt(0)
  s_barrier
  v_mfma_f32_16x16x32_bf16 v[88:91], v[40:43], v[144:147], v[88:91]
  ds_read_b64_tr_b16 v[24:25], v204 offset:0
  s_add_u32 m0, s51, 49152
  v_mfma_f32_16x16x32_bf16 v[104:107], v[40:43], v[148:151], v[104:107]
  ds_read_b64_tr_b16 v[26:27], v204 offset:1024
  buffer_load_dwordx4 v240, s[12:15], s50 offen sc1 lds
  v_mfma_f32_16x16x32_bf16 v[92:95], v[44:47], v[144:147], v[92:95]
  ds_read_b64_tr_b16 v[28:29], v205 offset:0
  s_add_u32 m0, s51, 50176
  v_mfma_f32_16x16x32_bf16 v[108:111], v[44:47], v[148:151], v[108:111]
  ds_read_b64_tr_b16 v[30:31], v205 offset:1024
  buffer_load_dwordx4 v241, s[12:15], s50 offen sc1 lds
  v_mfma_f32_16x16x32_bf16 v[96:99], v[48:51], v[144:147], v[96:99]
  ds_read_b64_tr_b16 v[32:33], v206 offset:0
  s_add_u32 s50, s50, 8192
  v_mfma_f32_16x16x32_bf16 v[112:115], v[48:51], v[148:151], v[112:115]
  ds_read_b64_tr_b16 v[34:35], v206 offset:1024
  v_mfma_f32_16x16x32_bf16 v[100:103], v[52:55], v[144:147], v[100:103]
  ds_read_b64_tr_b16 v[36:37], v207 offset:0
  v_mfma_f32_16x16x32_bf16 v[116:119], v[52:55], v[148:151], v[116:119]
  ds_read_b64_tr_b16 v[38:39], v207 offset:1024
  s_waitcnt vmcnt(14) lgkmcnt(0)
  v_mfma_f32_16x16x32_bf16 v[56:59], v[24:27], v[152:155], v[56:59]
  ds_read_b64_tr_b16 v[40:41], v204 offset:8192
  v_mfma_f32_16x16x32_bf16 v[72:75], v[24:27], v[156:159], v[72:75]
  ds_read_b64_tr_b16 v[42:43], v204 offset:9216
  v_mfma_f32_16x16x32_bf16 v[60:63], v[28:31], v[152:155], v[60:63]
  ds_read_b64_tr_b16 v[44:45], v205 offset:8192
  buffer_load_dwordx4 v[144:147], v6, s[12:15], s31 offen sc1
  v_mfma_f32_16x16x32_bf16 v[76:79], v[28:31], v[156:159], v[76:79]
  ds_read_b64_tr_b16 v[46:47], v205 offset:9216
  v_mfma_f32_16x16x32_bf16 v[64:67], v[32:35], v[152:155], v[64:67]
  ds_read_b64_tr_b16 v[48:49], v206 offset:8192
  v_mfma_f32_16x16x32_bf16 v[80:83], v[32:35], v[156:159], v[80:83]
  ds_read_b64_tr_b16 v[50:51], v206 offset:9216
  buffer_load_dwordx4 v[148:151], v7, s[12:15], s31 offen sc1
  s_add_u32 s31, s31, 4096
  v_mfma_f32_16x16x32_bf16 v[68:71], v[36:39], v[152:155], v[68:71]
  ds_read_b64_tr_b16 v[52:53], v207 offset:8192
  v_mfma_f32_16x16x32_bf16 v[84:87], v[36:39], v[156:159], v[84:87]
  ds_read_b64_tr_b16 v[54:55], v207 offset:9216
  s_waitcnt vmcnt(14) lgkmcnt(0)
  s_barrier
  v_mfma_f32_16x16x32_bf16 v[88:91], v[40:43], v[152:155], v[88:91]
  ds_read_b64_tr_b16 v[24:25], v2 offset:0
  s_add_u32 m0, s51, 65536
  v_mfma_f32_16x16x32_bf16 v[104:107], v[40:43], v[156:159], v[104:107]
  ds_read_b64_tr_b16 v[26:27], v2 offset:1024
  buffer_load_dwordx4 v240, s[12:15], s50 offen sc1 lds
  v_mfma_f32_16x16x32_bf16 v[92:95], v[44:47], v[152:155], v[92:95]
  ds_read_b64_tr_b16 v[28:29], v3 offset:0
  s_add_u32 m0, s51, 66560
  v_mfma_f32_16x16x32_bf16 v[108:111], v[44:47], v[156:159], v[108:111]
  ds_read_b64_tr_b16 v[30:31], v3 offset:1024
  buffer_load_dwordx4 v241, s[12:15], s50 offen sc1 lds
  v_mfma_f32_16x16x32_bf16 v[96:99], v[48:51], v[152:155], v[96:99]
  ds_read_b64_tr_b16 v[32:33], v4 offset:0
  s_add_u32 s50, s50, 8192
  v_mfma_f32_16x16x32_bf16 v[112:115], v[48:51], v[156:159], v[112:115]
  ds_read_b64_tr_b16 v[34:35], v4 offset:1024
  v_mfma_f32_16x16x32_bf16 v[100:103], v[52:55], v[152:155], v[100:103]
  ds_read_b64_tr_b16 v[36:37], v5 offset:0
  v_mfma_f32_16x16x32_bf16 v[116:119], v[52:55], v[156:159], v[116:119]
  ds_read_b64_tr_b16 v[38:39], v5 offset:1024
  s_add_u32 s36, s36, 1
  s_cmp_lt_u32 s36, 3
  s_cbranch_scc1 L_p5loop_46
  s_waitcnt vmcnt(14) lgkmcnt(0)
  v_mfma_f32_16x16x32_bf16 v[56:59], v[24:27], v[120:123], v[56:59]
  ds_read_b64_tr_b16 v[40:41], v2 offset:8192
  v_mfma_f32_16x16x32_bf16 v[72:75], v[24:27], v[124:127], v[72:75]
  ds_read_b64_tr_b16 v[42:43], v2 offset:9216
  v_mfma_f32_16x16x32_bf16 v[60:63], v[28:31], v[120:123], v[60:63]
  ds_read_b64_tr_b16 v[44:45], v3 offset:8192
  buffer_load_dwordx4 v[152:155], v6, s[12:15], s31 offen sc1
  v_mfma_f32_16x16x32_bf16 v[76:79], v[28:31], v[124:127], v[76:79]
  ds_read_b64_tr_b16 v[46:47], v3 offset:9216
  v_mfma_f32_16x16x32_bf16 v[64:67], v[32:35], v[120:123], v[64:67]
  ds_read_b64_tr_b16 v[48:49], v4 offset:8192
  v_mfma_f32_16x16x32_bf16 v[80:83], v[32:35], v[124:127], v[80:83]
  ds_read_b64_tr_b16 v[50:51], v4 offset:9216
  buffer_load_dwordx4 v[156:159], v7, s[12:15], s31 offen sc1
  s_add_u32 s31, s31, 4096
  v_mfma_f32_16x16x32_bf16 v[68:71], v[36:39], v[120:123], v[68:71]
  ds_read_b64_tr_b16 v[52:53], v5 offset:8192
  v_mfma_f32_16x16x32_bf16 v[84:87], v[36:39], v[124:127], v[84:87]
  ds_read_b64_tr_b16 v[54:55], v5 offset:9216
  s_waitcnt vmcnt(14) lgkmcnt(0)
  s_barrier
  v_mfma_f32_16x16x32_bf16 v[88:91], v[40:43], v[120:123], v[88:91]
  ds_read_b64_tr_b16 v[24:25], v2 offset:16384
  s_add_u32 m0, s51, 0
  v_mfma_f32_16x16x32_bf16 v[104:107], v[40:43], v[124:127], v[104:107]
  ds_read_b64_tr_b16 v[26:27], v2 offset:17408
  buffer_load_dwordx4 v240, s[12:15], s50 offen sc1 lds
  v_mfma_f32_16x16x32_bf16 v[92:95], v[44:47], v[120:123], v[92:95]
  ds_read_b64_tr_b16 v[28:29], v3 offset:16384
  s_add_u32 m0, s51, 1024
  v_mfma_f32_16x16x32_bf16 v[108:111], v[44:47], v[124:127], v[108:111]
  ds_read_b64_tr_b16 v[30:31], v3 offset:17408
  buffer_load_dwordx4 v241, s[12:15], s50 offen sc1 lds
  v_mfma_f32_16x16x32_bf16 v[96:99], v[48:51], v[120:123], v[96:99]
  ds_read_b64_tr_b16 v[32:33], v4 offset:16384
  s_add_u32 s50, s50, 8192
  v_mfma_f32_16x16x32_bf16 v[112:115], v[48:51], v[124:127], v[112:115]
  ds_read_b64_tr_b16 v[34:35], v4 offset:17408
  v_mfma_f32_16x16x32_bf16 v[100:103], v[52:55], v[120:123], v[100:103]
  ds_read_b64_tr_b16 v[36:37], v5 offset:16384
  v_mfma_f32_16x16x32_bf16 v[116:119], v[52:55], v[124:127], v[116:119]
  ds_read_b64_tr_b16 v[38:39], v5 offset:17408
  s_waitcnt vmcnt(14) lgkmcnt(0)
  v_mfma_f32_16x16x32_bf16 v[56:59], v[24:27], v[128:131], v[56:59]
  ds_read_b64_tr_b16 v[40:41], v2 offset:24576
  v_mfma_f32_16x16x32_bf16 v[72:75], v[24:27], v[132:135], v[72:75]
  ds_read_b64_tr_b16 v[42:43], v2 offset:25600
  v_mfma_f32_16x16x32_bf16 v[60:63], v[28:31], v[128:131], v[60:63]
  ds_read_b64_tr_b16 v[44:45], v3 offset:24576
  buffer_load_dwordx4 v[120:123], v6, s[12:15], s31 offen sc1
  v_mfma_f32_16x16x32_bf16 v[76:79], v[28:31], v[132:135], v[76:79]
  ds_read_b64_tr_b16 v[46:47], v3 offset:25600
  v_mfma_f32_16x16x32_bf16 v[64:67], v[32:35], v[128:131], v[64:67]
  ds_read_b64_tr_b16 v[48:49], v4 offset:24576
  v_mfma_f32_16x16x32_bf16 v[80:83], v[32:35], v[132:135], v[80:83]
  ds_read_b64_tr_b16 v[50:51], v4 offset:25600
  buffer_load_dwordx4 v[124:127], v7, s[12:15], s31 offen sc1
  s_add_u32 s31, s31, 4096
  v_mfma_f32_16x16x32_bf16 v[68:71], v[36:39], v[128:131], v[68:71]
  ds_read_b64_tr_b16 v[52:53], v5 offset:24576
  v_mfma_f32_16x16x32_bf16 v[84:87], v[36:39], v[132:135], v[84:87]
  ds_read_b64_tr_b16 v[54:55], v5 offset:25600
  s_waitcnt vmcnt(14) lgkmcnt(0)
  s_barrier
  v_mfma_f32_16x16x32_bf16 v[88:91], v[40:43], v[128:131], v[88:91]
  ds_read_b64_tr_b16 v[24:25], v2 offset:32768
  s_add_u32 m0, s51, 16384
  v_mfma_f32_16x16x32_bf16 v[104:107], v[40:43], v[132:135], v[104:107]
  ds_read_b64_tr_b16 v[26:27], v2 offset:33792
  buffer_load_dwordx4 v240, s[12:15], s50 offen sc1 lds
  v_mfma_f32_16x16x32_bf16 v[92:95], v[44:47], v[128:131], v[92:95]
  ds_read_b64_tr_b16 v[28:29], v3 offset:32768
  s_add_u32 m0, s51, 17408
  v_mfma_f32_16x16x32_bf16 v[108:111], v[44:47], v[132:135], v[108:111]
  ds_read_b64_tr_b16 v[30:31], v3 offset:33792
  buffer_load_dwordx4 v241, s[12:15], s50 offen sc1 lds
  v_mfma_f32_16x16x32_bf16 v[96:99], v[48:51], v[128:131], v[96:99]
  ds_read_b64_tr_b16 v[32:33], v4 offset:32768
  s_add_u32 s50, s50, 8192
  v_mfma_f32_16x16x32_bf16 v[112:115], v[48:51], v[132:135], v[112:115]
  ds_read_b64_tr_b16 v[34:35], v4 offset:33792
  v_mfma_f32_16x16x32_bf16 v[100:103], v[52:55], v[128:131], v[100:103]
  ds_read_b64_tr_b16 v[36:37], v5 offset:32768
  v_mfma_f32_16x16x32_bf16 v[116:119], v[52:55], v[132:135], v[116:119]
  ds_read_b64_tr_b16 v[38:39], v5 offset:33792
  s_waitcnt vmcnt(14) lgkmcnt(0)
  v_mfma_f32_16x16x32_bf16 v[56:59], v[24:27], v[136:139], v[56:59]
  ds_read_b64_tr_b16 v[40:41], v2 offset:40960
  v_mfma_f32_16x16x32_bf16 v[72:75], v[24:27], v[140:143], v[72:75]
  ds_read_b64_tr_b16 v[42:43], v2 offset:41984
  v_mfma_f32_16x16x32_bf16 v[60:63], v[28:31], v[136:139], v[60:63]
  ds_read_b64_tr_b16 v[44:45], v3 offset:40960
  buffer_load_dwordx4 v[128:131], v6, s[12:15], s31 offen sc1
  v_mfma_f32_16x16x32_bf16 v[76:79], v[28:31], v[140:143], v[76:79]
  ds_read_b64_tr_b16 v[46:47], v3 offset:41984
  v_mfma_f32_16x16x32_bf16 v[64:67], v[32:35], v[136:139], v[64:67]
  ds_read_b64_tr_b16 v[48:49], v4 offset:40960
  v_mfma_f32_16x16x32_bf16 v[80:83], v[32:35], v[140:143], v[80:83]
  ds_read_b64_tr_b16 v[50:51], v4 offset:41984
  buffer_load_dwordx4 v[132:135], v7, s[12:15], s31 offen sc1
  s_add_u32 s31, s31, 4096
  v_mfma_f32_16x16x32_bf16 v[68:71], v[36:39], v[136:139], v[68:71]
  ds_read_b64_tr_b16 v[52:53], v5 offset:40960
  v_mfma_f32_16x16x32_bf16 v[84:87], v[36:39], v[140:143], v[84:87]
  ds_read_b64_tr_b16 v[54:55], v5 offset:41984
  s_waitcnt vmcnt(14) lgkmcnt(0)
  s_barrier
  v_mfma_f32_16x16x32_bf16 v[88:91], v[40:43], v[136:139], v[88:91]
  ds_read_b64_tr_b16 v[24:25], v2 offset:49152
  s_add_u32 m0, s51, 32768
  v_mfma_f32_16x16x32_bf16 v[104:107], v[40:43], v[140:143], v[104:107]
  ds_read_b64_tr_b16 v[26:27], v2 offset:50176
  buffer_load_dwordx4 v240, s[12:15], s50 offen sc1 lds
  v_mfma_f32_16x16x32_bf16 v[92:95], v[44:47], v[136:139], v[92:95]
  ds_read_b64_tr_b16 v[28:29], v3 offset:49152
  s_add_u32 m0, s51, 33792
  v_mfma_f32_16x16x32_bf16 v[108:111], v[44:47], v[140:143], v[108:111]
  ds_read_b64_tr_b16 v[30:31], v3 offset:50176
  buffer_load_dwordx4 v241, s[12:15], s50 offen sc1 lds
  v_mfma_f32_16x16x32_bf16 v[96:99], v[48:51], v[136:139], v[96:99]
  ds_read_b64_tr_b16 v[32:33], v4 offset:49152
  s_add_u32 s50, s50, 8192
  v_mfma_f32_16x16x32_bf16 v[112:115], v[48:51], v[140:143], v[112:115]
  ds_read_b64_tr_b16 v[34:35], v4 offset:50176
  v_mfma_f32_16x16x32_bf16 v[100:103], v[52:55], v[136:139], v[100:103]
  ds_read_b64_tr_b16 v[36:37], v5 offset:49152
  v_mfma_f32_16x16x32_bf16 v[116:119], v[52:55], v[140:143], v[116:119]
  ds_read_b64_tr_b16 v[38:39], v5 offset:50176
  s_waitcnt vmcnt(14) lgkmcnt(0)
  v_mfma_f32_16x16x32_bf16 v[56:59], v[24:27], v[144:147], v[56:59]
  ds_read_b64_tr_b16 v[40:41], v2 offset:57344
  v_mfma_f32_16x16x32_bf16 v[72:75], v[24:27], v[148:151], v[72:75]
  ds_read_b64_tr_b16 v[42:43], v2 offset:58368
  v_mfma_f32_16x16x32_bf16 v[60:63], v[28:31], v[144:147], v[60:63]
  ds_read_b64_tr_b16 v[44:45], v3 offset:57344
  buffer_load_dwordx4 v[136:139], v6, s[12:15], s31 offen sc1
  v_mfma_f32_16x16x32_bf16 v[76:79], v[28:31], v[148:151], v[76:79]
  ds_read_b64_tr_b16 v[46:47], v3 offset:58368
  v_mfma_f32_16x16x32_bf16 v[64:67], v[32:35], v[144:147], v[64:67]
  ds_read_b64_tr_b16 v[48:49], v4 offset:57344
  v_mfma_f32_16x16x32_bf16 v[80:83], v[32:35], v[148:151], v[80:83]
  ds_read_b64_tr_b16 v[50:51], v4 offset:58368
  buffer_load_dwordx4 v[140:143], v7, s[12:15], s31 offen sc1
  s_add_u32 s31, s31, 4096
  v_mfma_f32_16x16x32_bf16 v[68:71], v[36:39], v[144:147], v[68:71]
  ds_read_b64_tr_b16 v[52:53], v5 offset:57344
  v_mfma_f32_16x16x32_bf16 v[84:87], v[36:39], v[148:151], v[84:87]
  ds_read_b64_tr_b16 v[54:55], v5 offset:58368
  s_waitcnt vmcnt(14) lgkmcnt(0)
  s_barrier
  v_mfma_f32_16x16x32_bf16 v[88:91], v[40:43], v[144:147], v[88:91]
  ds_read_b64_tr_b16 v[24:25], v204 offset:0
  v_mfma_f32_16x16x32_bf16 v[104:107], v[40:43], v[148:151], v[104:107]
  ds_read_b64_tr_b16 v[26:27], v204 offset:1024
  v_mfma_f32_16x16x32_bf16 v[92:95], v[44:47], v[144:147], v[92:95]
  ds_read_b64_tr_b16 v[28:29], v205 offset:0
  v_mfma_f32_16x16x32_bf16 v[108:111], v[44:47], v[148:151], v[108:111]
  ds_read_b64_tr_b16 v[30:31], v205 offset:1024
  v_mfma_f32_16x16x32_bf16 v[96:99], v[48:51], v[144:147], v[96:99]
  ds_read_b64_tr_b16 v[32:33], v206 offset:0
  v_mfma_f32_16x16x32_bf16 v[112:115], v[48:51], v[148:151], v[112:115]
  ds_read_b64_tr_b16 v[34:35], v206 offset:1024
  v_mfma_f32_16x16x32_bf16 v[100:103], v[52:55], v[144:147], v[100:103]
  ds_read_b64_tr_b16 v[36:37], v207 offset:0
  v_mfma_f32_16x16x32_bf16 v[116:119], v[52:55], v[148:151], v[116:119]
  ds_read_b64_tr_b16 v[38:39], v207 offset:1024
  s_waitcnt vmcnt(12) lgkmcnt(0)
  v_mfma_f32_16x16x32_bf16 v[56:59], v[24:27], v[152:155], v[56:59]
  ds_read_b64_tr_b16 v[40:41], v204 offset:8192
  v_mfma_f32_16x16x32_bf16 v[72:75], v[24:27], v[156:159], v[72:75]
  ds_read_b64_tr_b16 v[42:43], v204 offset:9216
  v_mfma_f32_16x16x32_bf16 v[60:63], v[28:31], v[152:155], v[60:63]
  ds_read_b64_tr_b16 v[44:45], v205 offset:8192
  v_mfma_f32_16x16x32_bf16 v[76:79], v[28:31], v[156:159], v[76:79]
  ds_read_b64_tr_b16 v[46:47], v205 offset:9216
  v_mfma_f32_16x16x32_bf16 v[64:67], v[32:35], v[152:155], v[64:67]
  ds_read_b64_tr_b16 v[48:49], v206 offset:8192
  v_mfma_f32_16x16x32_bf16 v[80:83], v[32:35], v[156:159], v[80:83]
  ds_read_b64_tr_b16 v[50:51], v206 offset:9216
  v_mfma_f32_16x16x32_bf16 v[68:71], v[36:39], v[152:155], v[68:71]
  ds_read_b64_tr_b16 v[52:53], v207 offset:8192
  v_mfma_f32_16x16x32_bf16 v[84:87], v[36:39], v[156:159], v[84:87]
  ds_read_b64_tr_b16 v[54:55], v207 offset:9216
  s_waitcnt vmcnt(10) lgkmcnt(0)
  s_barrier
  v_mfma_f32_16x16x32_bf16 v[88:91], v[40:43], v[152:155], v[88:91]
  ds_read_b64_tr_b16 v[24:25], v2 offset:0
  v_mfma_f32_16x16x32_bf16 v[104:107], v[40:43], v[156:159], v[104:107]
  ds_read_b64_tr_b16 v[26:27], v2 offset:1024
  v_mfma_f32_16x16x32_bf16 v[92:95], v[44:47], v[152:155], v[92:95]
  ds_read_b64_tr_b16 v[28:29], v3 offset:0
  v_mfma_f32_16x16x32_bf16 v[108:111], v[44:47], v[156:159], v[108:111]
  ds_read_b64_tr_b16 v[30:31], v3 offset:1024
  v_mfma_f32_16x16x32_bf16 v[96:99], v[48:51], v[152:155], v[96:99]
  ds_read_b64_tr_b16 v[32:33], v4 offset:0
  v_mfma_f32_16x16x32_bf16 v[112:115], v[48:51], v[156:159], v[112:115]
  ds_read_b64_tr_b16 v[34:35], v4 offset:1024
  v_mfma_f32_16x16x32_bf16 v[100:103], v[52:55], v[152:155], v[100:103]
  ds_read_b64_tr_b16 v[36:37], v5 offset:0
  v_mfma_f32_16x16x32_bf16 v[116:119], v[52:55], v[156:159], v[116:119]
  ds_read_b64_tr_b16 v[38:39], v5 offset:1024
  s_waitcnt vmcnt(6) lgkmcnt(0)
  s_barrier
  v_mfma_f32_16x16x32_bf16 v[56:59], v[24:27], v[120:123], v[56:59]
  ds_read_b64_tr_b16 v[40:41], v2 offset:16384
  v_mfma_f32_16x16x32_bf16 v[72:75], v[24:27], v[124:127], v[72:75]
  ds_read_b64_tr_b16 v[42:43], v2 offset:17408
  v_mfma_f32_16x16x32_bf16 v[60:63], v[28:31], v[120:123], v[60:63]
  ds_read_b64_tr_b16 v[44:45], v3 offset:16384
  v_mfma_f32_16x16x32_bf16 v[76:79], v[28:31], v[124:127], v[76:79]
  ds_read_b64_tr_b16 v[46:47], v3 offset:17408
  buffer_load_dwordx4 v[208:211], v201, s[12:15], s38 offen offset:0 sc1
  v_mfma_f32_16x16x32_bf16 v[64:67], v[32:35], v[120:123], v[64:67]
  ds_read_b64_tr_b16 v[48:49], v4 offset:16384
  v_mfma_f32_16x16x32_bf16 v[80:83], v[32:35], v[124:127], v[80:83]
  ds_read_b64_tr_b16 v[50:51], v4 offset:17408
  buffer_load_dwordx4 v[212:215], v201, s[12:15], s38 offen offset:1024 sc1
  v_mfma_f32_16x16x32_bf16 v[68:71], v[36:39], v[120:123], v[68:71]
  ds_read_b64_tr_b16 v[52:53], v5 offset:16384
  v_mfma_f32_16x16x32_bf16 v[84:87], v[36:39], v[124:127], v[84:87]
  ds_read_b64_tr_b16 v[54:55], v5 offset:17408
  s_waitcnt vmcnt(4) lgkmcnt(0)
  s_barrier
  v_mfma_f32_16x16x32_bf16 v[56:59], v[40:43], v[128:131], v[56:59]
  ds_read_b64_tr_b16 v[24:25], v2 offset:32768
  v_mfma_f32_16x16x32_bf16 v[72:75], v[40:43], v[132:135], v[72:75]
  ds_read_b64_tr_b16 v[26:27], v2 offset:33792
  v_mfma_f32_16x16x32_bf16 v[60:63], v[44:47], v[128:131], v[60:63]
  ds_read_b64_tr_b16 v[28:29], v3 offset:32768
  v_mfma_f32_16x16x32_bf16 v[76:79], v[44:47], v[132:135], v[76:79]
  ds_read_b64_tr_b16 v[30:31], v3 offset:33792
  v_mfma_f32_16x16x32_bf16 v[64:67], v[48:51], v[128:131], v[64:67]
  ds_read_b64_tr_b16 v[32:33], v4 offset:32768
  v_mfma_f32_16x16x32_bf16 v[80:83], v[48:51], v[132:135], v[80:83]
  ds_read_b64_tr_b16 v[34:35], v4 offset:33792
  v_mfma_f32_16x16x32_bf16 v[68:71], v[52:55], v[128:131], v[68:71]
  ds_read_b64_tr_b16 v[36:37], v5 offset:32768
  v_mfma_f32_16x16x32_bf16 v[84:87], v[52:55], v[132:135], v[84:87]
  ds_read_b64_tr_b16 v[38:39], v5 offset:33792
  s_waitcnt vmcnt(2) lgkmcnt(0)
  v_mfma_f32_16x16x32_bf16 v[56:59], v[24:27], v[136:139], v[56:59]
  ds_read_b64_tr_b16 v[40:41], v2 offset:8192
  v_mfma_f32_16x16x32_bf16 v[72:75], v[24:27], v[140:143], v[72:75]
  ds_read_b64_tr_b16 v[42:43], v2 offset:9216
  v_mfma_f32_16x16x32_bf16 v[60:63], v[28:31], v[136:139], v[60:63]
  ds_read_b64_tr_b16 v[44:45], v3 offset:8192
  v_mfma_f32_16x16x32_bf16 v[76:79], v[28:31], v[140:143], v[76:79]
  ds_read_b64_tr_b16 v[46:47], v3 offset:9216
  v_mfma_f32_16x16x32_bf16 v[64:67], v[32:35], v[136:139], v[64:67]
  ds_read_b64_tr_b16 v[48:49], v4 offset:8192
  v_mfma_f32_16x16x32_bf16 v[80:83], v[32:35], v[140:143], v[80:83]
  ds_read_b64_tr_b16 v[50:51], v4 offset:9216
  v_mfma_f32_16x16x32_bf16 v[68:71], v[36:39], v[136:139], v[68:71]
  ds_read_b64_tr_b16 v[52:53], v5 offset:8192
  v_mfma_f32_16x16x32_bf16 v[84:87], v[36:39], v[140:143], v[84:87]
  ds_read_b64_tr_b16 v[54:55], v5 offset:9216
  s_waitcnt lgkmcnt(0)
  v_mfma_f32_16x16x32_bf16 v[88:91], v[40:43], v[120:123], v[88:91]
  ds_read_b64_tr_b16 v[24:25], v2 offset:24576
  v_mfma_f32_16x16x32_bf16 v[104:107], v[40:43], v[124:127], v[104:107]
  ds_read_b64_tr_b16 v[26:27], v2 offset:25600
  v_mfma_f32_16x16x32_bf16 v[92:95], v[44:47], v[120:123], v[92:95]
  ds_read_b64_tr_b16 v[28:29], v3 offset:24576
  ds_write_b128 v13, v[72:75] offset:0
  v_mfma_f32_16x16x32_bf16 v[108:111], v[44:47], v[124:127], v[108:111]
  ds_read_b64_tr_b16 v[30:31], v3 offset:25600
  ds_write_b128 v13, v[76:79] offset:1024
  v_mfma_f32_16x16x32_bf16 v[96:99], v[48:51], v[120:123], v[96:99]
  ds_read_b64_tr_b16 v[32:33], v4 offset:24576
  ds_write_b128 v13, v[80:83] offset:2048
  v_mfma_f32_16x16x32_bf16 v[112:115], v[48:51], v[124:127], v[112:115]
  ds_read_b64_tr_b16 v[34:35], v4 offset:25600
  ds_write_b128 v13, v[84:87] offset:3072
  v_mfma_f32_16x16x32_bf16 v[100:103], v[52:55], v[120:123], v[100:103]
  ds_read_b64_tr_b16 v[36:37], v5 offset:24576
  v_mfma_f32_16x16x32_bf16 v[116:119], v[52:55], v[124:127], v[116:119]
  ds_read_b64_tr_b16 v[38:39], v5 offset:25600
  s_waitcnt lgkmcnt(0)
  s_barrier
  v_mfma_f32_16x16x32_bf16 v[88:91], v[24:27], v[128:131], v[88:91]
  ds_read_b128 v[72:75], v14 offset:0
  s_getreg_b32 s40, hwreg(HW_REG_XCC_ID, 0, 4)
  v_readfirstlane_b32 s41, v202
  ds_read_b64_tr_b16 v[40:41], v2 offset:40960
  v_mfma_f32_16x16x32_bf16 v[104:107], v[24:27], v[132:135], v[104:107]
  ds_read_b128 v[76:79], v14 offset:1024
  ds_read_b64_tr_b16 v[42:43], v2 offset:41984
  v_mfma_f32_16x16x32_bf16 v[92:95], v[28:31], v[128:131], v[92:95]
  ds_read_b128 v[80:83], v14 offset:2048
  ds_read_b64_tr_b16 v[44:45], v3 offset:40960
  v_mfma_f32_16x16x32_bf16 v[108:111], v[28:31], v[132:135], v[108:111]
  ds_read_b128 v[84:87], v14 offset:3072
  ds_read_b64_tr_b16 v[46:47], v3 offset:41984
  v_mfma_f32_16x16x32_bf16 v[96:99], v[32:35], v[128:131], v[96:99]
  ds_read_b64_tr_b16 v[48:49], v4 offset:40960
  v_mfma_f32_16x16x32_bf16 v[112:115], v[32:35], v[132:135], v[112:115]
  ds_read_b64_tr_b16 v[50:51], v4 offset:41984
  v_mfma_f32_16x16x32_bf16 v[100:103], v[36:39], v[128:131], v[100:103]
  ds_read_b64_tr_b16 v[52:53], v5 offset:40960
  v_mfma_f32_16x16x32_bf16 v[116:119], v[36:39], v[132:135], v[116:119]
  ds_read_b64_tr_b16 v[54:55], v5 offset:41984
  s_waitcnt lgkmcnt(0)
  v_mfma_f32_16x16x32_bf16 v[88:91], v[40:43], v[136:139], v[88:91]
  v_add_f32 v56, v56, v72
  v_add_f32 v57, v57, v73
  v_cvt_pk_bf16_f32 v224, v56, v57
  v_add_f32 v58, v58, v74
  v_mfma_f32_16x16x32_bf16 v[104:107], v[40:43], v[140:143], v[104:107]
  v_add_f32 v59, v59, v75
  v_cvt_pk_bf16_f32 v225, v58, v59
  v_add_f32 v60, v60, v76
  v_add_f32 v61, v61, v77
  v_mfma_f32_16x16x32_bf16 v[92:95], v[44:47], v[136:139], v[92:95]
  v_cvt_pk_bf16_f32 v226, v60, v61
  v_add_f32 v62, v62, v78
  v_add_f32 v63, v63, v79
  v_cvt_pk_bf16_f32 v227, v62, v63
  s_cmp_eq_u32 s40, s41
  s_cbranch_scc1 L_p5fast_42
  buffer_store_dwordx4 v[224:227], v201, s[12:15], s39 offen offset:0 sc1
  s_branch L_p5sent_43
L_p5fast_42:
  buffer_store_dwordx4 v[224:227], v201, s[12:15], s39 offen offset:0
L_p5sent_43:
  v_mfma_f32_16x16x32_bf16 v[108:111], v[44:47], v[140:143], v[108:111]
  v_add_f32 v64, v64, v80
  v_add_f32 v65, v65, v81
  v_cvt_pk_bf16_f32 v228, v64, v65
  v_add_f32 v66, v66, v82
  v_mfma_f32_16x16x32_bf16 v[96:99], v[48:51], v[136:139], v[96:99]
  v_add_f32 v67, v67, v83
  v_cvt_pk_bf16_f32 v229, v66, v67
  v_add_f32 v68, v68, v84
  v_add_f32 v69, v69, v85
  v_mfma_f32_16x16x32_bf16 v[112:115], v[48:51], v[140:143], v[112:115]
  v_cvt_pk_bf16_f32 v230, v68, v69
  v_add_f32 v70, v70, v86
  v_add_f32 v71, v71, v87
  v_cvt_pk_bf16_f32 v231, v70, v71
  s_cmp_eq_u32 s40, s41
  s_cbranch_scc1 L_p5fast_44
  buffer_store_dwordx4 v[228:231], v201, s[12:15], s39 offen offset:1024 sc1
  s_branch L_p5sent_45
L_p5fast_44:
  buffer_store_dwordx4 v[228:231], v201, s[12:15], s39 offen offset:1024
L_p5sent_45:
  v_mfma_f32_16x16x32_bf16 v[100:103], v[52:55], v[136:139], v[100:103]
  v_mfma_f32_16x16x32_bf16 v[116:119], v[52:55], v[140:143], v[116:119]
  buffer_load_dwordx4 v[232:235], v201, s[12:15], s38 offen offset:0 sc1
  buffer_load_dwordx4 v[236:239], v201, s[12:15], s38 offen offset:1024 sc1
  ds_write_b128 v13, v[104:107] offset:4096
  ds_write_b128 v13, v[108:111] offset:5120
  ds_write_b128 v13, v[112:115] offset:6144
  s_nop 2
  ds_write_b128 v13, v[116:119] offset:7168
  s_waitcnt lgkmcnt(0)
  s_barrier
  ds_read_b128 v[104:107], v14 offset:4096
  ds_read_b128 v[108:111], v14 offset:5120
  ds_read_b128 v[112:115], v14 offset:6144
  ds_read_b128 v[116:119], v14 offset:7168
  buffer_load_dwordx4 v[208:211], v201, s[12:15], s38 offen offset:0 sc1
  buffer_load_dwordx4 v[212:215], v201, s[12:15], s38 offen offset:1024 sc1
  s_waitcnt lgkmcnt(0)
  v_pk_add_f32 v[88:89], v[88:89], v[104:105]
  v_pk_add_f32 v[90:91], v[90:91], v[106:107]
  v_pk_add_f32 v[92:93], v[92:93], v[108:109]
  v_pk_add_f32 v[94:95], v[94:95], v[110:111]
  v_pk_add_f32 v[96:97], v[96:97], v[112:113]
  v_pk_add_f32 v[98:99], v[98:99], v[114:115]
  v_pk_add_f32 v[100:101], v[100:101], v[116:117]
  v_pk_add_f32 v[102:103], v[102:103], v[118:119]
  s_mov_b32 s28, 0
  s_waitcnt vmcnt(2)
  v_max3_u32 v12, v232, v233, v234
  v_max3_u32 v203, v235, v236, v237
  v_max3_u32 v12, v12, v238, v239
  v_max_u32 v12, v12, v203
  v_cmp_eq_u32 vcc, -1, v12
  s_cmp_eq_u64 vcc, 0
  s_cbranch_scc1 L_p5gotA_47
  s_mov_b32 s28, 1
  s_waitcnt vmcnt(0)
  v_max3_u32 v12, v208, v209, v210
  v_max3_u32 v203, v211, v212, v213
  v_max3_u32 v12, v12, v214, v215
  v_max_u32 v12, v12, v203
  v_cmp_eq_u32 vcc, -1, v12
  s_cmp_eq_u64 vcc, 0
  s_cbranch_scc1 L_p5gotB_48
L_p5poll_49:
  buffer_load_dwordx4 v[232:235], v201, s[12:15], s38 offen offset:0 sc1
  buffer_load_dwordx4 v[236:239], v201, s[12:15], s38 offen offset:1024 sc1
  s_add_u32 s28, s28, 1
  s_waitcnt vmcnt(0)
  v_max3_u32 v12, v232, v233, v234
  v_max3_u32 v203, v235, v236, v237
  v_max3_u32 v12, v12, v238, v239
  v_max_u32 v12, v12, v203
  v_cmp_eq_u32 vcc, -1, v12
  s_cmp_eq_u64 vcc, 0
  s_cbranch_scc1 L_p5gotA_47
  s_cmp_lt_u32 s28, 65536
  s_cbranch_scc1 L_p5poll_49
  s_branch L_p5gotA_47
L_p5gotB_48:
  v_lshlrev_b32 v40, 16, v208
  v_and_b32 v41, v15, v208
  v_lshlrev_b32 v42, 16, v209
  v_and_b32 v43, v15, v209
  v_lshlrev_b32 v44, 16, v210
  v_and_b32 v45, v15, v210
  v_lshlrev_b32 v46, 16, v211
  v_and_b32 v47, v15, v211
  v_lshlrev_b32 v48, 16, v212
  v_and_b32 v49, v15, v212
  v_lshlrev_b32 v50, 16, v213
  v_and_b32 v51, v15, v213
  v_lshlrev_b32 v52, 16, v214
  v_and_b32 v53, v15, v214
  v_lshlrev_b32 v54, 16, v215
  v_and_b32 v55, v15, v215
  s_branch L_p5join_50
L_p5gotA_47:
  v_lshlrev_b32 v40, 16, v232
  v_and_b32 v41, v15, v232
  v_lshlrev_b32 v42, 16, v233
  v_and_b32 v43, v15, v233
  v_lshlrev_b32 v44, 16, v234
  v_and_b32 v45, v15, v234
  v_lshlrev_b32 v46, 16, v235
  v_and_b32 v47, v15, v235
  v_lshlrev_b32 v48, 16, v236
  v_and_b32 v49, v15, v236
  v_lshlrev_b32 v50, 16, v237
  v_and_b32 v51, v15, v237
  v_lshlrev_b32 v52, 16, v238
  v_and_b32 v53, v15, v238
  v_lshlrev_b32 v54, 16, v239
  v_and_b32 v55, v15, v239
L_p5join_50:
  v_pk_add_f32 v[88:89], v[88:89], v[40:41]
  v_pk_add_f32 v[90:91], v[90:91], v[42:43]
  v_pk_add_f32 v[92:93], v[92:93], v[44:45]
  v_pk_add_f32 v[94:95], v[94:95], v[46:47]
  v_pk_add_f32 v[96:97], v[96:97], v[48:49]
  v_pk_add_f32 v[98:99], v[98:99], v[50:51]
  v_pk_add_f32 v[100:101], v[100:101], v[52:53]
  v_pk_add_f32 v[102:103], v[102:103], v[54:55]
  v_cvt_pk_bf16_f32 v16, v88, v89
  v_cvt_pk_bf16_f32 v17, v90, v91
  ds_write_b64 v216, v[16:17]
  v_cvt_pk_bf16_f32 v18, v92, v93
  v_cvt_pk_bf16_f32 v19, v94, v95
  ds_write_b64 v217, v[18:19]
  v_cvt_pk_bf16_f32 v20, v96, v97
  v_cvt_pk_bf16_f32 v21, v98, v99
  ds_write_b64 v218, v[20:21]
  v_cvt_pk_bf16_f32 v22, v100, v101
  v_cvt_pk_bf16_f32 v23, v102, v103
  ds_write_b64 v219, v[22:23]
  ds_read_b128 v[16:19], v200 offset:0
  ds_read_b128 v[20:23], v220 offset:1024
  s_waitcnt lgkmcnt(1)
  buffer_store_dwordx4 v[16:19], v11, s[16:19], s33 offen
  s_waitcnt lgkmcnt(0)
  buffer_store_dwordx4 v[20:23], v11, s[16:19], s34 offen
  s_waitcnt vmcnt(0)
L_end:
  s_endpgm
.section .rodata,"a"
.p2align 6
.amdhsa_kernel sequential_preLN__mha_block__glu_gated_geglu__prompt_kernel
  .amdhsa_next_free_vgpr 256
  .amdhsa_next_free_sgpr 102
  .amdhsa_accum_offset 256
  .amdhsa_group_segment_fixed_size 0
  .amdhsa_kernarg_size 80
  .amdhsa_user_sgpr_count 2
  .amdhsa_user_sgpr_kernarg_segment_ptr 1
  .amdhsa_system_sgpr_workgroup_id_x 1
.end_amdhsa_kernel
```
